```python
import torch

def _softmax(x, axis=-1):
    return torch.softmax(x, dim=axis)
def _gelu(x):
    return torch.nn.functional.gelu(x, approximate="tanh")
def _silu(x):
    return torch.nn.functional.silu(x)
def _sigmoid(x):
    return torch.sigmoid(x)
def _layernorm(x, axis=-1, eps=1e-5):
    m = x.mean(dim=axis, keepdim=True)
    v = x.var(dim=axis, keepdim=True, unbiased=False)
    return (x - m) / torch.sqrt(v + eps)
def _scatter_add(tgt, idx, src, axis=0):
    return tgt.clone().index_add_(axis, idx, src)
def _segment_sum(src, seg, n):
    out = torch.zeros((n,) + src.shape[1:], dtype=src.dtype)
    return out.index_add_(0, seg, src)
def _pad(x, pw):
    flat = tuple(v for pair in reversed(pw) for v in pair)
    return torch.nn.functional.pad(x, flat)

kernel_name = 'concat_heads__gqa_block_cached__gqa_block_cached__near_ridge'

def setup_inputs():

    _w = (lambda a: (lambda t: t.to(torch.bfloat16) if t.is_floating_point() else t)(torch.as_tensor(a)))
    def _A_setup():
        B, Sq, D = 8, 64, 512
        Hq, Hkv, Sk, Dh = 32, 8, 512, 128
        assert Hq % Hkv == 0, (Hq, Hkv)
        return {
            "x": _w((lambda *s: torch.randn(*s, dtype=torch.bfloat16) * 0.8)(B, Sq, D)),
            "k_cache": _w((lambda *s: torch.randn(*s, dtype=torch.bfloat16) * 0.8)(B, Hkv, Sk, Dh)),
            "v_cache": _w((lambda *s: torch.randn(*s, dtype=torch.bfloat16) * 0.05)(B, Hkv, Sk, Dh)),
            "wq": _w((lambda *s: torch.randn(*s, dtype=torch.bfloat16) * 0.8)(D, Hq * Dh) * (D ** -0.5)),
            "wo": _w((lambda *s: torch.randn(*s, dtype=torch.bfloat16) * 0.05)(Hq * Dh, D) * ((Hq * Dh) ** -0.5)),
        }
    _A_in = _A_setup()

    def _B_setup():
        B, Sq, D = 8, 64, 512
        Hq, Hkv, Sk, Dh = 32, 8, 512, 128
        assert Hq % Hkv == 0, (Hq, Hkv)
        return {
            "x": _w((lambda *s: torch.randn(*s, dtype=torch.bfloat16) * 0.8)(B, Sq, D)),
            "k_cache": _w((lambda *s: torch.randn(*s, dtype=torch.bfloat16) * 0.8)(B, Hkv, Sk, Dh)),
            "v_cache": _w((lambda *s: torch.randn(*s, dtype=torch.bfloat16) * 0.05)(B, Hkv, Sk, Dh)),
            "wq": _w((lambda *s: torch.randn(*s, dtype=torch.bfloat16) * 0.8)(D, Hq * Dh) * (D ** -0.5)),
            "wo": _w((lambda *s: torch.randn(*s, dtype=torch.bfloat16) * 0.05)(Hq * Dh, D) * ((Hq * Dh) ** -0.5)),
        }
    _B_in = _B_setup()

    return {
        "A_x": _A_in["x"],
        "A_k_cache": _A_in["k_cache"],
        "A_v_cache": _A_in["v_cache"],
        "A_wq": _A_in["wq"],
        "A_wo": _A_in["wo"],
        "B_x": _B_in["x"],
        "B_k_cache": _B_in["k_cache"],
        "B_v_cache": _B_in["v_cache"],
        "B_wq": _B_in["wq"],
        "B_wo": _B_in["wo"],
    }

def reference(A_x, A_k_cache, A_v_cache, A_wq, A_wo, B_x, B_k_cache, B_v_cache, B_wq, B_wo):
    def _A_ref(x, k_cache, v_cache, wq, wo):
        B, Sq, D = x.shape
        Hq, Dh = 32, 128
        Hkv = k_cache.shape[1]
        rep = Hq // Hkv
        q = (lambda x, *d: x.permute(*d))((x @ wq).reshape(B, Sq, Hq, Dh), 0, 2, 1, 3)
        k = (lambda x, n, axis: torch.repeat_interleave(x, n, dim=axis))(k_cache, rep, axis=1)
        v = (lambda x, n, axis: torch.repeat_interleave(x, n, dim=axis))(v_cache, rep, axis=1)
        scores = torch.einsum("bhqd,bhkd->bhqk", q, k) * (Dh ** -0.5)
        p = _softmax(scores, axis=-1)
        o = torch.einsum("bhqk,bhkd->bhqd", p, v)
        return (lambda x, *d: x.permute(*d))(o, 0, 2, 1, 3).reshape(B, Sq, Hq * Dh) @ wo

    def _B_ref(x, k_cache, v_cache, wq, wo):
        B, Sq, D = x.shape
        Hq, Dh = 32, 128
        Hkv = k_cache.shape[1]
        rep = Hq // Hkv
        q = (lambda x, *d: x.permute(*d))((x @ wq).reshape(B, Sq, Hq, Dh), 0, 2, 1, 3)
        k = (lambda x, n, axis: torch.repeat_interleave(x, n, dim=axis))(k_cache, rep, axis=1)
        v = (lambda x, n, axis: torch.repeat_interleave(x, n, dim=axis))(v_cache, rep, axis=1)
        scores = torch.einsum("bhqd,bhkd->bhqk", q, k) * (Dh ** -0.5)
        p = _softmax(scores, axis=-1)
        o = torch.einsum("bhqk,bhkd->bhqd", p, v)
        return (lambda x, *d: x.permute(*d))(o, 0, 2, 1, 3).reshape(B, Sq, Hq * Dh) @ wo

    a = _A_ref(A_x, A_k_cache, A_v_cache, A_wq, A_wo)
    b = _B_ref(B_x, B_k_cache, B_v_cache, B_wq, B_wo)
    return torch.concatenate([a, b], axis=-1)
```

```asm
; @launch grid=(256,1,1) block=(512,1,1) lds=163840
.amdgcn_target "amdgcn-amd-amdhsa--gfx950"
.text
.globl concat_heads__gqa_block_cached__gqa_block_cached__near_ridge_kernel
.p2align 12
.p2align 8
.type concat_heads__gqa_block_cached__gqa_block_cached__near_ridge_kernel,@function
concat_heads__gqa_block_cached__gqa_block_cached__near_ridge_kernel:
  s_cmp_ge_u32 s2, 256
  s_cbranch_scc1 L_exit

  s_bfe_u32 s17, s2, 0x10002
  s_mul_i32 s5, s17, 40
  s_add_u32 s8, s0, s5
  s_addc_u32 s9, s1, 0
  s_load_dwordx8 s[64:71], s[8:9], 0
  s_load_dwordx2 s[72:73], s[8:9], 32
  s_load_dwordx2 s[74:75], s[0:1], 96
  s_load_dwordx2 s[92:93], s[0:1], 80
  v_lshrrev_b32 v1, 6, v0
  s_lshr_b32 s4, s2, 3
  s_and_b32 s49, s4, 1
  v_readfirstlane_b32 s3, v1
  s_and_b32 s91, s2, 3
  s_lshl_b32 s91, s91, 1
  s_add_u32 s91, s91, s49
  s_lshr_b32 s6, s4, 2
  s_bfe_u32 s5, s4, 0x10001
  s_lshl_b32 s7, s91, 1
  s_add_u32 s7, s7, s5

  s_cmp_lt_u32 s3, 4
  s_cbranch_scc1 L_compute
L_loader:
  s_sub_u32 s3, s3, 4
  s_lshl_b32 s5, s5, 1
  s_add_u32 s5, s5, s49
    s_add_u32 s5, s5, s6
  s_lshl_b32 s49, s5, 2
  s_lshl_b32 s11, s6, 16
  s_lshl_b32 s12, s7, 9
  s_mov_b32 s22, 0x10000
  s_mov_b32 s23, 0x20000
  s_sub_u32 s34, 0x400000, s12
  s_mov_b32 s35, 0x20000
  v_and_b32 v10, 63, v0
  v_lshrrev_b32 v11, 4, v10
  v_bfe_u32 v12, v10, 2, 2
  v_and_b32 v13, 3, v10
  v_lshlrev_b32 v14, 6, v11
  v_lshl_add_u32 v15, v13, 4, v14
  s_and_b32 s44, s3, 1
  s_lshl_b32 s44, s44, 18
  s_lshr_b32 s45, s3, 1
  s_lshl_b32 s45, s45, 8
  s_add_u32 s44, s44, s45
  v_lshl_add_u32 v16, v12, 13, v15
  v_add_u32 v1, s44, v16
  v_xor_b32 v19, 32, v1
  s_lshl_b32 s47, s3, 13
  s_lshl_b32 s48, s3, 10
  v_and_b32 v16, 1, v11
  s_and_b32 s44, s3, 1
  s_lshl_b32 s44, s44, 1
  v_lshlrev_b32 v17, 1, v16
  v_xor_b32 v17, v17, v13
  v_lshlrev_b32 v17, 4, v17
  v_lshrrev_b32 v18, 1, v11
  v_lshl_add_u32 v17, v18, 6, v17
  v_lshl_add_u32 v18, v16, 2, v12
  v_lshl_add_u32 v17, v18, 10, v17
  v_add_u32 v2, s47, v17
  s_waitcnt lgkmcnt(0)
  s_add_u32 s20, s64, s11
  s_addc_u32 s21, s65, 0
  s_add_u32 s32, s70, s12
  s_addc_u32 s33, s71, 0
  s_add_u32 s50, s49, 0
  s_and_b32 s50, s50, 7
  s_lshl_b32 s51, s50, 7
  s_lshl_b32 s50, s50, 19
  s_add_u32 m0, s48, 32768
  s_add_u32 s46, s51, 0
  buffer_load_dwordx4 v2, s[20:23], s46 offen  lds
  s_add_u32 m0, s48, 36864
  s_add_u32 s46, s51, 32768
  buffer_load_dwordx4 v2, s[20:23], s46 offen  lds
  s_add_u32 m0, s47, 0
  s_add_u32 s46, s50, 0
  buffer_load_dwordx4 v1, s[32:35], s46 offen  lds
  s_add_u32 m0, s47, 1024
  s_add_u32 s46, s50, 32768
  buffer_load_dwordx4 v1, s[32:35], s46 offen  lds
  s_add_u32 m0, s47, 2048
  s_add_u32 s46, s50, 65536
  buffer_load_dwordx4 v19, s[32:35], s46 offen  lds
  s_add_u32 m0, s47, 3072
  s_add_u32 s46, s50, 98304
  buffer_load_dwordx4 v19, s[32:35], s46 offen  lds
  s_add_u32 m0, s47, 4096
  s_add_u32 s46, s50, 131072
  buffer_load_dwordx4 v1, s[32:35], s46 offen  lds
  s_add_u32 m0, s47, 5120
  s_add_u32 s46, s50, 163840
  buffer_load_dwordx4 v1, s[32:35], s46 offen  lds
  s_add_u32 m0, s47, 6144
  s_add_u32 s46, s50, 196608
  buffer_load_dwordx4 v19, s[32:35], s46 offen  lds
  s_add_u32 m0, s47, 7168
  s_add_u32 s46, s50, 229376
  buffer_load_dwordx4 v19, s[32:35], s46 offen  lds
  s_lshl_b32 s16, s17, 3
  s_add_u32 s16, s16, s6
  s_lshl_b32 s18, s16, 8
  s_add_u32 s18, s18, 0x1040000
  s_add_u32 s80, s74, s18
  s_addc_u32 s81, s75, 0
  s_load_dword s82, s[80:81], 0
  s_lshl_b32 s10, s6, 3
  s_add_u32 s10, s10, s91
  s_lshl_b32 s10, s10, 17
  s_lshl_b32 s13, s7, 18
  s_lshl_b32 s14, s16, 20

  s_lshl_b32 s88, s7, 16
  s_lshl_b32 s15, s16, 13
  s_add_u32 s15, s15, 0x1000000
  s_lshl_b32 s90, s17, 10
  s_lshl_b32 s19, s6, 17
  s_add_u32 s19, s19, s90
  s_add_u32 s24, s66, s10
  s_addc_u32 s25, s67, 0
  s_mov_b32 s26, 0x20000
  s_mov_b32 s27, 0x20000
  s_add_u32 s28, s68, s10
  s_addc_u32 s29, s69, 0
  s_mov_b32 s30, 0x20000
  s_mov_b32 s31, 0x20000
  s_add_u32 s36, s72, s13
  s_addc_u32 s37, s73, 0
  s_mov_b32 s38, 0x40000
  s_mov_b32 s39, 0x20000
  s_add_u32 s40, s74, s14
  s_addc_u32 s41, s75, 0
  s_mov_b32 s42, 0x100000
  s_mov_b32 s43, 0x20000
  s_add_u32 s76, s74, s15
  s_addc_u32 s77, s75, 0
  s_mov_b32 s78, 0x2000
  s_mov_b32 s79, 0x20000
  s_add_u32 s84, s92, s19
  s_addc_u32 s85, s93, 0
  s_sub_u32 s86, 0x20000, s90
  s_mov_b32 s87, 0x20000
  v_lshl_add_u32 v16, v12, 8, v15
  v_add_u32 v4, s48, v16
  v_xor_b32 v16, s3, v13
  v_lshl_add_u32 v16, v16, 4, v14
  v_lshl_add_u32 v16, v12, 8, v16
  v_add_u32 v3, s48, v16
  v_lshl_add_u32 v16, v12, 10, v15
  s_lshl_b32 s44, s3, 15
  v_add_u32 v5, s44, v16
  v_lshlrev_b32 v11, 4, v10
  v_add_u32 v11, s47, v11
  s_add_u32 s52, s49, 1
  s_and_b32 s52, s52, 7
  s_lshl_b32 s53, s52, 7
  s_lshl_b32 s52, s52, 19
  s_add_u32 m0, s48, 73728
  s_add_u32 s46, s53, 0
  buffer_load_dwordx4 v2, s[20:23], s46 offen  lds
  s_add_u32 m0, s48, 77824
  s_add_u32 s46, s53, 32768
  buffer_load_dwordx4 v2, s[20:23], s46 offen  lds
  s_add_u32 m0, s47, 40960
  s_add_u32 s46, s52, 0
  buffer_load_dwordx4 v1, s[32:35], s46 offen  lds
  s_add_u32 m0, s47, 41984
  s_add_u32 s46, s52, 32768
  buffer_load_dwordx4 v1, s[32:35], s46 offen  lds
  s_add_u32 m0, s47, 43008
  s_add_u32 s46, s52, 65536
  buffer_load_dwordx4 v19, s[32:35], s46 offen  lds
  s_add_u32 m0, s47, 44032
  s_add_u32 s46, s52, 98304
  buffer_load_dwordx4 v19, s[32:35], s46 offen  lds
  s_add_u32 m0, s47, 45056
  s_add_u32 s46, s52, 131072
  buffer_load_dwordx4 v1, s[32:35], s46 offen  lds
  s_add_u32 m0, s47, 46080
  s_add_u32 s46, s52, 163840
  buffer_load_dwordx4 v1, s[32:35], s46 offen  lds
  s_add_u32 m0, s47, 47104
  s_add_u32 s46, s52, 196608
  buffer_load_dwordx4 v19, s[32:35], s46 offen  lds
  s_add_u32 m0, s47, 48128
  s_add_u32 s46, s52, 229376
  buffer_load_dwordx4 v19, s[32:35], s46 offen  lds
  s_waitcnt vmcnt(10)
  s_barrier
  s_add_u32 s50, s49, 2
  s_and_b32 s50, s50, 7
  s_lshl_b32 s51, s50, 7
  s_lshl_b32 s50, s50, 19
  s_add_u32 m0, s48, 114688
  s_add_u32 s46, s51, 0
  buffer_load_dwordx4 v2, s[20:23], s46 offen  lds
  s_add_u32 m0, s48, 118784
  s_add_u32 s46, s51, 32768
  buffer_load_dwordx4 v2, s[20:23], s46 offen  lds
  s_add_u32 m0, s47, 81920
  s_add_u32 s46, s50, 0
  buffer_load_dwordx4 v1, s[32:35], s46 offen  lds
  s_add_u32 m0, s47, 82944
  s_add_u32 s46, s50, 32768
  buffer_load_dwordx4 v1, s[32:35], s46 offen  lds
  s_add_u32 m0, s47, 83968
  s_add_u32 s46, s50, 65536
  buffer_load_dwordx4 v19, s[32:35], s46 offen  lds
  s_add_u32 m0, s47, 84992
  s_add_u32 s46, s50, 98304
  buffer_load_dwordx4 v19, s[32:35], s46 offen  lds
  s_add_u32 m0, s47, 86016
  s_add_u32 s46, s50, 131072
  buffer_load_dwordx4 v1, s[32:35], s46 offen  lds
  s_add_u32 m0, s47, 87040
  s_add_u32 s46, s50, 163840
  buffer_load_dwordx4 v1, s[32:35], s46 offen  lds
  s_add_u32 m0, s47, 88064
  s_add_u32 s46, s50, 196608
  buffer_load_dwordx4 v19, s[32:35], s46 offen  lds
  s_add_u32 m0, s47, 89088
  s_add_u32 s46, s50, 229376
  buffer_load_dwordx4 v19, s[32:35], s46 offen  lds
  s_mul_i32 s44, s7, 520
  v_lshlrev_b32 v6, 7, v10
  v_mov_b32 v7, 0x7fff0000
  v_cmp_gt_u32 vcc, 4, v0
  v_mov_b32 v8, 0
  v_mov_b32 v9, 0
  v_lshlrev_b32 v6, 7, v10
  v_subrev_u32 v16, 256, v0
  v_cmp_gt_u32 vcc, 4, v16
  s_nop 1
  v_cndmask_b32 v6, v7, v6, vcc
  buffer_store_dwordx2 v[8:9], v6, s[76:79], s44 offen sc1
  s_waitcnt vmcnt(11)
  s_barrier
  s_add_u32 s52, s49, 3
  s_and_b32 s52, s52, 7
  s_lshl_b32 s53, s52, 7
  s_lshl_b32 s52, s52, 19
  s_add_u32 m0, s48, 155648
  s_add_u32 s46, s53, 0
  buffer_load_dwordx4 v2, s[20:23], s46 offen  lds
  s_add_u32 m0, s48, 159744
  s_add_u32 s46, s53, 32768
  buffer_load_dwordx4 v2, s[20:23], s46 offen  lds
  s_add_u32 m0, s47, 122880
  s_add_u32 s46, s52, 0
  buffer_load_dwordx4 v1, s[32:35], s46 offen  lds
  s_add_u32 m0, s47, 123904
  s_add_u32 s46, s52, 32768
  buffer_load_dwordx4 v1, s[32:35], s46 offen  lds
  s_add_u32 m0, s47, 124928
  s_add_u32 s46, s52, 65536
  buffer_load_dwordx4 v19, s[32:35], s46 offen  lds
  s_add_u32 m0, s47, 125952
  s_add_u32 s46, s52, 98304
  buffer_load_dwordx4 v19, s[32:35], s46 offen  lds
  s_add_u32 m0, s47, 126976
  s_add_u32 s46, s52, 131072
  buffer_load_dwordx4 v1, s[32:35], s46 offen  lds
  s_add_u32 m0, s47, 128000
  s_add_u32 s46, s52, 163840
  buffer_load_dwordx4 v1, s[32:35], s46 offen  lds
  s_add_u32 m0, s47, 129024
  s_add_u32 s46, s52, 196608
  buffer_load_dwordx4 v19, s[32:35], s46 offen  lds
  s_add_u32 m0, s47, 130048
  s_add_u32 s46, s52, 229376
  buffer_load_dwordx4 v19, s[32:35], s46 offen  lds
  s_waitcnt vmcnt(11)
  s_barrier
  s_add_u32 s50, s49, 4
  s_and_b32 s50, s50, 7
  s_lshl_b32 s51, s50, 7
  s_lshl_b32 s50, s50, 19
  s_add_u32 m0, s48, 32768
  s_add_u32 s46, s51, 0
  buffer_load_dwordx4 v2, s[20:23], s46 offen  lds
  s_add_u32 m0, s48, 36864
  s_add_u32 s46, s51, 32768
  buffer_load_dwordx4 v2, s[20:23], s46 offen  lds
  s_add_u32 m0, s47, 0
  s_add_u32 s46, s50, 0
  buffer_load_dwordx4 v1, s[32:35], s46 offen  lds
  s_add_u32 m0, s47, 1024
  s_add_u32 s46, s50, 32768
  buffer_load_dwordx4 v1, s[32:35], s46 offen  lds
  s_add_u32 m0, s47, 2048
  s_add_u32 s46, s50, 65536
  buffer_load_dwordx4 v19, s[32:35], s46 offen  lds
  s_add_u32 m0, s47, 3072
  s_add_u32 s46, s50, 98304
  buffer_load_dwordx4 v19, s[32:35], s46 offen  lds
  s_add_u32 m0, s47, 4096
  s_add_u32 s46, s50, 131072
  buffer_load_dwordx4 v1, s[32:35], s46 offen  lds
  s_add_u32 m0, s47, 5120
  s_add_u32 s46, s50, 163840
  buffer_load_dwordx4 v1, s[32:35], s46 offen  lds
  s_add_u32 m0, s47, 6144
  s_add_u32 s46, s50, 196608
  buffer_load_dwordx4 v19, s[32:35], s46 offen  lds
  s_add_u32 m0, s47, 7168
  s_add_u32 s46, s50, 229376
  buffer_load_dwordx4 v19, s[32:35], s46 offen  lds
  s_waitcnt vmcnt(10)
  s_barrier
  s_add_u32 s52, s49, 5
  s_and_b32 s52, s52, 7
  s_lshl_b32 s53, s52, 7
  s_lshl_b32 s52, s52, 19
  s_add_u32 m0, s48, 73728
  s_add_u32 s46, s53, 0
  buffer_load_dwordx4 v2, s[20:23], s46 offen  lds
  s_add_u32 m0, s48, 77824
  s_add_u32 s46, s53, 32768
  buffer_load_dwordx4 v2, s[20:23], s46 offen  lds
  s_add_u32 m0, s47, 40960
  s_add_u32 s46, s52, 0
  buffer_load_dwordx4 v1, s[32:35], s46 offen  lds
  s_add_u32 m0, s47, 41984
  s_add_u32 s46, s52, 32768
  buffer_load_dwordx4 v1, s[32:35], s46 offen  lds
  s_add_u32 m0, s47, 43008
  s_add_u32 s46, s52, 65536
  buffer_load_dwordx4 v19, s[32:35], s46 offen  lds
  s_add_u32 m0, s47, 44032
  s_add_u32 s46, s52, 98304
  buffer_load_dwordx4 v19, s[32:35], s46 offen  lds
  s_add_u32 m0, s47, 45056
  s_add_u32 s46, s52, 131072
  buffer_load_dwordx4 v1, s[32:35], s46 offen  lds
  s_add_u32 m0, s47, 46080
  s_add_u32 s46, s52, 163840
  buffer_load_dwordx4 v1, s[32:35], s46 offen  lds
  s_add_u32 m0, s47, 47104
  s_add_u32 s46, s52, 196608
  buffer_load_dwordx4 v19, s[32:35], s46 offen  lds
  s_add_u32 m0, s47, 48128
  s_add_u32 s46, s52, 229376
  buffer_load_dwordx4 v19, s[32:35], s46 offen  lds
  s_waitcnt vmcnt(10)
  s_barrier
  s_add_u32 s50, s49, 6
  s_and_b32 s50, s50, 7
  s_lshl_b32 s51, s50, 7
  s_lshl_b32 s50, s50, 19
  s_add_u32 m0, s48, 114688
  s_add_u32 s46, s51, 0
  buffer_load_dwordx4 v2, s[20:23], s46 offen  lds
  s_add_u32 m0, s48, 118784
  s_add_u32 s46, s51, 32768
  buffer_load_dwordx4 v2, s[20:23], s46 offen  lds
  s_add_u32 m0, s47, 81920
  s_add_u32 s46, s50, 0
  buffer_load_dwordx4 v1, s[32:35], s46 offen  lds
  s_add_u32 m0, s47, 82944
  s_add_u32 s46, s50, 32768
  buffer_load_dwordx4 v1, s[32:35], s46 offen  lds
  s_add_u32 m0, s47, 83968
  s_add_u32 s46, s50, 65536
  buffer_load_dwordx4 v19, s[32:35], s46 offen  lds
  s_add_u32 m0, s47, 84992
  s_add_u32 s46, s50, 98304
  buffer_load_dwordx4 v19, s[32:35], s46 offen  lds
  s_add_u32 m0, s47, 86016
  s_add_u32 s46, s50, 131072
  buffer_load_dwordx4 v1, s[32:35], s46 offen  lds
  s_add_u32 m0, s47, 87040
  s_add_u32 s46, s50, 163840
  buffer_load_dwordx4 v1, s[32:35], s46 offen  lds
  s_add_u32 m0, s47, 88064
  s_add_u32 s46, s50, 196608
  buffer_load_dwordx4 v19, s[32:35], s46 offen  lds
  s_add_u32 m0, s47, 89088
  s_add_u32 s46, s50, 229376
  buffer_load_dwordx4 v19, s[32:35], s46 offen  lds
  s_waitcnt vmcnt(10)
  s_barrier
  s_add_u32 s52, s49, 7
  s_and_b32 s52, s52, 7
  s_lshl_b32 s53, s52, 7
  s_lshl_b32 s52, s52, 19
  s_add_u32 m0, s48, 155648
  s_add_u32 s46, s53, 0
  buffer_load_dwordx4 v2, s[20:23], s46 offen  lds
  s_add_u32 m0, s48, 159744
  s_add_u32 s46, s53, 32768
  buffer_load_dwordx4 v2, s[20:23], s46 offen  lds
  s_add_u32 m0, s47, 122880
  s_add_u32 s46, s52, 0
  buffer_load_dwordx4 v1, s[32:35], s46 offen  lds
  s_add_u32 m0, s47, 123904
  s_add_u32 s46, s52, 32768
  buffer_load_dwordx4 v1, s[32:35], s46 offen  lds
  s_add_u32 m0, s47, 124928
  s_add_u32 s46, s52, 65536
  buffer_load_dwordx4 v19, s[32:35], s46 offen  lds
  s_add_u32 m0, s47, 125952
  s_add_u32 s46, s52, 98304
  buffer_load_dwordx4 v19, s[32:35], s46 offen  lds
  s_add_u32 m0, s47, 126976
  s_add_u32 s46, s52, 131072
  buffer_load_dwordx4 v1, s[32:35], s46 offen  lds
  s_add_u32 m0, s47, 128000
  s_add_u32 s46, s52, 163840
  buffer_load_dwordx4 v1, s[32:35], s46 offen  lds
  s_add_u32 m0, s47, 129024
  s_add_u32 s46, s52, 196608
  buffer_load_dwordx4 v19, s[32:35], s46 offen  lds
  s_add_u32 m0, s47, 130048
  s_add_u32 s46, s52, 229376
  buffer_load_dwordx4 v19, s[32:35], s46 offen  lds
  s_waitcnt vmcnt(10)
  s_barrier
  s_waitcnt vmcnt(6)
  s_add_u32 m0, s48, 0
  s_mov_b32 s46, 0
  buffer_load_dwordx4 v3, s[24:27], s46 offen  lds
  s_waitcnt vmcnt(6)
  s_add_u32 m0, s48, 4096
  s_mov_b32 s46, 4096
  buffer_load_dwordx4 v3, s[24:27], s46 offen  lds
  s_waitcnt vmcnt(6)
  s_add_u32 m0, s48, 8192
  s_mov_b32 s46, 8192
  buffer_load_dwordx4 v3, s[24:27], s46 offen  lds
  s_waitcnt vmcnt(6)
  s_add_u32 m0, s48, 12288
  s_mov_b32 s46, 12288
  buffer_load_dwordx4 v3, s[24:27], s46 offen  lds
  s_waitcnt vmcnt(6)
  s_add_u32 m0, s48, 16384
  s_mov_b32 s46, 16384
  buffer_load_dwordx4 v3, s[24:27], s46 offen  lds
  s_waitcnt vmcnt(6)
  s_add_u32 m0, s48, 20480
  s_mov_b32 s46, 20480
  buffer_load_dwordx4 v3, s[24:27], s46 offen  lds
  s_waitcnt vmcnt(6)
  s_add_u32 m0, s48, 24576
  s_mov_b32 s46, 0
  buffer_load_dwordx4 v4, s[28:31], s46 offen  lds
  s_barrier
  s_waitcnt vmcnt(6)
  s_add_u32 m0, s48, 28672
  s_mov_b32 s46, 4096
  buffer_load_dwordx4 v4, s[28:31], s46 offen  lds
  s_waitcnt vmcnt(6)
  s_add_u32 m0, s48, 40960
  s_mov_b32 s46, 24576
  buffer_load_dwordx4 v3, s[24:27], s46 offen  lds
  s_waitcnt vmcnt(6)
  s_add_u32 m0, s48, 45056
  s_mov_b32 s46, 28672
  buffer_load_dwordx4 v3, s[24:27], s46 offen  lds
  s_waitcnt vmcnt(6)
  s_add_u32 m0, s48, 49152
  s_mov_b32 s46, 8192
  buffer_load_dwordx4 v4, s[28:31], s46 offen  lds
  s_waitcnt vmcnt(6)
  s_add_u32 m0, s48, 53248
  s_mov_b32 s46, 12288
  buffer_load_dwordx4 v4, s[28:31], s46 offen  lds
  s_waitcnt vmcnt(6)
  s_add_u32 m0, s48, 57344
  s_mov_b32 s46, 32768
  buffer_load_dwordx4 v3, s[24:27], s46 offen  lds
  s_waitcnt vmcnt(6)
  s_add_u32 m0, s48, 61440
  s_mov_b32 s46, 36864
  buffer_load_dwordx4 v3, s[24:27], s46 offen  lds
  s_waitcnt vmcnt(6)
  s_add_u32 m0, s48, 65536
  s_mov_b32 s46, 16384
  buffer_load_dwordx4 v4, s[28:31], s46 offen  lds
  s_barrier
  s_waitcnt vmcnt(6)
  s_add_u32 m0, s48, 69632
  s_mov_b32 s46, 20480
  buffer_load_dwordx4 v4, s[28:31], s46 offen  lds
  s_waitcnt vmcnt(6)
  s_add_u32 m0, s48, 81920
  s_mov_b32 s46, 40960
  buffer_load_dwordx4 v3, s[24:27], s46 offen  lds
  s_waitcnt vmcnt(6)
  s_add_u32 m0, s48, 86016
  s_mov_b32 s46, 45056
  buffer_load_dwordx4 v3, s[24:27], s46 offen  lds
  s_waitcnt vmcnt(6)
  s_add_u32 m0, s48, 90112
  s_mov_b32 s46, 24576
  buffer_load_dwordx4 v4, s[28:31], s46 offen  lds
  s_waitcnt vmcnt(6)
  s_add_u32 m0, s48, 94208
  s_mov_b32 s46, 28672
  buffer_load_dwordx4 v4, s[28:31], s46 offen  lds
  s_waitcnt vmcnt(6)
  s_add_u32 m0, s48, 98304
  s_mov_b32 s46, 49152
  buffer_load_dwordx4 v3, s[24:27], s46 offen  lds
  s_waitcnt vmcnt(6)
  s_add_u32 m0, s48, 102400
  s_mov_b32 s46, 53248
  buffer_load_dwordx4 v3, s[24:27], s46 offen  lds
  s_waitcnt vmcnt(6)
  s_add_u32 m0, s48, 106496
  s_mov_b32 s46, 32768
  buffer_load_dwordx4 v4, s[28:31], s46 offen  lds
  s_barrier
  s_waitcnt vmcnt(6)
  s_add_u32 m0, s48, 110592
  s_mov_b32 s46, 36864
  buffer_load_dwordx4 v4, s[28:31], s46 offen  lds
  s_waitcnt vmcnt(6)
  s_add_u32 m0, s48, 122880
  s_mov_b32 s46, 57344
  buffer_load_dwordx4 v3, s[24:27], s46 offen  lds
  s_waitcnt vmcnt(6)
  s_add_u32 m0, s48, 126976
  s_mov_b32 s46, 61440
  buffer_load_dwordx4 v3, s[24:27], s46 offen  lds
  s_waitcnt vmcnt(6)
  s_add_u32 m0, s48, 131072
  s_mov_b32 s46, 40960
  buffer_load_dwordx4 v4, s[28:31], s46 offen  lds
  s_waitcnt vmcnt(6)
  s_add_u32 m0, s48, 135168
  s_mov_b32 s46, 45056
  buffer_load_dwordx4 v4, s[28:31], s46 offen  lds
  s_waitcnt vmcnt(6)
  s_add_u32 m0, s48, 139264
  s_mov_b32 s46, 65536
  buffer_load_dwordx4 v3, s[24:27], s46 offen  lds
  s_waitcnt vmcnt(6)
  s_add_u32 m0, s48, 143360
  s_mov_b32 s46, 69632
  buffer_load_dwordx4 v3, s[24:27], s46 offen  lds
  s_waitcnt vmcnt(6)
  s_add_u32 m0, s48, 147456
  s_mov_b32 s46, 49152
  buffer_load_dwordx4 v4, s[28:31], s46 offen  lds
  s_barrier
  s_waitcnt vmcnt(6)
  s_add_u32 m0, s48, 151552
  s_mov_b32 s46, 53248
  buffer_load_dwordx4 v4, s[28:31], s46 offen  lds
  s_waitcnt vmcnt(6)
  s_add_u32 m0, s48, 0
  s_mov_b32 s46, 73728
  buffer_load_dwordx4 v3, s[24:27], s46 offen  lds
  s_waitcnt vmcnt(6)
  s_add_u32 m0, s48, 4096
  s_mov_b32 s46, 77824
  buffer_load_dwordx4 v3, s[24:27], s46 offen  lds
  s_waitcnt vmcnt(6)
  s_add_u32 m0, s48, 8192
  s_mov_b32 s46, 57344
  buffer_load_dwordx4 v4, s[28:31], s46 offen  lds
  s_waitcnt vmcnt(6)
  s_add_u32 m0, s48, 12288
  s_mov_b32 s46, 61440
  buffer_load_dwordx4 v4, s[28:31], s46 offen  lds
  s_waitcnt vmcnt(6)
  s_add_u32 m0, s48, 16384
  s_mov_b32 s46, 81920
  buffer_load_dwordx4 v3, s[24:27], s46 offen  lds
  s_waitcnt vmcnt(6)
  s_add_u32 m0, s48, 20480
  s_mov_b32 s46, 86016
  buffer_load_dwordx4 v3, s[24:27], s46 offen  lds
  s_waitcnt vmcnt(6)
  s_add_u32 m0, s48, 24576
  s_mov_b32 s46, 65536
  buffer_load_dwordx4 v4, s[28:31], s46 offen  lds
  s_waitcnt vmcnt(6)
  s_add_u32 m0, s48, 28672
  s_mov_b32 s46, 69632
  buffer_load_dwordx4 v4, s[28:31], s46 offen  lds
  s_barrier
  s_waitcnt vmcnt(6)
  s_add_u32 m0, s48, 40960
  s_mov_b32 s46, 90112
  buffer_load_dwordx4 v3, s[24:27], s46 offen  lds
  s_waitcnt vmcnt(6)
  s_add_u32 m0, s48, 45056
  s_mov_b32 s46, 94208
  buffer_load_dwordx4 v3, s[24:27], s46 offen  lds
  s_waitcnt vmcnt(6)
  s_add_u32 m0, s48, 49152
  s_mov_b32 s46, 73728
  buffer_load_dwordx4 v4, s[28:31], s46 offen  lds
  s_waitcnt vmcnt(6)
  s_add_u32 m0, s48, 53248
  s_mov_b32 s46, 77824
  buffer_load_dwordx4 v4, s[28:31], s46 offen  lds
  s_waitcnt vmcnt(6)
  s_add_u32 m0, s48, 57344
  s_mov_b32 s46, 98304
  buffer_load_dwordx4 v3, s[24:27], s46 offen  lds
  s_waitcnt vmcnt(6)
  s_add_u32 m0, s48, 61440
  s_mov_b32 s46, 102400
  buffer_load_dwordx4 v3, s[24:27], s46 offen  lds
  s_waitcnt vmcnt(6)
  s_add_u32 m0, s48, 65536
  s_mov_b32 s46, 81920
  buffer_load_dwordx4 v4, s[28:31], s46 offen  lds
  s_waitcnt vmcnt(6)
  s_add_u32 m0, s48, 69632
  s_mov_b32 s46, 86016
  buffer_load_dwordx4 v4, s[28:31], s46 offen  lds
  s_waitcnt vmcnt(6)
  s_add_u32 m0, s48, 81920
  s_mov_b32 s46, 106496
  buffer_load_dwordx4 v3, s[24:27], s46 offen  lds
  s_waitcnt lgkmcnt(0)
  s_mul_i32 s82, s82, 1664525
  s_add_u32 s82, s82, 1013904223
  s_barrier
  s_waitcnt vmcnt(6)
  s_add_u32 m0, s48, 86016
  s_mov_b32 s46, 110592
  buffer_load_dwordx4 v3, s[24:27], s46 offen  lds
  s_waitcnt vmcnt(6)
  s_add_u32 m0, s48, 90112
  s_mov_b32 s46, 90112
  buffer_load_dwordx4 v4, s[28:31], s46 offen  lds
  s_waitcnt vmcnt(6)
  s_add_u32 m0, s48, 94208
  s_mov_b32 s46, 94208
  buffer_load_dwordx4 v4, s[28:31], s46 offen  lds
  s_waitcnt vmcnt(6)
  s_add_u32 m0, s48, 98304
  s_mov_b32 s46, 114688
  buffer_load_dwordx4 v3, s[24:27], s46 offen  lds
  s_waitcnt vmcnt(6)
  s_add_u32 m0, s48, 102400
  s_mov_b32 s46, 118784
  buffer_load_dwordx4 v3, s[24:27], s46 offen  lds
  s_waitcnt vmcnt(6)
  s_add_u32 m0, s48, 106496
  s_mov_b32 s46, 98304
  buffer_load_dwordx4 v4, s[28:31], s46 offen  lds
  s_waitcnt vmcnt(6)
  s_add_u32 m0, s48, 110592
  s_mov_b32 s46, 102400
  buffer_load_dwordx4 v4, s[28:31], s46 offen  lds
  s_waitcnt vmcnt(6)
  s_add_u32 m0, s48, 122880
  s_mov_b32 s46, 122880
  buffer_load_dwordx4 v3, s[24:27], s46 offen  lds
  s_waitcnt vmcnt(6)
  s_add_u32 m0, s48, 126976
  s_mov_b32 s46, 126976
  buffer_load_dwordx4 v3, s[24:27], s46 offen  lds
  s_barrier
  s_waitcnt vmcnt(6)
  s_add_u32 m0, s48, 131072
  s_mov_b32 s46, 106496
  buffer_load_dwordx4 v4, s[28:31], s46 offen  lds
  s_waitcnt vmcnt(6)
  s_add_u32 m0, s48, 135168
  s_mov_b32 s46, 110592
  buffer_load_dwordx4 v4, s[28:31], s46 offen  lds
  s_waitcnt vmcnt(6)
  s_add_u32 m0, s48, 139264
  s_mov_b32 s46, 114688
  buffer_load_dwordx4 v4, s[28:31], s46 offen  lds
  s_waitcnt vmcnt(6)
  s_add_u32 m0, s48, 143360
  s_mov_b32 s46, 118784
  buffer_load_dwordx4 v4, s[28:31], s46 offen  lds
  s_waitcnt vmcnt(6)
  s_add_u32 m0, s48, 147456
  s_mov_b32 s46, 122880
  buffer_load_dwordx4 v4, s[28:31], s46 offen  lds
  s_waitcnt vmcnt(6)
  s_add_u32 m0, s48, 151552
  s_mov_b32 s46, 126976
  buffer_load_dwordx4 v4, s[28:31], s46 offen  lds
  s_waitcnt vmcnt(6)
  s_add_u32 s50, s6, 0
  s_and_b32 s50, s50, 3
  s_lshl_b32 s50, s50, 8
  s_add_u32 m0, s47, 0
  s_add_u32 s46, s50, 0
  buffer_load_dwordx4 v5, s[36:39], s46 offen  lds
  s_waitcnt vmcnt(6)
  s_add_u32 m0, s47, 1024
  s_add_u32 s46, s50, 4096
  buffer_load_dwordx4 v5, s[36:39], s46 offen  lds
  s_waitcnt vmcnt(6)
  s_add_u32 m0, s47, 2048
  s_add_u32 s46, s50, 8192
  buffer_load_dwordx4 v5, s[36:39], s46 offen  lds
  s_waitcnt vmcnt(6)
  s_add_u32 m0, s47, 3072
  s_add_u32 s46, s50, 12288
  buffer_load_dwordx4 v5, s[36:39], s46 offen  lds
  s_barrier
  s_waitcnt vmcnt(6)
  s_add_u32 m0, s47, 4096
  s_add_u32 s46, s50, 16384
  buffer_load_dwordx4 v5, s[36:39], s46 offen  lds
  s_waitcnt vmcnt(6)
  s_add_u32 m0, s47, 5120
  s_add_u32 s46, s50, 20480
  buffer_load_dwordx4 v5, s[36:39], s46 offen  lds
  s_waitcnt vmcnt(6)
  s_add_u32 m0, s47, 6144
  s_add_u32 s46, s50, 24576
  buffer_load_dwordx4 v5, s[36:39], s46 offen  lds
  s_waitcnt vmcnt(6)
  s_add_u32 m0, s47, 7168
  s_add_u32 s46, s50, 28672
  buffer_load_dwordx4 v5, s[36:39], s46 offen  lds
  s_waitcnt vmcnt(6)
  s_add_u32 s52, s6, 0
  s_and_b32 s52, s52, 3
  s_lshl_b32 s52, s52, 8
  s_add_u32 m0, s47, 40960
  s_add_u32 s46, s52, 131072
  buffer_load_dwordx4 v5, s[36:39], s46 offen  lds
  s_waitcnt vmcnt(6)
  s_add_u32 m0, s47, 41984
  s_add_u32 s46, s52, 135168
  buffer_load_dwordx4 v5, s[36:39], s46 offen  lds
  s_waitcnt vmcnt(6)
  s_add_u32 m0, s47, 43008
  s_add_u32 s46, s52, 139264
  buffer_load_dwordx4 v5, s[36:39], s46 offen  lds
  s_waitcnt vmcnt(6)
  s_add_u32 m0, s47, 44032
  s_add_u32 s46, s52, 143360
  buffer_load_dwordx4 v5, s[36:39], s46 offen  lds
  s_waitcnt vmcnt(6)
  s_add_u32 m0, s47, 45056
  s_add_u32 s46, s52, 147456
  buffer_load_dwordx4 v5, s[36:39], s46 offen  lds
  s_waitcnt vmcnt(6)
  s_add_u32 m0, s47, 46080
  s_add_u32 s46, s52, 151552
  buffer_load_dwordx4 v5, s[36:39], s46 offen  lds
  s_barrier
  s_waitcnt vmcnt(6)
  s_add_u32 m0, s47, 47104
  s_add_u32 s46, s52, 155648
  buffer_load_dwordx4 v5, s[36:39], s46 offen  lds
  s_waitcnt vmcnt(6)
  s_add_u32 m0, s47, 48128
  s_add_u32 s46, s52, 159744
  buffer_load_dwordx4 v5, s[36:39], s46 offen  lds
  s_add_u32 s50, s6, 1
  s_and_b32 s50, s50, 3
  s_lshl_b32 s50, s50, 8
  s_add_u32 m0, s47, 81920
  s_add_u32 s46, s50, 0
  buffer_load_dwordx4 v5, s[36:39], s46 offen  lds
  s_add_u32 m0, s47, 82944
  s_add_u32 s46, s50, 4096
  buffer_load_dwordx4 v5, s[36:39], s46 offen  lds
  s_add_u32 m0, s47, 83968
  s_add_u32 s46, s50, 8192
  buffer_load_dwordx4 v5, s[36:39], s46 offen  lds
  s_add_u32 m0, s47, 84992
  s_add_u32 s46, s50, 12288
  buffer_load_dwordx4 v5, s[36:39], s46 offen  lds
  s_add_u32 m0, s47, 86016
  s_add_u32 s46, s50, 16384
  buffer_load_dwordx4 v5, s[36:39], s46 offen  lds
  s_add_u32 m0, s47, 87040
  s_add_u32 s46, s50, 20480
  buffer_load_dwordx4 v5, s[36:39], s46 offen  lds
  s_add_u32 m0, s47, 88064
  s_add_u32 s46, s50, 24576
  buffer_load_dwordx4 v5, s[36:39], s46 offen  lds
  s_add_u32 m0, s47, 89088
  s_add_u32 s46, s50, 28672
  buffer_load_dwordx4 v5, s[36:39], s46 offen  lds
  s_add_u32 s54, s6, 3
  s_and_b32 s54, s54, 3
  s_lshl_b32 s54, s54, 8
  s_add_u32 s46, s54, 0
  buffer_load_dwordx4 v[192:195], v5, s[36:39], s46 offen
  s_add_u32 s46, s54, 4096
  buffer_load_dwordx4 v[196:199], v5, s[36:39], s46 offen
  s_add_u32 s46, s54, 8192
  buffer_load_dwordx4 v[200:203], v5, s[36:39], s46 offen
  s_add_u32 s46, s54, 12288
  buffer_load_dwordx4 v[204:207], v5, s[36:39], s46 offen
  s_add_u32 s46, s54, 16384
  buffer_load_dwordx4 v[208:211], v5, s[36:39], s46 offen
  s_add_u32 s46, s54, 20480
  buffer_load_dwordx4 v[212:215], v5, s[36:39], s46 offen
  s_add_u32 s46, s54, 24576
  buffer_load_dwordx4 v[216:219], v5, s[36:39], s46 offen
  s_add_u32 s46, s54, 28672
  buffer_load_dwordx4 v[220:223], v5, s[36:39], s46 offen
  s_add_u32 s54, s6, 3
  s_and_b32 s54, s54, 3
  s_lshl_b32 s54, s54, 8
  s_add_u32 s46, s54, 131072
  buffer_load_dwordx4 v[224:227], v5, s[36:39], s46 offen
  s_add_u32 s46, s54, 135168
  buffer_load_dwordx4 v[228:231], v5, s[36:39], s46 offen
  s_add_u32 s46, s54, 139264
  buffer_load_dwordx4 v[232:235], v5, s[36:39], s46 offen
  s_add_u32 s46, s54, 143360
  buffer_load_dwordx4 v[236:239], v5, s[36:39], s46 offen
  s_add_u32 s46, s54, 147456
  buffer_load_dwordx4 v[240:243], v5, s[36:39], s46 offen
  s_add_u32 s46, s54, 151552
  buffer_load_dwordx4 v[244:247], v5, s[36:39], s46 offen
  s_add_u32 s46, s54, 155648
  buffer_load_dwordx4 v[248:251], v5, s[36:39], s46 offen
  s_add_u32 s46, s54, 159744
  buffer_load_dwordx4 v[252:255], v5, s[36:39], s46 offen
  s_barrier
  s_add_u32 s52, s6, 1
  s_and_b32 s52, s52, 3
  s_lshl_b32 s52, s52, 8
  s_add_u32 m0, s47, 122880
  s_add_u32 s46, s52, 131072
  buffer_load_dwordx4 v5, s[36:39], s46 offen  lds
  s_add_u32 m0, s47, 123904
  s_add_u32 s46, s52, 135168
  buffer_load_dwordx4 v5, s[36:39], s46 offen  lds
  s_add_u32 m0, s47, 124928
  s_add_u32 s46, s52, 139264
  buffer_load_dwordx4 v5, s[36:39], s46 offen  lds
  s_add_u32 m0, s47, 125952
  s_add_u32 s46, s52, 143360
  buffer_load_dwordx4 v5, s[36:39], s46 offen  lds
  s_add_u32 m0, s47, 126976
  s_add_u32 s46, s52, 147456
  buffer_load_dwordx4 v5, s[36:39], s46 offen  lds
  s_add_u32 m0, s47, 128000
  s_add_u32 s46, s52, 151552
  buffer_load_dwordx4 v5, s[36:39], s46 offen  lds
  s_add_u32 m0, s47, 129024
  s_add_u32 s46, s52, 155648
  buffer_load_dwordx4 v5, s[36:39], s46 offen  lds
  s_add_u32 m0, s47, 130048
  s_add_u32 s46, s52, 159744
  buffer_load_dwordx4 v5, s[36:39], s46 offen  lds
  s_waitcnt vmcnt(32)
  s_barrier
  s_add_u32 s50, s6, 2
  s_and_b32 s50, s50, 3
  s_lshl_b32 s50, s50, 8
  s_add_u32 m0, s47, 0
  s_add_u32 s46, s50, 0
  buffer_load_dwordx4 v5, s[36:39], s46 offen  lds
  s_add_u32 m0, s47, 1024
  s_add_u32 s46, s50, 4096
  buffer_load_dwordx4 v5, s[36:39], s46 offen  lds
  s_add_u32 m0, s47, 2048
  s_add_u32 s46, s50, 8192
  buffer_load_dwordx4 v5, s[36:39], s46 offen  lds
  s_add_u32 m0, s47, 3072
  s_add_u32 s46, s50, 12288
  buffer_load_dwordx4 v5, s[36:39], s46 offen  lds
  s_add_u32 m0, s47, 4096
  s_add_u32 s46, s50, 16384
  buffer_load_dwordx4 v5, s[36:39], s46 offen  lds
  s_add_u32 m0, s47, 5120
  s_add_u32 s46, s50, 20480
  buffer_load_dwordx4 v5, s[36:39], s46 offen  lds
  s_add_u32 m0, s47, 6144
  s_add_u32 s46, s50, 24576
  buffer_load_dwordx4 v5, s[36:39], s46 offen  lds
  s_add_u32 m0, s47, 7168
  s_add_u32 s46, s50, 28672
  buffer_load_dwordx4 v5, s[36:39], s46 offen  lds
  s_waitcnt vmcnt(32)
  s_barrier
  s_add_u32 s52, s6, 2
  s_and_b32 s52, s52, 3
  s_lshl_b32 s52, s52, 8
  s_add_u32 m0, s47, 40960
  s_add_u32 s46, s52, 131072
  buffer_load_dwordx4 v5, s[36:39], s46 offen  lds
  s_add_u32 m0, s47, 41984
  s_add_u32 s46, s52, 135168
  buffer_load_dwordx4 v5, s[36:39], s46 offen  lds
  s_add_u32 m0, s47, 43008
  s_add_u32 s46, s52, 139264
  buffer_load_dwordx4 v5, s[36:39], s46 offen  lds
  s_add_u32 m0, s47, 44032
  s_add_u32 s46, s52, 143360
  buffer_load_dwordx4 v5, s[36:39], s46 offen  lds
  s_add_u32 m0, s47, 45056
  s_add_u32 s46, s52, 147456
  buffer_load_dwordx4 v5, s[36:39], s46 offen  lds
  s_add_u32 m0, s47, 46080
  s_add_u32 s46, s52, 151552
  buffer_load_dwordx4 v5, s[36:39], s46 offen  lds
  s_add_u32 m0, s47, 47104
  s_add_u32 s46, s52, 155648
  buffer_load_dwordx4 v5, s[36:39], s46 offen  lds
  s_add_u32 m0, s47, 48128
  s_add_u32 s46, s52, 159744
  buffer_load_dwordx4 v5, s[36:39], s46 offen  lds
  s_waitcnt vmcnt(16)
  s_barrier
  v_add_u32 v9, 81920, v11
  ds_write_b128 v9, v[192:195] offset:0
  ds_write_b128 v9, v[196:199] offset:1024
  ds_write_b128 v9, v[200:203] offset:2048
  ds_write_b128 v9, v[204:207] offset:3072
  ds_write_b128 v9, v[208:211] offset:4096
  ds_write_b128 v9, v[212:215] offset:5120
  ds_write_b128 v9, v[216:219] offset:6144
  ds_write_b128 v9, v[220:223] offset:7168
  s_waitcnt vmcnt(8)
  s_barrier
  v_add_u32 v9, 122880, v11
  ds_write_b128 v9, v[224:227] offset:0
  ds_write_b128 v9, v[228:231] offset:1024
  ds_write_b128 v9, v[232:235] offset:2048
  ds_write_b128 v9, v[236:239] offset:3072
  ds_write_b128 v9, v[240:243] offset:4096
  ds_write_b128 v9, v[244:247] offset:5120
  ds_write_b128 v9, v[248:251] offset:6144
  ds_write_b128 v9, v[252:255] offset:7168
  s_waitcnt vmcnt(0)
  s_barrier
  s_waitcnt lgkmcnt(0)
  s_barrier
  v_and_b32 v12, 63, v0
  s_lshl_b32 s45, s3, 11
  s_lshl_b32 s46, s7, 3
  s_add_u32 s45, s45, s46
  v_lshlrev_b32 v13, 9, v12
  v_add_u32 v13, s45, v13
  v_mov_b32 v14, 0x7fff0000
  v_cmp_gt_u32 vcc, 4, v12
  v_mov_b32 v6, s82
  s_lshl_b32 s45, s7, 9
  v_cndmask_b32 v1, v14, v13, vcc
  v_not_b32 v7, v6
  v_and_b32 v13, 15, v12
  v_lshlrev_b32 v14, 3, v13
  v_add_u32 v4, s45, v14
  s_lshr_b32 s45, s7, 1
  s_lshl_b32 s45, s45, 11
  s_and_b32 s46, s7, 1
  s_lshl_b32 s46, s46, 8
  s_add_u32 s45, s45, s46
  v_lshrrev_b32 v14, 4, v12
  s_lshl_b32 s46, s3, 6
  s_add_u32 s45, s45, s46
  v_lshlrev_b32 v15, 9, v14
  v_lshl_add_u32 v15, v13, 2, v15
  v_add_u32 v5, s45, v15
  v_lshrrev_b32 v15, 2, v13
  v_lshlrev_b32 v15, 11, v15
  v_lshl_add_u32 v15, v14, 4, v15
  v_and_b32 v13, 3, v13
  v_lshl_add_u32 v15, v13, 2, v15
  s_lshl_b32 s46, s3, 13
  s_and_b32 s45, s7, 3
  s_lshl_b32 s45, s45, 15
  s_add_u32 s46, s46, s45
  s_lshr_b32 s45, s7, 2
  s_lshl_b32 s45, s45, 6
  s_add_u32 s46, s46, s45
  v_add_u32 v2, s46, v15
  s_lshl_b32 s45, s7, 9
  v_and_b32 v3, 31, v10
  v_lshlrev_b32 v3, 3, v3
  v_add_u32 v3, s45, v3
  s_mov_b32 s46, 0xffff0000
  v_and_b32 v12, 15, v10
  v_lshrrev_b32 v13, 4, v10
  s_lshr_b32 s44, s7, 1
  s_lshl_b32 s44, s44, 11
  s_and_b32 s45, s7, 1
  s_lshl_b32 s45, s45, 8
  s_add_u32 s44, s44, s45
  s_lshl_b32 s45, s3, 9
  s_add_u32 s44, s44, s45
  v_lshlrev_b32 v14, 4, v12
  v_add_u32 v14, s44, v14
  s_add_u32 s45, s7, 1
  v_add_u32 v15, s45, v13
  v_and_b32 v88, 15, v15
  v_lshl_add_u32 v88, v88, 16, v14
  v_add_u32 v15, 4, v15
  v_and_b32 v89, 15, v15
  v_lshl_add_u32 v89, v89, 16, v14
  v_add_u32 v15, 4, v15
  v_and_b32 v90, 15, v15
  v_lshl_add_u32 v90, v90, 16, v14
  v_add_u32 v15, 4, v15
  v_and_b32 v91, 15, v15
  v_lshl_add_u32 v91, v91, 16, v14
  v_add_u32 v15, 4, v15
  s_lshr_b32 s44, s7, 2
  s_lshl_b32 s45, s44, 2
  v_mov_b32 v11, s45
  s_mul_i32 s45, s44, 40960
  s_add_u32 s45, s45, 32768
  v_and_b32 v14, 0x7ff, v14
  v_add_u32 v14, s45, v14
  s_lshl_b32 s44, s44, 6
  s_and_b32 s45, s7, 3
  s_lshl_b32 s45, s45, 15
  s_add_u32 s44, s44, s45
  s_lshl_b32 s45, s3, 4
  s_add_u32 s44, s44, s45
  v_lshlrev_b32 v12, 11, v12
  v_lshl_add_u32 v12, v13, 2, v12
  v_add_u32 v2, s44, v12
  s_mov_b32 s89, 0
L_go_a:
  ds_read_b32 v12, v11
  s_add_u32 s89, s89, 1
  s_cmp_gt_u32 s89, 2000000
  s_cbranch_scc1 L_gone_a
  s_sleep 1
  s_waitcnt lgkmcnt(0)
  v_cmp_ne_u32 vcc, v12, v6
  s_cbranch_vccnz L_go_a
L_gone_a:

  buffer_load_dwordx2 v[8:9], v4, s[76:79], 0 offen offset:0 sc1
  s_waitcnt vmcnt(0)
  s_mov_b32 s89, 0
L_sp0:
  v_cmp_ne_u64 vcc, v[8:9], v[6:7]
  s_cbranch_vccz L_sg0
  buffer_load_dwordx2 v[8:9], v4, s[76:79], 0 offen offset:0 sc1
  s_add_u32 s89, s89, 1
  s_cmp_lt_u32 s89, 2000000
  s_waitcnt vmcnt(0)
  s_cbranch_scc1 L_sp0
L_sg0:

  s_mov_b32 s45, 0
  buffer_load_dwordx4 v[16:19], v88, s[40:43], s45 offen sc1
  buffer_load_dwordx4 v[20:23], v89, s[40:43], s45 offen sc1
  buffer_load_dwordx4 v[24:27], v90, s[40:43], s45 offen sc1
  s_mov_b32 exec_hi, 0x0000ffff
  buffer_load_dwordx4 v[28:31], v91, s[40:43], s45 offen sc1
  s_mov_b32 exec_lo, 0
  s_mov_b32 exec_hi, 0xffff0000
  ds_read_b128 v[28:31], v14 offset:0
  s_mov_b64 exec, -1
  buffer_load_dwordx2 v[8:9], v4, s[76:79], 0 offen offset:128 sc1
  s_waitcnt vmcnt(0) lgkmcnt(0)
  s_mov_b32 s89, 0
L_sp1:
  v_cmp_ne_u64 vcc, v[8:9], v[6:7]
  s_cbranch_vccz L_sg1
  buffer_load_dwordx2 v[8:9], v4, s[76:79], 0 offen offset:128 sc1
  s_add_u32 s89, s89, 1
  s_cmp_lt_u32 s89, 2000000
  s_waitcnt vmcnt(0)
  s_cbranch_scc1 L_sp1
L_sg1:

  s_mov_b32 s45, 16384
  buffer_load_dwordx4 v[32:35], v88, s[40:43], s45 offen sc1
  buffer_load_dwordx4 v[36:39], v89, s[40:43], s45 offen sc1
  buffer_load_dwordx4 v[40:43], v90, s[40:43], s45 offen sc1
  s_mov_b32 exec_hi, 0x0000ffff
  buffer_load_dwordx4 v[44:47], v91, s[40:43], s45 offen sc1
  s_mov_b32 exec_lo, 0
  s_mov_b32 exec_hi, 0xffff0000
  ds_read_b128 v[44:47], v14 offset:2048
  s_mov_b64 exec, -1
  buffer_load_dwordx2 v[8:9], v4, s[76:79], 0 offen offset:256 sc1
  s_add_u32 s50, s6, 0
  s_and_b32 s50, s50, 3
  s_lshl_b32 s50, s50, 8
  v_lshlrev_b32 v80, 16, v16
  v_and_b32 v81, s46, v16
  v_lshlrev_b32 v82, 16, v17
  v_and_b32 v83, s46, v17
  v_lshlrev_b32 v84, 16, v18
  v_and_b32 v85, s46, v18
  v_lshlrev_b32 v86, 16, v19
  v_and_b32 v87, s46, v19
  v_lshlrev_b32 v12, 16, v20
  v_and_b32 v13, s46, v20
  v_add_f32 v80, v12, v80
  v_add_f32 v81, v13, v81
  v_lshlrev_b32 v12, 16, v21
  v_and_b32 v13, s46, v21
  v_add_f32 v82, v12, v82
  v_add_f32 v83, v13, v83
  v_lshlrev_b32 v12, 16, v22
  v_and_b32 v13, s46, v22
  v_add_f32 v84, v12, v84
  v_add_f32 v85, v13, v85
  v_lshlrev_b32 v12, 16, v23
  v_and_b32 v13, s46, v23
  v_add_f32 v86, v12, v86
  v_add_f32 v87, v13, v87
  v_lshlrev_b32 v12, 16, v24
  v_and_b32 v13, s46, v24
  v_add_f32 v80, v12, v80
  v_add_f32 v81, v13, v81
  v_lshlrev_b32 v12, 16, v25
  v_and_b32 v13, s46, v25
  v_add_f32 v82, v12, v82
  v_add_f32 v83, v13, v83
  v_lshlrev_b32 v12, 16, v26
  v_and_b32 v13, s46, v26
  v_add_f32 v84, v12, v84
  v_add_f32 v85, v13, v85
  v_lshlrev_b32 v12, 16, v27
  v_and_b32 v13, s46, v27
  v_add_f32 v86, v12, v86
  v_add_f32 v87, v13, v87
  v_lshlrev_b32 v12, 16, v28
  v_and_b32 v13, s46, v28
  v_add_f32 v80, v12, v80
  v_add_f32 v81, v13, v81
  v_lshlrev_b32 v12, 16, v29
  v_and_b32 v13, s46, v29
  v_add_f32 v82, v12, v82
  v_add_f32 v83, v13, v83
  v_lshlrev_b32 v12, 16, v30
  v_and_b32 v13, s46, v30
  v_add_f32 v84, v12, v84
  v_add_f32 v85, v13, v85
  v_lshlrev_b32 v12, 16, v31
  v_and_b32 v13, s46, v31
  v_add_f32 v86, v12, v86
  v_add_f32 v87, v13, v87
  s_nop 1
  v_permlane32_swap_b32 v80, v84
  v_permlane32_swap_b32 v81, v85
  v_permlane32_swap_b32 v82, v86
  v_permlane32_swap_b32 v83, v87
  v_add_f32 v80, v80, v84
  v_add_f32 v81, v81, v85
  v_add_f32 v82, v82, v86
  v_add_f32 v83, v83, v87
  s_nop 1
  v_permlane16_swap_b32 v80, v82
  v_permlane16_swap_b32 v81, v83
  v_add_f32 v80, v80, v82
  v_add_f32 v81, v81, v83
  v_cvt_pk_bf16_f32 v92, v80, v81
  buffer_store_dword v92, v2, s[84:87], s50 offen
  s_waitcnt vmcnt(1) lgkmcnt(0)
  s_mov_b32 s89, 0
L_sp2:
  v_cmp_ne_u64 vcc, v[8:9], v[6:7]
  s_cbranch_vccz L_sg2
  buffer_load_dwordx2 v[8:9], v4, s[76:79], 0 offen offset:256 sc1
  s_add_u32 s89, s89, 1
  s_cmp_lt_u32 s89, 2000000
  s_waitcnt vmcnt(0)
  s_cbranch_scc1 L_sp2
L_sg2:

  s_mov_b32 s45, 32768
  buffer_load_dwordx4 v[48:51], v88, s[40:43], s45 offen sc1
  buffer_load_dwordx4 v[52:55], v89, s[40:43], s45 offen sc1
  buffer_load_dwordx4 v[56:59], v90, s[40:43], s45 offen sc1
  s_mov_b32 exec_hi, 0x0000ffff
  buffer_load_dwordx4 v[60:63], v91, s[40:43], s45 offen sc1
  s_mov_b32 exec_lo, 0
  s_mov_b32 exec_hi, 0xffff0000
  ds_read_b128 v[60:63], v14 offset:4096
  s_mov_b64 exec, -1
  buffer_load_dwordx2 v[8:9], v4, s[76:79], 0 offen offset:384 sc1
  s_add_u32 s51, s6, 1
  s_and_b32 s51, s51, 3
  s_lshl_b32 s51, s51, 8
  v_lshlrev_b32 v80, 16, v32
  v_and_b32 v81, s46, v32
  v_lshlrev_b32 v82, 16, v33
  v_and_b32 v83, s46, v33
  v_lshlrev_b32 v84, 16, v34
  v_and_b32 v85, s46, v34
  v_lshlrev_b32 v86, 16, v35
  v_and_b32 v87, s46, v35
  v_lshlrev_b32 v12, 16, v36
  v_and_b32 v13, s46, v36
  v_add_f32 v80, v12, v80
  v_add_f32 v81, v13, v81
  v_lshlrev_b32 v12, 16, v37
  v_and_b32 v13, s46, v37
  v_add_f32 v82, v12, v82
  v_add_f32 v83, v13, v83
  v_lshlrev_b32 v12, 16, v38
  v_and_b32 v13, s46, v38
  v_add_f32 v84, v12, v84
  v_add_f32 v85, v13, v85
  v_lshlrev_b32 v12, 16, v39
  v_and_b32 v13, s46, v39
  v_add_f32 v86, v12, v86
  v_add_f32 v87, v13, v87
  v_lshlrev_b32 v12, 16, v40
  v_and_b32 v13, s46, v40
  v_add_f32 v80, v12, v80
  v_add_f32 v81, v13, v81
  v_lshlrev_b32 v12, 16, v41
  v_and_b32 v13, s46, v41
  v_add_f32 v82, v12, v82
  v_add_f32 v83, v13, v83
  v_lshlrev_b32 v12, 16, v42
  v_and_b32 v13, s46, v42
  v_add_f32 v84, v12, v84
  v_add_f32 v85, v13, v85
  v_lshlrev_b32 v12, 16, v43
  v_and_b32 v13, s46, v43
  v_add_f32 v86, v12, v86
  v_add_f32 v87, v13, v87
  v_lshlrev_b32 v12, 16, v44
  v_and_b32 v13, s46, v44
  v_add_f32 v80, v12, v80
  v_add_f32 v81, v13, v81
  v_lshlrev_b32 v12, 16, v45
  v_and_b32 v13, s46, v45
  v_add_f32 v82, v12, v82
  v_add_f32 v83, v13, v83
  v_lshlrev_b32 v12, 16, v46
  v_and_b32 v13, s46, v46
  v_add_f32 v84, v12, v84
  v_add_f32 v85, v13, v85
  v_lshlrev_b32 v12, 16, v47
  v_and_b32 v13, s46, v47
  v_add_f32 v86, v12, v86
  v_add_f32 v87, v13, v87
  s_nop 1
  v_permlane32_swap_b32 v80, v84
  v_permlane32_swap_b32 v81, v85
  v_permlane32_swap_b32 v82, v86
  v_permlane32_swap_b32 v83, v87
  v_add_f32 v80, v80, v84
  v_add_f32 v81, v81, v85
  v_add_f32 v82, v82, v86
  v_add_f32 v83, v83, v87
  s_nop 1
  v_permlane16_swap_b32 v80, v82
  v_permlane16_swap_b32 v81, v83
  v_add_f32 v80, v80, v82
  v_add_f32 v81, v81, v83
  v_cvt_pk_bf16_f32 v93, v80, v81
  buffer_store_dword v93, v2, s[84:87], s51 offen
  s_waitcnt vmcnt(1) lgkmcnt(0)
  s_mov_b32 s89, 0
L_sp3:
  v_cmp_ne_u64 vcc, v[8:9], v[6:7]
  s_cbranch_vccz L_sg3
  buffer_load_dwordx2 v[8:9], v4, s[76:79], 0 offen offset:384 sc1
  s_add_u32 s89, s89, 1
  s_cmp_lt_u32 s89, 2000000
  s_waitcnt vmcnt(0)
  s_cbranch_scc1 L_sp3
L_sg3:

  s_mov_b32 s45, 49152
  buffer_load_dwordx4 v[64:67], v88, s[40:43], s45 offen sc1
  buffer_load_dwordx4 v[68:71], v89, s[40:43], s45 offen sc1
  buffer_load_dwordx4 v[72:75], v90, s[40:43], s45 offen sc1
  s_mov_b32 exec_hi, 0x0000ffff
  buffer_load_dwordx4 v[76:79], v91, s[40:43], s45 offen sc1
  s_mov_b32 exec_lo, 0
  s_mov_b32 exec_hi, 0xffff0000
  ds_read_b128 v[76:79], v14 offset:6144
  s_mov_b64 exec, -1
  s_add_u32 s52, s6, 2
  s_and_b32 s52, s52, 3
  s_lshl_b32 s52, s52, 8
  v_lshlrev_b32 v80, 16, v48
  v_and_b32 v81, s46, v48
  v_lshlrev_b32 v82, 16, v49
  v_and_b32 v83, s46, v49
  v_lshlrev_b32 v84, 16, v50
  v_and_b32 v85, s46, v50
  v_lshlrev_b32 v86, 16, v51
  v_and_b32 v87, s46, v51
  v_lshlrev_b32 v12, 16, v52
  v_and_b32 v13, s46, v52
  v_add_f32 v80, v12, v80
  v_add_f32 v81, v13, v81
  v_lshlrev_b32 v12, 16, v53
  v_and_b32 v13, s46, v53
  v_add_f32 v82, v12, v82
  v_add_f32 v83, v13, v83
  v_lshlrev_b32 v12, 16, v54
  v_and_b32 v13, s46, v54
  v_add_f32 v84, v12, v84
  v_add_f32 v85, v13, v85
  v_lshlrev_b32 v12, 16, v55
  v_and_b32 v13, s46, v55
  v_add_f32 v86, v12, v86
  v_add_f32 v87, v13, v87
  v_lshlrev_b32 v12, 16, v56
  v_and_b32 v13, s46, v56
  v_add_f32 v80, v12, v80
  v_add_f32 v81, v13, v81
  v_lshlrev_b32 v12, 16, v57
  v_and_b32 v13, s46, v57
  v_add_f32 v82, v12, v82
  v_add_f32 v83, v13, v83
  v_lshlrev_b32 v12, 16, v58
  v_and_b32 v13, s46, v58
  v_add_f32 v84, v12, v84
  v_add_f32 v85, v13, v85
  v_lshlrev_b32 v12, 16, v59
  v_and_b32 v13, s46, v59
  v_add_f32 v86, v12, v86
  v_add_f32 v87, v13, v87
  v_lshlrev_b32 v12, 16, v60
  v_and_b32 v13, s46, v60
  v_add_f32 v80, v12, v80
  v_add_f32 v81, v13, v81
  v_lshlrev_b32 v12, 16, v61
  v_and_b32 v13, s46, v61
  v_add_f32 v82, v12, v82
  v_add_f32 v83, v13, v83
  v_lshlrev_b32 v12, 16, v62
  v_and_b32 v13, s46, v62
  v_add_f32 v84, v12, v84
  v_add_f32 v85, v13, v85
  v_lshlrev_b32 v12, 16, v63
  v_and_b32 v13, s46, v63
  v_add_f32 v86, v12, v86
  v_add_f32 v87, v13, v87
  s_nop 1
  v_permlane32_swap_b32 v80, v84
  v_permlane32_swap_b32 v81, v85
  v_permlane32_swap_b32 v82, v86
  v_permlane32_swap_b32 v83, v87
  v_add_f32 v80, v80, v84
  v_add_f32 v81, v81, v85
  v_add_f32 v82, v82, v86
  v_add_f32 v83, v83, v87
  s_nop 1
  v_permlane16_swap_b32 v80, v82
  v_permlane16_swap_b32 v81, v83
  v_add_f32 v80, v80, v82
  v_add_f32 v81, v81, v83
  v_cvt_pk_bf16_f32 v94, v80, v81
  buffer_store_dword v94, v2, s[84:87], s52 offen
  s_add_u32 s53, s6, 3
  s_and_b32 s53, s53, 3
  s_lshl_b32 s53, s53, 8
  s_waitcnt vmcnt(4)
  v_lshlrev_b32 v80, 16, v64
  v_and_b32 v81, s46, v64
  v_lshlrev_b32 v82, 16, v65
  v_and_b32 v83, s46, v65
  v_lshlrev_b32 v84, 16, v66
  v_and_b32 v85, s46, v66
  v_lshlrev_b32 v86, 16, v67
  v_and_b32 v87, s46, v67
  s_waitcnt vmcnt(3)
  v_lshlrev_b32 v12, 16, v68
  v_and_b32 v13, s46, v68
  v_add_f32 v80, v12, v80
  v_add_f32 v81, v13, v81
  v_lshlrev_b32 v12, 16, v69
  v_and_b32 v13, s46, v69
  v_add_f32 v82, v12, v82
  v_add_f32 v83, v13, v83
  v_lshlrev_b32 v12, 16, v70
  v_and_b32 v13, s46, v70
  v_add_f32 v84, v12, v84
  v_add_f32 v85, v13, v85
  v_lshlrev_b32 v12, 16, v71
  v_and_b32 v13, s46, v71
  v_add_f32 v86, v12, v86
  v_add_f32 v87, v13, v87
  s_waitcnt vmcnt(2)
  v_lshlrev_b32 v12, 16, v72
  v_and_b32 v13, s46, v72
  v_add_f32 v80, v12, v80
  v_add_f32 v81, v13, v81
  v_lshlrev_b32 v12, 16, v73
  v_and_b32 v13, s46, v73
  v_add_f32 v82, v12, v82
  v_add_f32 v83, v13, v83
  v_lshlrev_b32 v12, 16, v74
  v_and_b32 v13, s46, v74
  v_add_f32 v84, v12, v84
  v_add_f32 v85, v13, v85
  v_lshlrev_b32 v12, 16, v75
  v_and_b32 v13, s46, v75
  v_add_f32 v86, v12, v86
  v_add_f32 v87, v13, v87
  s_waitcnt vmcnt(1) lgkmcnt(0)
  v_lshlrev_b32 v12, 16, v76
  v_and_b32 v13, s46, v76
  v_add_f32 v80, v12, v80
  v_add_f32 v81, v13, v81
  v_lshlrev_b32 v12, 16, v77
  v_and_b32 v13, s46, v77
  v_add_f32 v82, v12, v82
  v_add_f32 v83, v13, v83
  v_lshlrev_b32 v12, 16, v78
  v_and_b32 v13, s46, v78
  v_add_f32 v84, v12, v84
  v_add_f32 v85, v13, v85
  v_lshlrev_b32 v12, 16, v79
  v_and_b32 v13, s46, v79
  v_add_f32 v86, v12, v86
  v_add_f32 v87, v13, v87
  s_nop 1
  v_permlane32_swap_b32 v80, v84
  v_permlane32_swap_b32 v81, v85
  v_permlane32_swap_b32 v82, v86
  v_permlane32_swap_b32 v83, v87
  v_add_f32 v80, v80, v84
  v_add_f32 v81, v81, v85
  v_add_f32 v82, v82, v86
  v_add_f32 v83, v83, v87
  s_nop 1
  v_permlane16_swap_b32 v80, v82
  v_permlane16_swap_b32 v81, v83
  v_add_f32 v80, v80, v82
  v_add_f32 v81, v81, v83
  v_cvt_pk_bf16_f32 v95, v80, v81

  buffer_store_dword v95, v2, s[84:87], s53 offen
  s_or_b32 s44, s7, s3
  s_cmp_lg_u32 s44, 0
  s_cbranch_scc1 L_noep
  v_mov_b32 v12, 0
  global_store_dword v12, v6, s[80:81]
L_noep:
L_ld_done:
  s_endpgm
.p2align 12
L_compute:
  v_and_b32 v14, 63, v0
  s_waitcnt lgkmcnt(0)
  s_lshl_b32 s16, s17, 3
  s_add_u32 s16, s16, s6
  s_lshl_b32 s18, s16, 8
  s_add_u32 s18, s18, 0x1040000
  s_add_u32 s80, s74, s18
  s_addc_u32 s81, s75, 0
  s_load_dword s82, s[80:81], 0
  s_lshl_b32 s10, s6, 3
  s_add_u32 s10, s10, s91
  s_lshl_b32 s10, s10, 17
  s_lshl_b32 s13, s7, 18
  s_lshl_b32 s14, s16, 20

  s_lshl_b32 s88, s7, 16
  s_lshl_b32 s15, s16, 13
  s_add_u32 s15, s15, 0x1000000
  s_lshl_b32 s90, s17, 10
  s_lshl_b32 s19, s6, 17
  s_add_u32 s19, s19, s90
  s_add_u32 s24, s66, s10
  s_addc_u32 s25, s67, 0
  s_mov_b32 s26, 0x20000
  s_mov_b32 s27, 0x20000
  s_add_u32 s28, s68, s10
  s_addc_u32 s29, s69, 0
  s_mov_b32 s30, 0x20000
  s_mov_b32 s31, 0x20000
  s_add_u32 s36, s72, s13
  s_addc_u32 s37, s73, 0
  s_mov_b32 s38, 0x40000
  s_mov_b32 s39, 0x20000
  s_add_u32 s40, s74, s14
  s_addc_u32 s41, s75, 0
  s_mov_b32 s42, 0x100000
  s_mov_b32 s43, 0x20000
  s_add_u32 s76, s74, s15
  s_addc_u32 s77, s75, 0
  s_mov_b32 s78, 0x2000
  s_mov_b32 s79, 0x20000
  s_add_u32 s84, s92, s19
  s_addc_u32 s85, s93, 0
  s_sub_u32 s86, 0x20000, s90
  s_mov_b32 s87, 0x20000
  s_getpc_b64 s[94:95]
  s_lshr_b32 s44, s2, 3
  s_lshl_b32 s44, s44, 2
  s_add_u32 s44, s44, s3
  s_lshl_b32 s44, s44, 7
  s_load_dword s96, s[94:95], s44
  s_lshr_b32 s44, s44, 2
  s_add_u32 s44, s44, 0x4000
  s_load_dword s97, s[94:95], s44
  v_lshrrev_b32 v18, 5, v14
  v_bfe_u32 v19, v14, 2, 2
  v_xor_b32 v20, v18, v19
  v_lshlrev_b32 v20, 4, v20
  v_and_b32 v21, 3, v14
  v_lshl_add_u32 v20, v21, 6, v20
  v_bfe_u32 v22, v14, 2, 3
  v_lshl_add_u32 v5, v22, 10, v20

  v_bfe_u32 v22, v14, 4, 1
  v_lshlrev_b32 v22, 5, v22
  v_lshl_add_u32 v22, v19, 6, v22
  v_lshl_add_u32 v23, v21, 3, v22
  v_lshl_add_u32 v7, v18, 10, v23
  v_and_b32 v23, 1, v21
  v_lshrrev_b32 v24, 1, v21
  v_lshl_add_u32 v23, v23, 1, v24
  v_lshl_add_u32 v23, v23, 3, v22

  s_lshl_b32 s44, s3, 8
  v_lshl_add_u32 v24, v18, 10, v23
  v_add_u32 v8, s44, v24
  s_mul_i32 s44, s3, 40960
  s_add_u32 s44, s44, 32768
  v_lshlrev_b32 v24, 4, v14
  v_add_u32 v9, s44, v24
  s_mov_b32 s44, 0
  s_mul_i32 s44, s44, 81920
  s_add_u32 s44, s44, 32768
  v_add_u32 v10, s44, v24
  s_lshl_b32 s44, s3, 12
  v_add_u32 v11, s44, v24
  s_mov_b32 s54, 0x4b800000
  s_mov_b32 s55, 0x3e0293ee
  v_lshrrev_b32 v18, 4, v14
  v_bfe_u32 v19, v14, 2, 1
  v_lshlrev_b32 v20, 1, v19
  v_xor_b32 v20, v18, v20
  v_lshlrev_b32 v20, 4, v20
  v_lshl_add_u32 v20, v21, 6, v20
  v_lshl_add_u32 v20, v19, 8, v20
  v_bfe_u32 v22, v14, 3, 1
  v_lshl_add_u32 v20, v22, 10, v20
  s_and_b32 s44, s3, 1
  s_lshl_b32 s44, s44, 12
  s_add_u32 s44, s44, 32768
  v_add_u32 v4, s44, v20
  v_bfe_u32 v19, v14, 2, 2
  v_lshlrev_b32 v20, 6, v19
  v_lshl_add_u32 v20, v21, 3, v20
  v_lshl_add_u32 v20, v18, 11, v20
  v_and_b32 v22, 1, v18
  v_lshl_add_u32 v20, v22, 5, v20
  s_lshr_b32 s44, s3, 1
  s_lshl_b32 s44, s44, 14
  v_add_u32 v6, s44, v20
  s_waitcnt lgkmcnt(0)
  s_mul_i32 s82, s82, 1664525
  s_add_u32 s82, s82, 1013904223
  s_mov_b64 exec, 0
  s_cmp_eq_u32 s3, 0
  s_cbranch_scc1 L_stub0
  s_cmp_eq_u32 s3, 1
  s_cbranch_scc1 L_stub1
  s_cmp_eq_u32 s3, 2
  s_cbranch_scc1 L_stub2
  s_cmp_eq_u32 s3, 3
  s_cbranch_scc1 L_stub3
L_warm_ret:
  s_mov_b64 exec, -1
  s_barrier
  v_add_u32 v1, 0, v4
  v_add_u32 v3, 0, v6
  v_xor_b32 v2, 32, v3
  ds_read_b128 v[48:51], v1 offset:0
  ds_read_b128 v[52:55], v1 offset:2048
  ds_read_b64_tr_b16 v[16:17], v3 offset:0
  ds_read_b64_tr_b16 v[18:19], v3 offset:1024
  ds_read_b64_tr_b16 v[20:21], v2 offset:0
  ds_read_b64_tr_b16 v[22:23], v2 offset:1024
  ds_read_b64_tr_b16 v[24:25], v3 offset:256
  ds_read_b64_tr_b16 v[26:27], v3 offset:1280
  ds_read_b64_tr_b16 v[28:29], v2 offset:256
  ds_read_b64_tr_b16 v[30:31], v2 offset:1280
  ds_read_b64_tr_b16 v[32:33], v3 offset:512
  ds_read_b64_tr_b16 v[34:35], v3 offset:1536
  ds_read_b64_tr_b16 v[36:37], v2 offset:512
  ds_read_b64_tr_b16 v[38:39], v2 offset:1536
  ds_read_b64_tr_b16 v[40:41], v3 offset:768
  s_waitcnt lgkmcnt(11)
  ds_read_b64_tr_b16 v[42:43], v3 offset:1792
  v_mfma_f32_16x16x32_bf16 v[64:67], v[16:19], v[48:51], 0
  s_waitcnt lgkmcnt(10)
  ds_read_b64_tr_b16 v[44:45], v2 offset:768
  ds_read_b64_tr_b16 v[46:47], v2 offset:1792
  v_mfma_f32_16x16x32_bf16 v[68:71], v[16:19], v[52:55], 0
  v_mfma_f32_16x16x32_bf16 v[72:75], v[20:23], v[48:51], 0
  s_waitcnt lgkmcnt(10)
  v_mfma_f32_16x16x32_bf16 v[76:79], v[20:23], v[52:55], 0
  v_mfma_f32_16x16x32_bf16 v[80:83], v[24:27], v[48:51], 0
  s_waitcnt lgkmcnt(6)
  ds_read_b128 v[56:59], v1 offset:512
  ds_read_b128 v[60:63], v1 offset:2560
  ds_read_b64_tr_b16 v[16:17], v3 offset:8192
  ds_read_b64_tr_b16 v[18:19], v3 offset:9216
  v_mfma_f32_16x16x32_bf16 v[84:87], v[24:27], v[52:55], 0
  v_mfma_f32_16x16x32_bf16 v[88:91], v[28:31], v[48:51], 0
  s_waitcnt lgkmcnt(8)
  ds_read_b64_tr_b16 v[20:21], v2 offset:8192
  ds_read_b64_tr_b16 v[22:23], v2 offset:9216
  ds_read_b64_tr_b16 v[24:25], v3 offset:8448
  ds_read_b64_tr_b16 v[26:27], v3 offset:9472
  v_mfma_f32_16x16x32_bf16 v[92:95], v[28:31], v[52:55], 0
  v_mfma_f32_16x16x32_bf16 v[96:99], v[32:35], v[48:51], 0
  s_waitcnt lgkmcnt(10)
  ds_read_b64_tr_b16 v[28:29], v2 offset:8448
  ds_read_b64_tr_b16 v[30:31], v2 offset:9472
  v_mfma_f32_16x16x32_bf16 v[100:103], v[32:35], v[52:55], 0
  v_mfma_f32_16x16x32_bf16 v[104:107], v[36:39], v[48:51], 0
  s_waitcnt lgkmcnt(10)
  ds_read_b64_tr_b16 v[32:33], v3 offset:8704
  ds_read_b64_tr_b16 v[34:35], v3 offset:9728
  v_mfma_f32_16x16x32_bf16 v[108:111], v[36:39], v[52:55], 0
  v_mfma_f32_16x16x32_bf16 v[112:115], v[40:43], v[48:51], 0
  s_waitcnt lgkmcnt(8)
  ds_read_b64_tr_b16 v[36:37], v2 offset:8704
  ds_read_b64_tr_b16 v[38:39], v2 offset:9728
  v_mfma_f32_16x16x32_bf16 v[116:119], v[40:43], v[52:55], 0
  v_mfma_f32_16x16x32_bf16 v[120:123], v[44:47], v[48:51], 0
  s_waitcnt lgkmcnt(8)
  ds_read_b64_tr_b16 v[40:41], v3 offset:8960
  ds_read_b64_tr_b16 v[42:43], v3 offset:9984
  v_mfma_f32_16x16x32_bf16 v[124:127], v[44:47], v[52:55], 0
  v_mfma_f32_16x16x32_bf16 v[64:67], v[16:19], v[56:59], v[64:67]
  s_waitcnt lgkmcnt(8)
  ds_read_b64_tr_b16 v[44:45], v2 offset:8960
  ds_read_b64_tr_b16 v[46:47], v2 offset:9984
  v_mfma_f32_16x16x32_bf16 v[68:71], v[16:19], v[60:63], v[68:71]
  v_mfma_f32_16x16x32_bf16 v[72:75], v[20:23], v[56:59], v[72:75]
  s_waitcnt lgkmcnt(8)
  v_add_u32 v1, 40960, v4
  v_mfma_f32_16x16x32_bf16 v[76:79], v[20:23], v[60:63], v[76:79]
  v_mfma_f32_16x16x32_bf16 v[80:83], v[24:27], v[56:59], v[80:83]
  s_waitcnt lgkmcnt(6)
  v_add_u32 v3, 40960, v6
  v_mfma_f32_16x16x32_bf16 v[84:87], v[24:27], v[60:63], v[84:87]
  v_mfma_f32_16x16x32_bf16 v[88:91], v[28:31], v[56:59], v[88:91]
  s_waitcnt lgkmcnt(4)
  v_xor_b32 v2, 32, v3
  v_mfma_f32_16x16x32_bf16 v[92:95], v[28:31], v[60:63], v[92:95]
  v_mfma_f32_16x16x32_bf16 v[96:99], v[32:35], v[56:59], v[96:99]
  s_waitcnt lgkmcnt(0)
  s_barrier
  ds_read_b128 v[48:51], v1 offset:0
  ds_read_b128 v[52:55], v1 offset:2048
  v_mfma_f32_16x16x32_bf16 v[100:103], v[32:35], v[60:63], v[100:103]
  v_mfma_f32_16x16x32_bf16 v[104:107], v[36:39], v[56:59], v[104:107]
  ds_read_b64_tr_b16 v[16:17], v3 offset:0
  ds_read_b64_tr_b16 v[18:19], v3 offset:1024
  ds_read_b64_tr_b16 v[20:21], v2 offset:0
  ds_read_b64_tr_b16 v[22:23], v2 offset:1024
  v_mfma_f32_16x16x32_bf16 v[108:111], v[36:39], v[60:63], v[108:111]
  v_mfma_f32_16x16x32_bf16 v[112:115], v[40:43], v[56:59], v[112:115]
  ds_read_b64_tr_b16 v[24:25], v3 offset:256
  ds_read_b64_tr_b16 v[26:27], v3 offset:1280
  ds_read_b64_tr_b16 v[28:29], v2 offset:256
  ds_read_b64_tr_b16 v[30:31], v2 offset:1280
  v_mfma_f32_16x16x32_bf16 v[116:119], v[40:43], v[60:63], v[116:119]
  v_mfma_f32_16x16x32_bf16 v[120:123], v[44:47], v[56:59], v[120:123]
  s_waitcnt lgkmcnt(6)
  ds_read_b64_tr_b16 v[32:33], v3 offset:512
  ds_read_b64_tr_b16 v[34:35], v3 offset:1536
  ds_read_b64_tr_b16 v[36:37], v2 offset:512
  ds_read_b64_tr_b16 v[38:39], v2 offset:1536
  v_mfma_f32_16x16x32_bf16 v[124:127], v[44:47], v[60:63], v[124:127]
  v_mfma_f32_16x16x32_bf16 v[64:67], v[16:19], v[48:51], v[64:67]
  s_waitcnt lgkmcnt(8)
  ds_read_b64_tr_b16 v[40:41], v3 offset:768
  ds_read_b64_tr_b16 v[42:43], v3 offset:1792
  ds_read_b64_tr_b16 v[44:45], v2 offset:768
  ds_read_b64_tr_b16 v[46:47], v2 offset:1792
  v_mfma_f32_16x16x32_bf16 v[68:71], v[16:19], v[52:55], v[68:71]
  v_mfma_f32_16x16x32_bf16 v[72:75], v[20:23], v[48:51], v[72:75]
  s_waitcnt lgkmcnt(8)
  v_mfma_f32_16x16x32_bf16 v[76:79], v[20:23], v[52:55], v[76:79]
  v_mfma_f32_16x16x32_bf16 v[80:83], v[24:27], v[48:51], v[80:83]
  s_waitcnt lgkmcnt(6)
  ds_read_b128 v[56:59], v1 offset:512
  ds_read_b128 v[60:63], v1 offset:2560
  ds_read_b64_tr_b16 v[16:17], v3 offset:8192
  ds_read_b64_tr_b16 v[18:19], v3 offset:9216
  v_mfma_f32_16x16x32_bf16 v[84:87], v[24:27], v[52:55], v[84:87]
  v_mfma_f32_16x16x32_bf16 v[88:91], v[28:31], v[48:51], v[88:91]
  s_waitcnt lgkmcnt(8)
  ds_read_b64_tr_b16 v[20:21], v2 offset:8192
  ds_read_b64_tr_b16 v[22:23], v2 offset:9216
  ds_read_b64_tr_b16 v[24:25], v3 offset:8448
  ds_read_b64_tr_b16 v[26:27], v3 offset:9472
  v_mfma_f32_16x16x32_bf16 v[92:95], v[28:31], v[52:55], v[92:95]
  v_mfma_f32_16x16x32_bf16 v[96:99], v[32:35], v[48:51], v[96:99]
  s_waitcnt lgkmcnt(10)
  ds_read_b64_tr_b16 v[28:29], v2 offset:8448
  ds_read_b64_tr_b16 v[30:31], v2 offset:9472
  v_mfma_f32_16x16x32_bf16 v[100:103], v[32:35], v[52:55], v[100:103]
  v_mfma_f32_16x16x32_bf16 v[104:107], v[36:39], v[48:51], v[104:107]
  s_waitcnt lgkmcnt(10)
  ds_read_b64_tr_b16 v[32:33], v3 offset:8704
  ds_read_b64_tr_b16 v[34:35], v3 offset:9728
  v_mfma_f32_16x16x32_bf16 v[108:111], v[36:39], v[52:55], v[108:111]
  v_mfma_f32_16x16x32_bf16 v[112:115], v[40:43], v[48:51], v[112:115]
  s_waitcnt lgkmcnt(8)
  ds_read_b64_tr_b16 v[36:37], v2 offset:8704
  ds_read_b64_tr_b16 v[38:39], v2 offset:9728
  v_mfma_f32_16x16x32_bf16 v[116:119], v[40:43], v[52:55], v[116:119]
  v_mfma_f32_16x16x32_bf16 v[120:123], v[44:47], v[48:51], v[120:123]
  s_waitcnt lgkmcnt(8)
  ds_read_b64_tr_b16 v[40:41], v3 offset:8960
  ds_read_b64_tr_b16 v[42:43], v3 offset:9984
  v_mfma_f32_16x16x32_bf16 v[124:127], v[44:47], v[52:55], v[124:127]
  v_mfma_f32_16x16x32_bf16 v[64:67], v[16:19], v[56:59], v[64:67]
  s_waitcnt lgkmcnt(8)
  ds_read_b64_tr_b16 v[44:45], v2 offset:8960
  ds_read_b64_tr_b16 v[46:47], v2 offset:9984
  v_mfma_f32_16x16x32_bf16 v[68:71], v[16:19], v[60:63], v[68:71]
  v_mfma_f32_16x16x32_bf16 v[72:75], v[20:23], v[56:59], v[72:75]
  s_waitcnt lgkmcnt(8)
  v_add_u32 v1, 81920, v4
  v_mfma_f32_16x16x32_bf16 v[76:79], v[20:23], v[60:63], v[76:79]
  v_mfma_f32_16x16x32_bf16 v[80:83], v[24:27], v[56:59], v[80:83]
  s_waitcnt lgkmcnt(6)
  v_add_u32 v3, 81920, v6
  v_mfma_f32_16x16x32_bf16 v[84:87], v[24:27], v[60:63], v[84:87]
  v_mfma_f32_16x16x32_bf16 v[88:91], v[28:31], v[56:59], v[88:91]
  s_waitcnt lgkmcnt(4)
  v_xor_b32 v2, 32, v3
  v_mfma_f32_16x16x32_bf16 v[92:95], v[28:31], v[60:63], v[92:95]
  v_mfma_f32_16x16x32_bf16 v[96:99], v[32:35], v[56:59], v[96:99]
  s_waitcnt lgkmcnt(0)
  s_barrier
  ds_read_b128 v[48:51], v1 offset:0
  ds_read_b128 v[52:55], v1 offset:2048
  v_mfma_f32_16x16x32_bf16 v[100:103], v[32:35], v[60:63], v[100:103]
  v_mfma_f32_16x16x32_bf16 v[104:107], v[36:39], v[56:59], v[104:107]
  ds_read_b64_tr_b16 v[16:17], v3 offset:0
  ds_read_b64_tr_b16 v[18:19], v3 offset:1024
  ds_read_b64_tr_b16 v[20:21], v2 offset:0
  ds_read_b64_tr_b16 v[22:23], v2 offset:1024
  v_mfma_f32_16x16x32_bf16 v[108:111], v[36:39], v[60:63], v[108:111]
  v_mfma_f32_16x16x32_bf16 v[112:115], v[40:43], v[56:59], v[112:115]
  ds_read_b64_tr_b16 v[24:25], v3 offset:256
  ds_read_b64_tr_b16 v[26:27], v3 offset:1280
  ds_read_b64_tr_b16 v[28:29], v2 offset:256
  ds_read_b64_tr_b16 v[30:31], v2 offset:1280
  v_mfma_f32_16x16x32_bf16 v[116:119], v[40:43], v[60:63], v[116:119]
  v_mfma_f32_16x16x32_bf16 v[120:123], v[44:47], v[56:59], v[120:123]
  s_waitcnt lgkmcnt(6)
  ds_read_b64_tr_b16 v[32:33], v3 offset:512
  ds_read_b64_tr_b16 v[34:35], v3 offset:1536
  ds_read_b64_tr_b16 v[36:37], v2 offset:512
  ds_read_b64_tr_b16 v[38:39], v2 offset:1536
  v_mfma_f32_16x16x32_bf16 v[124:127], v[44:47], v[60:63], v[124:127]
  v_mfma_f32_16x16x32_bf16 v[64:67], v[16:19], v[48:51], v[64:67]
  s_waitcnt lgkmcnt(8)
  ds_read_b64_tr_b16 v[40:41], v3 offset:768
  ds_read_b64_tr_b16 v[42:43], v3 offset:1792
  ds_read_b64_tr_b16 v[44:45], v2 offset:768
  ds_read_b64_tr_b16 v[46:47], v2 offset:1792
  v_mfma_f32_16x16x32_bf16 v[68:71], v[16:19], v[52:55], v[68:71]
  v_mfma_f32_16x16x32_bf16 v[72:75], v[20:23], v[48:51], v[72:75]
  s_waitcnt lgkmcnt(8)
  v_mfma_f32_16x16x32_bf16 v[76:79], v[20:23], v[52:55], v[76:79]
  v_mfma_f32_16x16x32_bf16 v[80:83], v[24:27], v[48:51], v[80:83]
  s_waitcnt lgkmcnt(6)
  ds_read_b128 v[56:59], v1 offset:512
  ds_read_b128 v[60:63], v1 offset:2560
  ds_read_b64_tr_b16 v[16:17], v3 offset:8192
  ds_read_b64_tr_b16 v[18:19], v3 offset:9216
  v_mfma_f32_16x16x32_bf16 v[84:87], v[24:27], v[52:55], v[84:87]
  v_mfma_f32_16x16x32_bf16 v[88:91], v[28:31], v[48:51], v[88:91]
  s_waitcnt lgkmcnt(8)
  ds_read_b64_tr_b16 v[20:21], v2 offset:8192
  ds_read_b64_tr_b16 v[22:23], v2 offset:9216
  ds_read_b64_tr_b16 v[24:25], v3 offset:8448
  ds_read_b64_tr_b16 v[26:27], v3 offset:9472
  v_mfma_f32_16x16x32_bf16 v[92:95], v[28:31], v[52:55], v[92:95]
  v_mfma_f32_16x16x32_bf16 v[96:99], v[32:35], v[48:51], v[96:99]
  s_waitcnt lgkmcnt(10)
  ds_read_b64_tr_b16 v[28:29], v2 offset:8448
  ds_read_b64_tr_b16 v[30:31], v2 offset:9472
  v_mfma_f32_16x16x32_bf16 v[100:103], v[32:35], v[52:55], v[100:103]
  v_mfma_f32_16x16x32_bf16 v[104:107], v[36:39], v[48:51], v[104:107]
  s_waitcnt lgkmcnt(10)
  ds_read_b64_tr_b16 v[32:33], v3 offset:8704
  ds_read_b64_tr_b16 v[34:35], v3 offset:9728
  v_mfma_f32_16x16x32_bf16 v[108:111], v[36:39], v[52:55], v[108:111]
  v_mfma_f32_16x16x32_bf16 v[112:115], v[40:43], v[48:51], v[112:115]
  s_waitcnt lgkmcnt(8)
  ds_read_b64_tr_b16 v[36:37], v2 offset:8704
  ds_read_b64_tr_b16 v[38:39], v2 offset:9728
  v_mfma_f32_16x16x32_bf16 v[116:119], v[40:43], v[52:55], v[116:119]
  v_mfma_f32_16x16x32_bf16 v[120:123], v[44:47], v[48:51], v[120:123]
  s_waitcnt lgkmcnt(8)
  ds_read_b64_tr_b16 v[40:41], v3 offset:8960
  ds_read_b64_tr_b16 v[42:43], v3 offset:9984
  v_mfma_f32_16x16x32_bf16 v[124:127], v[44:47], v[52:55], v[124:127]
  v_mfma_f32_16x16x32_bf16 v[64:67], v[16:19], v[56:59], v[64:67]
  s_waitcnt lgkmcnt(8)
  ds_read_b64_tr_b16 v[44:45], v2 offset:8960
  ds_read_b64_tr_b16 v[46:47], v2 offset:9984
  v_mfma_f32_16x16x32_bf16 v[68:71], v[16:19], v[60:63], v[68:71]
  v_mfma_f32_16x16x32_bf16 v[72:75], v[20:23], v[56:59], v[72:75]
  s_waitcnt lgkmcnt(8)
  v_add_u32 v1, 122880, v4
  v_mfma_f32_16x16x32_bf16 v[76:79], v[20:23], v[60:63], v[76:79]
  v_mfma_f32_16x16x32_bf16 v[80:83], v[24:27], v[56:59], v[80:83]
  s_waitcnt lgkmcnt(6)
  v_add_u32 v3, 122880, v6
  v_mfma_f32_16x16x32_bf16 v[84:87], v[24:27], v[60:63], v[84:87]
  v_mfma_f32_16x16x32_bf16 v[88:91], v[28:31], v[56:59], v[88:91]
  s_waitcnt lgkmcnt(4)
  v_xor_b32 v2, 32, v3
  v_mfma_f32_16x16x32_bf16 v[92:95], v[28:31], v[60:63], v[92:95]
  v_mfma_f32_16x16x32_bf16 v[96:99], v[32:35], v[56:59], v[96:99]
  s_waitcnt lgkmcnt(0)
  s_barrier
  ds_read_b128 v[48:51], v1 offset:0
  ds_read_b128 v[52:55], v1 offset:2048
  v_mfma_f32_16x16x32_bf16 v[100:103], v[32:35], v[60:63], v[100:103]
  v_mfma_f32_16x16x32_bf16 v[104:107], v[36:39], v[56:59], v[104:107]
  ds_read_b64_tr_b16 v[16:17], v3 offset:0
  ds_read_b64_tr_b16 v[18:19], v3 offset:1024
  ds_read_b64_tr_b16 v[20:21], v2 offset:0
  ds_read_b64_tr_b16 v[22:23], v2 offset:1024
  v_mfma_f32_16x16x32_bf16 v[108:111], v[36:39], v[60:63], v[108:111]
  v_mfma_f32_16x16x32_bf16 v[112:115], v[40:43], v[56:59], v[112:115]
  ds_read_b64_tr_b16 v[24:25], v3 offset:256
  ds_read_b64_tr_b16 v[26:27], v3 offset:1280
  ds_read_b64_tr_b16 v[28:29], v2 offset:256
  ds_read_b64_tr_b16 v[30:31], v2 offset:1280
  v_mfma_f32_16x16x32_bf16 v[116:119], v[40:43], v[60:63], v[116:119]
  v_mfma_f32_16x16x32_bf16 v[120:123], v[44:47], v[56:59], v[120:123]
  s_waitcnt lgkmcnt(6)
  ds_read_b64_tr_b16 v[32:33], v3 offset:512
  ds_read_b64_tr_b16 v[34:35], v3 offset:1536
  ds_read_b64_tr_b16 v[36:37], v2 offset:512
  ds_read_b64_tr_b16 v[38:39], v2 offset:1536
  v_mfma_f32_16x16x32_bf16 v[124:127], v[44:47], v[60:63], v[124:127]
  v_mfma_f32_16x16x32_bf16 v[64:67], v[16:19], v[48:51], v[64:67]
  s_waitcnt lgkmcnt(8)
  ds_read_b64_tr_b16 v[40:41], v3 offset:768
  ds_read_b64_tr_b16 v[42:43], v3 offset:1792
  ds_read_b64_tr_b16 v[44:45], v2 offset:768
  ds_read_b64_tr_b16 v[46:47], v2 offset:1792
  v_mfma_f32_16x16x32_bf16 v[68:71], v[16:19], v[52:55], v[68:71]
  v_mfma_f32_16x16x32_bf16 v[72:75], v[20:23], v[48:51], v[72:75]
  s_waitcnt lgkmcnt(8)
  v_mfma_f32_16x16x32_bf16 v[76:79], v[20:23], v[52:55], v[76:79]
  v_mfma_f32_16x16x32_bf16 v[80:83], v[24:27], v[48:51], v[80:83]
  s_waitcnt lgkmcnt(6)
  ds_read_b128 v[56:59], v1 offset:512
  ds_read_b128 v[60:63], v1 offset:2560
  ds_read_b64_tr_b16 v[16:17], v3 offset:8192
  ds_read_b64_tr_b16 v[18:19], v3 offset:9216
  v_mfma_f32_16x16x32_bf16 v[84:87], v[24:27], v[52:55], v[84:87]
  v_mfma_f32_16x16x32_bf16 v[88:91], v[28:31], v[48:51], v[88:91]
  s_waitcnt lgkmcnt(8)
  ds_read_b64_tr_b16 v[20:21], v2 offset:8192
  ds_read_b64_tr_b16 v[22:23], v2 offset:9216
  ds_read_b64_tr_b16 v[24:25], v3 offset:8448
  ds_read_b64_tr_b16 v[26:27], v3 offset:9472
  v_mfma_f32_16x16x32_bf16 v[92:95], v[28:31], v[52:55], v[92:95]
  v_mfma_f32_16x16x32_bf16 v[96:99], v[32:35], v[48:51], v[96:99]
  s_waitcnt lgkmcnt(10)
  ds_read_b64_tr_b16 v[28:29], v2 offset:8448
  ds_read_b64_tr_b16 v[30:31], v2 offset:9472
  v_mfma_f32_16x16x32_bf16 v[100:103], v[32:35], v[52:55], v[100:103]
  v_mfma_f32_16x16x32_bf16 v[104:107], v[36:39], v[48:51], v[104:107]
  s_waitcnt lgkmcnt(10)
  ds_read_b64_tr_b16 v[32:33], v3 offset:8704
  ds_read_b64_tr_b16 v[34:35], v3 offset:9728
  v_mfma_f32_16x16x32_bf16 v[108:111], v[36:39], v[52:55], v[108:111]
  v_mfma_f32_16x16x32_bf16 v[112:115], v[40:43], v[48:51], v[112:115]
  s_waitcnt lgkmcnt(8)
  ds_read_b64_tr_b16 v[36:37], v2 offset:8704
  ds_read_b64_tr_b16 v[38:39], v2 offset:9728
  v_mfma_f32_16x16x32_bf16 v[116:119], v[40:43], v[52:55], v[116:119]
  v_mfma_f32_16x16x32_bf16 v[120:123], v[44:47], v[48:51], v[120:123]
  s_waitcnt lgkmcnt(8)
  ds_read_b64_tr_b16 v[40:41], v3 offset:8960
  ds_read_b64_tr_b16 v[42:43], v3 offset:9984
  v_mfma_f32_16x16x32_bf16 v[124:127], v[44:47], v[52:55], v[124:127]
  v_mfma_f32_16x16x32_bf16 v[64:67], v[16:19], v[56:59], v[64:67]
  s_waitcnt lgkmcnt(8)
  ds_read_b64_tr_b16 v[44:45], v2 offset:8960
  ds_read_b64_tr_b16 v[46:47], v2 offset:9984
  v_mfma_f32_16x16x32_bf16 v[68:71], v[16:19], v[60:63], v[68:71]
  v_mfma_f32_16x16x32_bf16 v[72:75], v[20:23], v[56:59], v[72:75]
  s_waitcnt lgkmcnt(8)
  v_add_u32 v1, 0, v4
  v_mfma_f32_16x16x32_bf16 v[76:79], v[20:23], v[60:63], v[76:79]
  v_mfma_f32_16x16x32_bf16 v[80:83], v[24:27], v[56:59], v[80:83]
  s_waitcnt lgkmcnt(6)
  v_add_u32 v3, 0, v6
  v_mfma_f32_16x16x32_bf16 v[84:87], v[24:27], v[60:63], v[84:87]
  v_mfma_f32_16x16x32_bf16 v[88:91], v[28:31], v[56:59], v[88:91]
  s_waitcnt lgkmcnt(4)
  v_xor_b32 v2, 32, v3
  v_mfma_f32_16x16x32_bf16 v[92:95], v[28:31], v[60:63], v[92:95]
  v_mfma_f32_16x16x32_bf16 v[96:99], v[32:35], v[56:59], v[96:99]
  s_waitcnt lgkmcnt(0)
  s_barrier
  ds_read_b128 v[48:51], v1 offset:0
  ds_read_b128 v[52:55], v1 offset:2048
  v_mfma_f32_16x16x32_bf16 v[100:103], v[32:35], v[60:63], v[100:103]
  v_mfma_f32_16x16x32_bf16 v[104:107], v[36:39], v[56:59], v[104:107]
  ds_read_b64_tr_b16 v[16:17], v3 offset:0
  ds_read_b64_tr_b16 v[18:19], v3 offset:1024
  ds_read_b64_tr_b16 v[20:21], v2 offset:0
  ds_read_b64_tr_b16 v[22:23], v2 offset:1024
  v_mfma_f32_16x16x32_bf16 v[108:111], v[36:39], v[60:63], v[108:111]
  v_mfma_f32_16x16x32_bf16 v[112:115], v[40:43], v[56:59], v[112:115]
  ds_read_b64_tr_b16 v[24:25], v3 offset:256
  ds_read_b64_tr_b16 v[26:27], v3 offset:1280
  ds_read_b64_tr_b16 v[28:29], v2 offset:256
  ds_read_b64_tr_b16 v[30:31], v2 offset:1280
  v_mfma_f32_16x16x32_bf16 v[116:119], v[40:43], v[60:63], v[116:119]
  v_mfma_f32_16x16x32_bf16 v[120:123], v[44:47], v[56:59], v[120:123]
  s_waitcnt lgkmcnt(6)
  ds_read_b64_tr_b16 v[32:33], v3 offset:512
  ds_read_b64_tr_b16 v[34:35], v3 offset:1536
  ds_read_b64_tr_b16 v[36:37], v2 offset:512
  ds_read_b64_tr_b16 v[38:39], v2 offset:1536
  v_mfma_f32_16x16x32_bf16 v[124:127], v[44:47], v[60:63], v[124:127]
  v_mfma_f32_16x16x32_bf16 v[64:67], v[16:19], v[48:51], v[64:67]
  s_waitcnt lgkmcnt(8)
  ds_read_b64_tr_b16 v[40:41], v3 offset:768
  ds_read_b64_tr_b16 v[42:43], v3 offset:1792
  ds_read_b64_tr_b16 v[44:45], v2 offset:768
  ds_read_b64_tr_b16 v[46:47], v2 offset:1792
  v_mfma_f32_16x16x32_bf16 v[68:71], v[16:19], v[52:55], v[68:71]
  v_mfma_f32_16x16x32_bf16 v[72:75], v[20:23], v[48:51], v[72:75]
  s_waitcnt lgkmcnt(8)
  v_mfma_f32_16x16x32_bf16 v[76:79], v[20:23], v[52:55], v[76:79]
  v_mfma_f32_16x16x32_bf16 v[80:83], v[24:27], v[48:51], v[80:83]
  s_waitcnt lgkmcnt(6)
  ds_read_b128 v[56:59], v1 offset:512
  ds_read_b128 v[60:63], v1 offset:2560
  ds_read_b64_tr_b16 v[16:17], v3 offset:8192
  ds_read_b64_tr_b16 v[18:19], v3 offset:9216
  v_mfma_f32_16x16x32_bf16 v[84:87], v[24:27], v[52:55], v[84:87]
  v_mfma_f32_16x16x32_bf16 v[88:91], v[28:31], v[48:51], v[88:91]
  s_waitcnt lgkmcnt(8)
  ds_read_b64_tr_b16 v[20:21], v2 offset:8192
  ds_read_b64_tr_b16 v[22:23], v2 offset:9216
  ds_read_b64_tr_b16 v[24:25], v3 offset:8448
  ds_read_b64_tr_b16 v[26:27], v3 offset:9472
  v_mfma_f32_16x16x32_bf16 v[92:95], v[28:31], v[52:55], v[92:95]
  v_mfma_f32_16x16x32_bf16 v[96:99], v[32:35], v[48:51], v[96:99]
  s_waitcnt lgkmcnt(10)
  ds_read_b64_tr_b16 v[28:29], v2 offset:8448
  ds_read_b64_tr_b16 v[30:31], v2 offset:9472
  v_mfma_f32_16x16x32_bf16 v[100:103], v[32:35], v[52:55], v[100:103]
  v_mfma_f32_16x16x32_bf16 v[104:107], v[36:39], v[48:51], v[104:107]
  s_waitcnt lgkmcnt(10)
  ds_read_b64_tr_b16 v[32:33], v3 offset:8704
  ds_read_b64_tr_b16 v[34:35], v3 offset:9728
  v_mfma_f32_16x16x32_bf16 v[108:111], v[36:39], v[52:55], v[108:111]
  v_mfma_f32_16x16x32_bf16 v[112:115], v[40:43], v[48:51], v[112:115]
  s_waitcnt lgkmcnt(8)
  ds_read_b64_tr_b16 v[36:37], v2 offset:8704
  ds_read_b64_tr_b16 v[38:39], v2 offset:9728
  v_mfma_f32_16x16x32_bf16 v[116:119], v[40:43], v[52:55], v[116:119]
  v_mfma_f32_16x16x32_bf16 v[120:123], v[44:47], v[48:51], v[120:123]
  s_waitcnt lgkmcnt(8)
  ds_read_b64_tr_b16 v[40:41], v3 offset:8960
  ds_read_b64_tr_b16 v[42:43], v3 offset:9984
  v_mfma_f32_16x16x32_bf16 v[124:127], v[44:47], v[52:55], v[124:127]
  v_mfma_f32_16x16x32_bf16 v[64:67], v[16:19], v[56:59], v[64:67]
  s_waitcnt lgkmcnt(8)
  ds_read_b64_tr_b16 v[44:45], v2 offset:8960
  ds_read_b64_tr_b16 v[46:47], v2 offset:9984
  v_mfma_f32_16x16x32_bf16 v[68:71], v[16:19], v[60:63], v[68:71]
  v_mfma_f32_16x16x32_bf16 v[72:75], v[20:23], v[56:59], v[72:75]
  s_waitcnt lgkmcnt(8)
  v_add_u32 v1, 40960, v4
  v_mfma_f32_16x16x32_bf16 v[76:79], v[20:23], v[60:63], v[76:79]
  v_mfma_f32_16x16x32_bf16 v[80:83], v[24:27], v[56:59], v[80:83]
  s_waitcnt lgkmcnt(6)
  v_add_u32 v3, 40960, v6
  v_mfma_f32_16x16x32_bf16 v[84:87], v[24:27], v[60:63], v[84:87]
  v_mfma_f32_16x16x32_bf16 v[88:91], v[28:31], v[56:59], v[88:91]
  s_waitcnt lgkmcnt(4)
  v_xor_b32 v2, 32, v3
  v_mfma_f32_16x16x32_bf16 v[92:95], v[28:31], v[60:63], v[92:95]
  v_mfma_f32_16x16x32_bf16 v[96:99], v[32:35], v[56:59], v[96:99]
  s_waitcnt lgkmcnt(0)
  s_barrier
  ds_read_b128 v[48:51], v1 offset:0
  ds_read_b128 v[52:55], v1 offset:2048
  v_mfma_f32_16x16x32_bf16 v[100:103], v[32:35], v[60:63], v[100:103]
  v_mfma_f32_16x16x32_bf16 v[104:107], v[36:39], v[56:59], v[104:107]
  ds_read_b64_tr_b16 v[16:17], v3 offset:0
  ds_read_b64_tr_b16 v[18:19], v3 offset:1024
  ds_read_b64_tr_b16 v[20:21], v2 offset:0
  ds_read_b64_tr_b16 v[22:23], v2 offset:1024
  v_mfma_f32_16x16x32_bf16 v[108:111], v[36:39], v[60:63], v[108:111]
  v_mfma_f32_16x16x32_bf16 v[112:115], v[40:43], v[56:59], v[112:115]
  ds_read_b64_tr_b16 v[24:25], v3 offset:256
  ds_read_b64_tr_b16 v[26:27], v3 offset:1280
  ds_read_b64_tr_b16 v[28:29], v2 offset:256
  ds_read_b64_tr_b16 v[30:31], v2 offset:1280
  v_mfma_f32_16x16x32_bf16 v[116:119], v[40:43], v[60:63], v[116:119]
  v_mfma_f32_16x16x32_bf16 v[120:123], v[44:47], v[56:59], v[120:123]
  s_waitcnt lgkmcnt(6)
  ds_read_b64_tr_b16 v[32:33], v3 offset:512
  ds_read_b64_tr_b16 v[34:35], v3 offset:1536
  ds_read_b64_tr_b16 v[36:37], v2 offset:512
  ds_read_b64_tr_b16 v[38:39], v2 offset:1536
  v_mfma_f32_16x16x32_bf16 v[124:127], v[44:47], v[60:63], v[124:127]
  v_mfma_f32_16x16x32_bf16 v[64:67], v[16:19], v[48:51], v[64:67]
  s_waitcnt lgkmcnt(8)
  ds_read_b64_tr_b16 v[40:41], v3 offset:768
  ds_read_b64_tr_b16 v[42:43], v3 offset:1792
  ds_read_b64_tr_b16 v[44:45], v2 offset:768
  ds_read_b64_tr_b16 v[46:47], v2 offset:1792
  v_mfma_f32_16x16x32_bf16 v[68:71], v[16:19], v[52:55], v[68:71]
  v_mfma_f32_16x16x32_bf16 v[72:75], v[20:23], v[48:51], v[72:75]
  s_waitcnt lgkmcnt(8)
  v_mfma_f32_16x16x32_bf16 v[76:79], v[20:23], v[52:55], v[76:79]
  v_mfma_f32_16x16x32_bf16 v[80:83], v[24:27], v[48:51], v[80:83]
  s_waitcnt lgkmcnt(6)
  ds_read_b128 v[56:59], v1 offset:512
  ds_read_b128 v[60:63], v1 offset:2560
  ds_read_b64_tr_b16 v[16:17], v3 offset:8192
  ds_read_b64_tr_b16 v[18:19], v3 offset:9216
  v_mfma_f32_16x16x32_bf16 v[84:87], v[24:27], v[52:55], v[84:87]
  v_mfma_f32_16x16x32_bf16 v[88:91], v[28:31], v[48:51], v[88:91]
  s_waitcnt lgkmcnt(8)
  ds_read_b64_tr_b16 v[20:21], v2 offset:8192
  ds_read_b64_tr_b16 v[22:23], v2 offset:9216
  ds_read_b64_tr_b16 v[24:25], v3 offset:8448
  ds_read_b64_tr_b16 v[26:27], v3 offset:9472
  v_mfma_f32_16x16x32_bf16 v[92:95], v[28:31], v[52:55], v[92:95]
  v_mfma_f32_16x16x32_bf16 v[96:99], v[32:35], v[48:51], v[96:99]
L_stub0:
  s_cbranch_execz L_warm_ret
  s_waitcnt lgkmcnt(10)
  ds_read_b64_tr_b16 v[28:29], v2 offset:8448
  ds_read_b64_tr_b16 v[30:31], v2 offset:9472
  v_mfma_f32_16x16x32_bf16 v[100:103], v[32:35], v[52:55], v[100:103]
  v_mfma_f32_16x16x32_bf16 v[104:107], v[36:39], v[48:51], v[104:107]
  s_waitcnt lgkmcnt(10)
  ds_read_b64_tr_b16 v[32:33], v3 offset:8704
  ds_read_b64_tr_b16 v[34:35], v3 offset:9728
  v_mfma_f32_16x16x32_bf16 v[108:111], v[36:39], v[52:55], v[108:111]
  v_mfma_f32_16x16x32_bf16 v[112:115], v[40:43], v[48:51], v[112:115]
  s_waitcnt lgkmcnt(8)
  ds_read_b64_tr_b16 v[36:37], v2 offset:8704
  ds_read_b64_tr_b16 v[38:39], v2 offset:9728
  v_mfma_f32_16x16x32_bf16 v[116:119], v[40:43], v[52:55], v[116:119]
  v_mfma_f32_16x16x32_bf16 v[120:123], v[44:47], v[48:51], v[120:123]
  s_waitcnt lgkmcnt(8)
  ds_read_b64_tr_b16 v[40:41], v3 offset:8960
  ds_read_b64_tr_b16 v[42:43], v3 offset:9984
  v_mfma_f32_16x16x32_bf16 v[124:127], v[44:47], v[52:55], v[124:127]
  v_mfma_f32_16x16x32_bf16 v[64:67], v[16:19], v[56:59], v[64:67]
  s_waitcnt lgkmcnt(8)
  ds_read_b64_tr_b16 v[44:45], v2 offset:8960
  ds_read_b64_tr_b16 v[46:47], v2 offset:9984
  v_mfma_f32_16x16x32_bf16 v[68:71], v[16:19], v[60:63], v[68:71]
  v_mfma_f32_16x16x32_bf16 v[72:75], v[20:23], v[56:59], v[72:75]
  s_waitcnt lgkmcnt(8)
  v_add_u32 v1, 81920, v4
  v_mfma_f32_16x16x32_bf16 v[76:79], v[20:23], v[60:63], v[76:79]
  v_mfma_f32_16x16x32_bf16 v[80:83], v[24:27], v[56:59], v[80:83]
  s_waitcnt lgkmcnt(6)
  v_add_u32 v3, 81920, v6
  v_mfma_f32_16x16x32_bf16 v[84:87], v[24:27], v[60:63], v[84:87]
  v_mfma_f32_16x16x32_bf16 v[88:91], v[28:31], v[56:59], v[88:91]
  s_waitcnt lgkmcnt(4)
  v_xor_b32 v2, 32, v3
  v_mfma_f32_16x16x32_bf16 v[92:95], v[28:31], v[60:63], v[92:95]
  v_mfma_f32_16x16x32_bf16 v[96:99], v[32:35], v[56:59], v[96:99]
  s_waitcnt lgkmcnt(0)
  s_barrier
  ds_read_b128 v[48:51], v1 offset:0
  ds_read_b128 v[52:55], v1 offset:2048
  v_mfma_f32_16x16x32_bf16 v[100:103], v[32:35], v[60:63], v[100:103]
  v_mfma_f32_16x16x32_bf16 v[104:107], v[36:39], v[56:59], v[104:107]
  ds_read_b64_tr_b16 v[16:17], v3 offset:0
  ds_read_b64_tr_b16 v[18:19], v3 offset:1024
  ds_read_b64_tr_b16 v[20:21], v2 offset:0
  ds_read_b64_tr_b16 v[22:23], v2 offset:1024
  v_mfma_f32_16x16x32_bf16 v[108:111], v[36:39], v[60:63], v[108:111]
  v_mfma_f32_16x16x32_bf16 v[112:115], v[40:43], v[56:59], v[112:115]
  ds_read_b64_tr_b16 v[24:25], v3 offset:256
  ds_read_b64_tr_b16 v[26:27], v3 offset:1280
  ds_read_b64_tr_b16 v[28:29], v2 offset:256
  ds_read_b64_tr_b16 v[30:31], v2 offset:1280
  v_mfma_f32_16x16x32_bf16 v[116:119], v[40:43], v[60:63], v[116:119]
  v_mfma_f32_16x16x32_bf16 v[120:123], v[44:47], v[56:59], v[120:123]
  s_waitcnt lgkmcnt(6)
  ds_read_b64_tr_b16 v[32:33], v3 offset:512
  ds_read_b64_tr_b16 v[34:35], v3 offset:1536
  ds_read_b64_tr_b16 v[36:37], v2 offset:512
  ds_read_b64_tr_b16 v[38:39], v2 offset:1536
  v_mfma_f32_16x16x32_bf16 v[124:127], v[44:47], v[60:63], v[124:127]
  v_mfma_f32_16x16x32_bf16 v[64:67], v[16:19], v[48:51], v[64:67]
  s_waitcnt lgkmcnt(8)
  ds_read_b64_tr_b16 v[40:41], v3 offset:768
  ds_read_b64_tr_b16 v[42:43], v3 offset:1792
  ds_read_b64_tr_b16 v[44:45], v2 offset:768
  ds_read_b64_tr_b16 v[46:47], v2 offset:1792
  v_mfma_f32_16x16x32_bf16 v[68:71], v[16:19], v[52:55], v[68:71]
  v_mfma_f32_16x16x32_bf16 v[72:75], v[20:23], v[48:51], v[72:75]
  s_waitcnt lgkmcnt(8)
  v_mfma_f32_16x16x32_bf16 v[76:79], v[20:23], v[52:55], v[76:79]
  v_mfma_f32_16x16x32_bf16 v[80:83], v[24:27], v[48:51], v[80:83]
  s_waitcnt lgkmcnt(6)
  ds_read_b128 v[56:59], v1 offset:512
  ds_read_b128 v[60:63], v1 offset:2560
  ds_read_b64_tr_b16 v[16:17], v3 offset:8192
  ds_read_b64_tr_b16 v[18:19], v3 offset:9216
  v_mfma_f32_16x16x32_bf16 v[84:87], v[24:27], v[52:55], v[84:87]
  v_mfma_f32_16x16x32_bf16 v[88:91], v[28:31], v[48:51], v[88:91]
  s_waitcnt lgkmcnt(8)
  ds_read_b64_tr_b16 v[20:21], v2 offset:8192
  ds_read_b64_tr_b16 v[22:23], v2 offset:9216
  ds_read_b64_tr_b16 v[24:25], v3 offset:8448
  ds_read_b64_tr_b16 v[26:27], v3 offset:9472
  v_mfma_f32_16x16x32_bf16 v[92:95], v[28:31], v[52:55], v[92:95]
  v_mfma_f32_16x16x32_bf16 v[96:99], v[32:35], v[48:51], v[96:99]
  s_waitcnt lgkmcnt(10)
  ds_read_b64_tr_b16 v[28:29], v2 offset:8448
  ds_read_b64_tr_b16 v[30:31], v2 offset:9472
  v_mfma_f32_16x16x32_bf16 v[100:103], v[32:35], v[52:55], v[100:103]
  v_mfma_f32_16x16x32_bf16 v[104:107], v[36:39], v[48:51], v[104:107]
  s_waitcnt lgkmcnt(10)
  ds_read_b64_tr_b16 v[32:33], v3 offset:8704
  ds_read_b64_tr_b16 v[34:35], v3 offset:9728
  v_mfma_f32_16x16x32_bf16 v[108:111], v[36:39], v[52:55], v[108:111]
  v_mfma_f32_16x16x32_bf16 v[112:115], v[40:43], v[48:51], v[112:115]
  s_waitcnt lgkmcnt(8)
  ds_read_b64_tr_b16 v[36:37], v2 offset:8704
  ds_read_b64_tr_b16 v[38:39], v2 offset:9728
  v_mfma_f32_16x16x32_bf16 v[116:119], v[40:43], v[52:55], v[116:119]
  v_mfma_f32_16x16x32_bf16 v[120:123], v[44:47], v[48:51], v[120:123]
  s_waitcnt lgkmcnt(8)
  ds_read_b64_tr_b16 v[40:41], v3 offset:8960
  ds_read_b64_tr_b16 v[42:43], v3 offset:9984
  v_mfma_f32_16x16x32_bf16 v[124:127], v[44:47], v[52:55], v[124:127]
  v_mfma_f32_16x16x32_bf16 v[64:67], v[16:19], v[56:59], v[64:67]
  s_waitcnt lgkmcnt(8)
  ds_read_b64_tr_b16 v[44:45], v2 offset:8960
  ds_read_b64_tr_b16 v[46:47], v2 offset:9984
  v_mfma_f32_16x16x32_bf16 v[68:71], v[16:19], v[60:63], v[68:71]
  v_mfma_f32_16x16x32_bf16 v[72:75], v[20:23], v[56:59], v[72:75]
  s_waitcnt lgkmcnt(8)
  v_add_u32 v1, 122880, v4
  v_mfma_f32_16x16x32_bf16 v[76:79], v[20:23], v[60:63], v[76:79]
  v_mfma_f32_16x16x32_bf16 v[80:83], v[24:27], v[56:59], v[80:83]
  s_waitcnt lgkmcnt(6)
  v_add_u32 v3, 122880, v6
  v_mfma_f32_16x16x32_bf16 v[84:87], v[24:27], v[60:63], v[84:87]
  v_mfma_f32_16x16x32_bf16 v[88:91], v[28:31], v[56:59], v[88:91]
  s_waitcnt lgkmcnt(4)
  v_xor_b32 v2, 32, v3
  v_mfma_f32_16x16x32_bf16 v[92:95], v[28:31], v[60:63], v[92:95]
  v_mfma_f32_16x16x32_bf16 v[96:99], v[32:35], v[56:59], v[96:99]
  s_waitcnt lgkmcnt(0)
  s_barrier
  ds_read_b128 v[48:51], v1 offset:0
  ds_read_b128 v[52:55], v1 offset:2048
  v_mfma_f32_16x16x32_bf16 v[100:103], v[32:35], v[60:63], v[100:103]
  v_mfma_f32_16x16x32_bf16 v[104:107], v[36:39], v[56:59], v[104:107]
  ds_read_b64_tr_b16 v[16:17], v3 offset:0
  ds_read_b64_tr_b16 v[18:19], v3 offset:1024
  ds_read_b128 v[176:179], v1 offset:512
  ds_read_b128 v[180:183], v1 offset:2560
  v_mfma_f32_16x16x32_bf16 v[108:111], v[36:39], v[60:63], v[108:111]
  v_mfma_f32_16x16x32_bf16 v[112:115], v[40:43], v[56:59], v[112:115]
  ds_read_b64_tr_b16 v[20:21], v3 offset:8192
  ds_read_b64_tr_b16 v[22:23], v3 offset:9216
  ds_read_b64_tr_b16 v[24:25], v2 offset:0
  ds_read_b64_tr_b16 v[26:27], v2 offset:1024
  v_mfma_f32_16x16x32_bf16 v[116:119], v[40:43], v[60:63], v[116:119]
  v_mfma_f32_16x16x32_bf16 v[120:123], v[44:47], v[56:59], v[120:123]
  s_waitcnt lgkmcnt(6)
  ds_read_b64_tr_b16 v[28:29], v2 offset:8192
  ds_read_b64_tr_b16 v[30:31], v2 offset:9216
  ds_read_b64_tr_b16 v[32:33], v3 offset:256
  ds_read_b64_tr_b16 v[34:35], v3 offset:1280
  v_mfma_f32_16x16x32_bf16 v[124:127], v[44:47], v[60:63], v[124:127]
  v_mfma_f32_16x16x32_bf16 v[64:67], v[16:19], v[48:51], v[64:67]
  s_waitcnt lgkmcnt(6)
  ds_read_b64_tr_b16 v[36:37], v3 offset:8448
  ds_read_b64_tr_b16 v[38:39], v3 offset:9472
  ds_read_b64_tr_b16 v[40:41], v2 offset:256
  ds_read_b64_tr_b16 v[42:43], v2 offset:1280
  v_mfma_f32_16x16x32_bf16 v[68:71], v[16:19], v[52:55], v[68:71]
  v_mfma_f32_16x16x32_bf16 v[64:67], v[20:23], v[176:179], v[64:67]
  s_waitcnt lgkmcnt(8)
  ds_read_b64_tr_b16 v[44:45], v2 offset:8448
  ds_read_b64_tr_b16 v[46:47], v2 offset:9472
  ds_read_b64_tr_b16 v[16:17], v3 offset:512
  ds_read_b64_tr_b16 v[18:19], v3 offset:1536
  v_mfma_f32_16x16x32_bf16 v[68:71], v[20:23], v[180:183], v[68:71]
  v_mfma_f32_16x16x32_bf16 v[72:75], v[24:27], v[48:51], v[72:75]
  s_waitcnt lgkmcnt(8)
  ds_read_b64_tr_b16 v[20:21], v3 offset:8704
  ds_read_b64_tr_b16 v[22:23], v3 offset:9728
  v_mfma_f32_16x16x32_bf16 v[76:79], v[24:27], v[52:55], v[76:79]
  v_mfma_f32_16x16x32_bf16 v[72:75], v[28:31], v[176:179], v[72:75]
  s_waitcnt lgkmcnt(8)
  ds_read_b64_tr_b16 v[24:25], v2 offset:512
  ds_read_b64_tr_b16 v[26:27], v2 offset:1536
  v_mfma_f32_16x16x32_bf16 v[76:79], v[28:31], v[180:183], v[76:79]
  v_mul_f32 v64, s55, v64
  v_mul_f32 v65, s55, v65
  v_mfma_f32_16x16x32_bf16 v[80:83], v[32:35], v[48:51], v[80:83]
  s_waitcnt lgkmcnt(8)
  ds_read_b64_tr_b16 v[28:29], v2 offset:8704
  ds_read_b64_tr_b16 v[30:31], v2 offset:9728
  v_mfma_f32_16x16x32_bf16 v[84:87], v[32:35], v[52:55], v[84:87]
  v_mul_f32 v66, s55, v66
  v_mul_f32 v67, s55, v67
  v_mfma_f32_16x16x32_bf16 v[80:83], v[36:39], v[176:179], v[80:83]
  s_waitcnt lgkmcnt(8)
  ds_read_b64_tr_b16 v[32:33], v3 offset:768
  ds_read_b64_tr_b16 v[34:35], v3 offset:1792
  v_mfma_f32_16x16x32_bf16 v[84:87], v[36:39], v[180:183], v[84:87]
  v_mul_f32 v68, s55, v68
  v_mul_f32 v69, s55, v69
  v_mfma_f32_16x16x32_bf16 v[88:91], v[40:43], v[48:51], v[88:91]
  s_waitcnt lgkmcnt(8)
  ds_read_b64_tr_b16 v[36:37], v3 offset:8960
  ds_read_b64_tr_b16 v[38:39], v3 offset:9984
  v_mfma_f32_16x16x32_bf16 v[92:95], v[40:43], v[52:55], v[92:95]
  v_mul_f32 v70, s55, v70
  v_mul_f32 v71, s55, v71
  v_mfma_f32_16x16x32_bf16 v[88:91], v[44:47], v[176:179], v[88:91]
  s_waitcnt lgkmcnt(8)
  ds_read_b64_tr_b16 v[40:41], v2 offset:768
  ds_read_b64_tr_b16 v[42:43], v2 offset:1792
  v_mfma_f32_16x16x32_bf16 v[92:95], v[44:47], v[180:183], v[92:95]
  v_cvt_pk_bf16_f32 v128, v64, v65
  v_cvt_pk_bf16_f32 v129, v66, v67
  v_mfma_f32_16x16x32_bf16 v[96:99], v[16:19], v[48:51], v[96:99]
  s_waitcnt lgkmcnt(8)
  ds_read_b64_tr_b16 v[44:45], v2 offset:8960
  ds_read_b64_tr_b16 v[46:47], v2 offset:9984
  v_mfma_f32_16x16x32_bf16 v[100:103], v[16:19], v[52:55], v[100:103]
  v_cvt_pk_bf16_f32 v130, v68, v69
  v_cvt_pk_bf16_f32 v131, v70, v71
  v_mfma_f32_16x16x32_bf16 v[96:99], v[20:23], v[176:179], v[96:99]
  s_waitcnt lgkmcnt(8)
  v_add_u32 v1, 0, v5
  v_permlane16_swap_b32 v128, v130
  v_mfma_f32_16x16x32_bf16 v[100:103], v[20:23], v[180:183], v[100:103]
  v_permlane16_swap_b32 v129, v131
  v_mul_f32 v72, s55, v72
  v_mfma_f32_16x16x32_bf16 v[104:107], v[24:27], v[48:51], v[104:107]
  s_waitcnt lgkmcnt(6)
  v_add_u32 v3, 0, v7
  v_mul_f32 v73, s55, v73
  v_mfma_f32_16x16x32_bf16 v[108:111], v[24:27], v[52:55], v[108:111]
  v_mul_f32 v74, s55, v74
  v_mul_f32 v75, s55, v75
  v_mfma_f32_16x16x32_bf16 v[104:107], v[28:31], v[176:179], v[104:107]
  s_waitcnt lgkmcnt(4)
  v_xor_b32 v2, 32, v1
  v_mul_f32 v76, s55, v76
  v_mfma_f32_16x16x32_bf16 v[108:111], v[28:31], v[180:183], v[108:111]
  v_mul_f32 v77, s55, v77
  v_mul_f32 v78, s55, v78
  v_mfma_f32_16x16x32_bf16 v[112:115], v[32:35], v[48:51], v[112:115]
  s_waitcnt lgkmcnt(0)
  s_barrier
  ds_read_b128 v[16:19], v1 offset:0
  ds_read_b128 v[20:23], v2 offset:0
  v_mfma_f32_16x16x32_bf16 v[116:119], v[32:35], v[52:55], v[116:119]
  v_mul_f32 v79, s55, v79
  v_mfma_f32_16x16x32_bf16 v[112:115], v[36:39], v[176:179], v[112:115]
  ds_read_b128 v[24:27], v1 offset:256
  ds_read_b128 v[28:31], v2 offset:256
  ds_read_b128 v[32:35], v1 offset:512
  v_mfma_f32_16x16x32_bf16 v[116:119], v[36:39], v[180:183], v[116:119]
  v_cvt_pk_bf16_f32 v132, v72, v73
  v_cvt_pk_bf16_f32 v133, v74, v75
  v_mfma_f32_16x16x32_bf16 v[120:123], v[40:43], v[48:51], v[120:123]
  ds_read_b128 v[36:39], v2 offset:512
  v_cvt_pk_bf16_f32 v134, v76, v77
  v_mfma_f32_16x16x32_bf16 v[124:127], v[40:43], v[52:55], v[124:127]
  v_cvt_pk_bf16_f32 v135, v78, v79
  v_permlane16_swap_b32 v132, v134
  v_mfma_f32_16x16x32_bf16 v[120:123], v[44:47], v[176:179], v[120:123]
  s_waitcnt lgkmcnt(4)
  ds_read_b128 v[40:43], v1 offset:768
  v_permlane16_swap_b32 v133, v135
  v_mfma_f32_16x16x32_bf16 v[124:127], v[44:47], v[180:183], v[124:127]
  v_mul_f32 v80, s55, v80
  v_mul_f32 v81, s55, v81
  v_mfma_f32_32x32x16_bf16 v[160:175], v[16:19], v[128:131], 0
  s_waitcnt lgkmcnt(4)
  ds_read_b128 v[44:47], v2 offset:768
  v_mul_f32 v82, s55, v82
  v_mul_f32 v83, s55, v83
  v_mul_f32 v84, s55, v84
  v_mul_f32 v85, s55, v85
  v_mul_f32 v86, s55, v86
  v_mfma_f32_32x32x16_bf16 v[160:175], v[20:23], v[132:135], v[160:175]
  s_waitcnt lgkmcnt(4)
  ds_read_b128 v[16:19], v1 offset:8192
  v_mul_f32 v87, s55, v87
  v_cvt_pk_bf16_f32 v136, v80, v81
  v_cvt_pk_bf16_f32 v137, v82, v83
  v_cvt_pk_bf16_f32 v138, v84, v85
  v_cvt_pk_bf16_f32 v139, v86, v87
  s_nop 0
  v_permlane16_swap_b32 v136, v138
  v_permlane16_swap_b32 v137, v139
  s_nop 1
  v_mfma_f32_32x32x16_bf16 v[160:175], v[24:27], v[136:139], v[160:175]
  s_waitcnt lgkmcnt(4)
  ds_read_b128 v[20:23], v2 offset:8192
  v_mul_f32 v88, s55, v88
  v_mul_f32 v89, s55, v89
  v_mul_f32 v90, s55, v90
  v_mul_f32 v91, s55, v91
  v_mul_f32 v92, s55, v92
  v_mul_f32 v93, s55, v93
  v_mul_f32 v94, s55, v94
  v_mul_f32 v95, s55, v95
  v_cvt_pk_bf16_f32 v140, v88, v89
  v_cvt_pk_bf16_f32 v141, v90, v91
  v_cvt_pk_bf16_f32 v142, v92, v93
  v_cvt_pk_bf16_f32 v143, v94, v95
  s_nop 0
  v_permlane16_swap_b32 v140, v142
  v_permlane16_swap_b32 v141, v143
  s_nop 1
  v_mfma_f32_32x32x16_bf16 v[160:175], v[28:31], v[140:143], v[160:175]
  s_waitcnt lgkmcnt(4)
  ds_read_b128 v[24:27], v1 offset:8448
  v_mul_f32 v96, s55, v96
  v_mul_f32 v97, s55, v97
  v_mul_f32 v98, s55, v98
  v_mul_f32 v99, s55, v99
  v_mul_f32 v100, s55, v100
  v_mul_f32 v101, s55, v101
  v_mul_f32 v102, s55, v102
  v_mul_f32 v103, s55, v103
  v_cvt_pk_bf16_f32 v144, v96, v97
  v_cvt_pk_bf16_f32 v145, v98, v99
  v_cvt_pk_bf16_f32 v146, v100, v101
  v_cvt_pk_bf16_f32 v147, v102, v103
  s_nop 0
  v_permlane16_swap_b32 v144, v146
  v_permlane16_swap_b32 v145, v147
  s_nop 1
  v_mfma_f32_32x32x16_bf16 v[160:175], v[32:35], v[144:147], v[160:175]
  s_waitcnt lgkmcnt(4)
  ds_read_b128 v[28:31], v2 offset:8448
  v_mul_f32 v104, s55, v104
  v_mul_f32 v105, s55, v105
  v_mul_f32 v106, s55, v106
  v_mul_f32 v107, s55, v107
  v_mul_f32 v108, s55, v108
  v_mul_f32 v109, s55, v109
  v_mul_f32 v110, s55, v110
  v_mul_f32 v111, s55, v111
  v_cvt_pk_bf16_f32 v148, v104, v105
  v_cvt_pk_bf16_f32 v149, v106, v107
  v_cvt_pk_bf16_f32 v150, v108, v109
  v_cvt_pk_bf16_f32 v151, v110, v111
  s_nop 0
  v_permlane16_swap_b32 v148, v150
  v_permlane16_swap_b32 v149, v151
  s_nop 1
  v_mfma_f32_32x32x16_bf16 v[160:175], v[36:39], v[148:151], v[160:175]
  s_waitcnt lgkmcnt(4)
  ds_read_b128 v[32:35], v1 offset:8704
  v_mul_f32 v112, s55, v112
  v_mul_f32 v113, s55, v113
  v_mul_f32 v114, s55, v114
  v_mul_f32 v115, s55, v115
  v_mul_f32 v116, s55, v116
  v_mul_f32 v117, s55, v117
  v_mul_f32 v118, s55, v118
  v_mul_f32 v119, s55, v119
  v_cvt_pk_bf16_f32 v152, v112, v113
  v_cvt_pk_bf16_f32 v153, v114, v115
  v_cvt_pk_bf16_f32 v154, v116, v117
  v_cvt_pk_bf16_f32 v155, v118, v119
  s_nop 0
  v_permlane16_swap_b32 v152, v154
  v_permlane16_swap_b32 v153, v155
  s_nop 1
  v_mfma_f32_32x32x16_bf16 v[160:175], v[40:43], v[152:155], v[160:175]
  s_waitcnt lgkmcnt(4)
  ds_read_b128 v[36:39], v2 offset:8704
  v_mul_f32 v120, s55, v120
  v_mul_f32 v121, s55, v121
  v_mul_f32 v122, s55, v122
  v_mul_f32 v123, s55, v123
  v_mul_f32 v124, s55, v124
  v_mul_f32 v125, s55, v125
  v_mul_f32 v126, s55, v126
  v_mul_f32 v127, s55, v127
  v_cvt_pk_bf16_f32 v156, v120, v121
  v_cvt_pk_bf16_f32 v157, v122, v123
  v_cvt_pk_bf16_f32 v158, v124, v125
  v_cvt_pk_bf16_f32 v159, v126, v127
  s_nop 0
  v_permlane16_swap_b32 v156, v158
  v_permlane16_swap_b32 v157, v159
  s_nop 1
  v_mfma_f32_32x32x16_bf16 v[160:175], v[44:47], v[156:159], v[160:175]
  s_waitcnt lgkmcnt(4)
  ds_read_b128 v[40:43], v1 offset:8960
  v_mfma_f32_32x32x16_bf16 v[176:191], v[16:19], v[128:131], 0
  s_waitcnt lgkmcnt(4)
  ds_read_b128 v[44:47], v2 offset:8960
  v_mfma_f32_32x32x16_bf16 v[176:191], v[20:23], v[132:135], v[176:191]
  s_waitcnt lgkmcnt(4)
  ds_read_b128 v[16:19], v1 offset:16384
  v_max3_f32 v14, v160, v161, v162
  v_max3_f32 v14, v14, v163, v164
  v_max3_f32 v14, v14, v165, v166
  v_max3_f32 v14, v14, v167, v168
  v_max3_f32 v14, v14, v169, v170
  v_mfma_f32_32x32x16_bf16 v[176:191], v[24:27], v[136:139], v[176:191]
  s_waitcnt lgkmcnt(4)
  ds_read_b128 v[20:23], v2 offset:16384
  v_max3_f32 v14, v14, v171, v172
  v_max3_f32 v14, v14, v173, v174
  v_max_f32 v14, v14, v175
  v_mov_b32 v15, v14
  s_nop 1
  v_permlane32_swap_b32 v14, v15
  v_mfma_f32_32x32x16_bf16 v[176:191], v[28:31], v[140:143], v[176:191]
  s_waitcnt lgkmcnt(4)
  ds_read_b128 v[24:27], v1 offset:16640
  v_max_f32 v14, v14, v15
  v_sub_f32 v208, 0, v14
  v_add_f32 v160, v208, v160
  v_exp_f32 v48, v160
  v_mfma_f32_32x32x16_bf16 v[176:191], v[32:35], v[144:147], v[176:191]
  s_waitcnt lgkmcnt(4)
  ds_read_b128 v[28:31], v2 offset:16640
  v_add_f32 v161, v208, v161
  v_exp_f32 v49, v161
  v_add_f32 v162, v208, v162
  v_mfma_f32_32x32x16_bf16 v[176:191], v[36:39], v[148:151], v[176:191]
  s_waitcnt lgkmcnt(4)
  ds_read_b128 v[32:35], v1 offset:16896
  v_exp_f32 v50, v162
  v_add_f32 v13, v49, v48
  v_cvt_pk_bf16_f32 v192, v48, v49
  v_add_f32 v163, v208, v163
  v_mfma_f32_32x32x16_bf16 v[176:191], v[40:43], v[152:155], v[176:191]
  s_waitcnt lgkmcnt(4)
  ds_read_b128 v[36:39], v2 offset:16896
  v_exp_f32 v51, v163
  v_add_f32 v13, v50, v13
  v_add_f32 v164, v208, v164
  v_mfma_f32_32x32x16_bf16 v[176:191], v[44:47], v[156:159], v[176:191]
  s_waitcnt lgkmcnt(4)
  ds_read_b128 v[40:43], v1 offset:17152
  v_exp_f32 v52, v164
  v_add_f32 v13, v51, v13
  v_cvt_pk_bf16_f32 v193, v50, v51
  v_add_f32 v165, v208, v165
  v_mfma_f32_32x32x16_bf16 v[224:239], v[16:19], v[128:131], 0
  s_waitcnt lgkmcnt(4)
  ds_read_b128 v[44:47], v2 offset:17152
  v_exp_f32 v53, v165
  v_add_f32 v13, v52, v13
  v_add_f32 v166, v208, v166
  v_mfma_f32_32x32x16_bf16 v[224:239], v[20:23], v[132:135], v[224:239]
  s_waitcnt lgkmcnt(4)
  ds_read_b64_tr_b16 v[16:17], v3 offset:24576
  ds_read_b64_tr_b16 v[18:19], v3 offset:26624
  v_exp_f32 v54, v166
  v_add_f32 v13, v53, v13
  v_cvt_pk_bf16_f32 v194, v52, v53
  v_mfma_f32_32x32x16_bf16 v[224:239], v[24:27], v[136:139], v[224:239]
  s_waitcnt lgkmcnt(5)
  ds_read_b64_tr_b16 v[20:21], v3 offset:24832
  ds_read_b64_tr_b16 v[22:23], v3 offset:26880
  v_add_f32 v167, v208, v167
  v_exp_f32 v55, v167
  v_add_f32 v13, v54, v13
  v_mfma_f32_32x32x16_bf16 v[224:239], v[28:31], v[140:143], v[224:239]
  s_waitcnt lgkmcnt(6)
  ds_read_b64_tr_b16 v[24:25], v3 offset:25088
  ds_read_b64_tr_b16 v[26:27], v3 offset:27136
  v_add_f32 v168, v208, v168
  v_exp_f32 v48, v168
  v_add_f32 v13, v55, v13
  v_mfma_f32_32x32x16_bf16 v[224:239], v[32:35], v[144:147], v[224:239]
  s_waitcnt lgkmcnt(7)
  ds_read_b64_tr_b16 v[28:29], v3 offset:25344
  ds_read_b64_tr_b16 v[30:31], v3 offset:27392
  v_cvt_pk_bf16_f32 v195, v54, v55
  v_add_f32 v169, v208, v169
  v_exp_f32 v49, v169
  v_mfma_f32_32x32x16_bf16 v[224:239], v[36:39], v[148:151], v[224:239]
  s_waitcnt lgkmcnt(8)
  ds_read_b64_tr_b16 v[32:33], v3 offset:28672
  ds_read_b64_tr_b16 v[34:35], v3 offset:30720
  v_add_f32 v13, v48, v13
  v_add_f32 v170, v208, v170
  v_exp_f32 v50, v170
  v_mfma_f32_32x32x16_bf16 v[224:239], v[40:43], v[152:155], v[224:239]
  s_waitcnt lgkmcnt(8)
  ds_read_b64_tr_b16 v[36:37], v3 offset:28928
  ds_read_b64_tr_b16 v[38:39], v3 offset:30976
  v_add_f32 v13, v49, v13
  v_cvt_pk_bf16_f32 v196, v48, v49
  v_add_f32 v171, v208, v171
  v_mfma_f32_32x32x16_bf16 v[224:239], v[44:47], v[156:159], v[224:239]
  s_waitcnt lgkmcnt(8)
  ds_read_b64_tr_b16 v[40:41], v3 offset:29184
  ds_read_b64_tr_b16 v[42:43], v3 offset:31232
  v_exp_f32 v51, v171
  v_add_f32 v13, v50, v13
  v_add_f32 v172, v208, v172
  v_exp_f32 v52, v172
  v_add_f32 v13, v51, v13
  v_cvt_pk_bf16_f32 v197, v50, v51
  v_add_f32 v173, v208, v173
  v_exp_f32 v53, v173
  v_add_f32 v13, v52, v13
  v_add_f32 v174, v208, v174
  v_exp_f32 v54, v174
  v_add_f32 v13, v53, v13
  v_cvt_pk_bf16_f32 v198, v52, v53
  v_add_f32 v175, v208, v175
  v_exp_f32 v55, v175
  v_add_f32 v13, v54, v13
  v_add_f32 v13, v55, v13
  v_cvt_pk_bf16_f32 v199, v54, v55
  v_mov_b32 v12, v13
  v_mfma_f32_32x32x16_bf16 v[64:79], v[16:19], v[192:195], 0
  s_waitcnt lgkmcnt(8)
  ds_read_b64_tr_b16 v[44:45], v3 offset:29440
  ds_read_b64_tr_b16 v[46:47], v3 offset:31488
  v_mov_b32 v209, v208
  v_mov_b32 v210, v208
  v_mov_b32 v211, v208
  v_mov_b32 v212, v208
  v_mfma_f32_32x32x16_bf16 v[80:95], v[20:23], v[192:195], 0
  s_waitcnt lgkmcnt(8)
  v_add_u32 v1, 40960, v5
  v_mov_b32 v213, v208
  v_mov_b32 v214, v208
  v_mov_b32 v215, v208
  v_mov_b32 v216, v208
  v_mov_b32 v217, v208
  v_mfma_f32_32x32x16_bf16 v[96:111], v[24:27], v[192:195], 0
  s_waitcnt lgkmcnt(6)
  v_add_u32 v3, 40960, v7
  v_mov_b32 v218, v208
  v_mov_b32 v219, v208
  v_mov_b32 v220, v208
  v_mov_b32 v221, v208
  v_mov_b32 v222, v208
  v_mfma_f32_32x32x16_bf16 v[112:127], v[28:31], v[192:195], 0
  s_waitcnt lgkmcnt(4)
  v_xor_b32 v2, 32, v1
  v_mov_b32 v223, v208
  v_add_f32 v176, v208, v176
  v_exp_f32 v48, v176
  v_add_f32 v177, v208, v177
  v_mfma_f32_32x32x16_bf16 v[64:79], v[32:35], v[196:199], v[64:79]
  s_waitcnt lgkmcnt(0)
  s_barrier
  ds_read_b128 v[16:19], v1 offset:0
  ds_read_b128 v[20:23], v2 offset:0
  v_exp_f32 v49, v177
  v_add_f32 v178, v208, v178
  v_mfma_f32_32x32x16_bf16 v[80:95], v[36:39], v[196:199], v[80:95]
  ds_read_b128 v[24:27], v1 offset:256
  ds_read_b128 v[28:31], v2 offset:256
  ds_read_b128 v[32:35], v1 offset:512
  v_exp_f32 v50, v178
  v_add_f32 v60, v49, v48
  v_mfma_f32_32x32x16_bf16 v[96:111], v[40:43], v[196:199], v[96:111]
  ds_read_b128 v[36:39], v2 offset:512
  v_cvt_pk_bf16_f32 v200, v48, v49
  v_add_f32 v179, v208, v179
  v_exp_f32 v51, v179
  v_add_f32 v60, v50, v60
  v_mfma_f32_32x32x16_bf16 v[112:127], v[44:47], v[196:199], v[112:127]
  s_waitcnt lgkmcnt(4)
  ds_read_b128 v[40:43], v1 offset:768
  v_add_f32 v180, v208, v180
  v_exp_f32 v52, v180
  v_add_f32 v60, v51, v60
  v_cvt_pk_bf16_f32 v201, v50, v51
  v_mfma_f32_32x32x16_bf16 v[160:175], v[16:19], v[128:131], v[208:223]
  s_waitcnt lgkmcnt(4)
  ds_read_b128 v[44:47], v2 offset:768
  v_add_f32 v181, v208, v181
  v_exp_f32 v53, v181
  v_add_f32 v60, v52, v60
  v_add_f32 v182, v208, v182
  v_mfma_f32_32x32x16_bf16 v[160:175], v[20:23], v[132:135], v[160:175]
  s_waitcnt lgkmcnt(4)
  ds_read_b64_tr_b16 v[16:17], v3 offset:8192
  ds_read_b64_tr_b16 v[18:19], v3 offset:10240
  v_exp_f32 v54, v182
  v_add_f32 v60, v53, v60
  v_cvt_pk_bf16_f32 v202, v52, v53
  v_mfma_f32_32x32x16_bf16 v[160:175], v[24:27], v[136:139], v[160:175]
  s_waitcnt lgkmcnt(5)
  ds_read_b64_tr_b16 v[20:21], v3 offset:8448
  ds_read_b64_tr_b16 v[22:23], v3 offset:10496
  v_add_f32 v183, v208, v183
  v_exp_f32 v55, v183
  v_add_f32 v60, v54, v60
  v_mfma_f32_32x32x16_bf16 v[160:175], v[28:31], v[140:143], v[160:175]
  s_waitcnt lgkmcnt(6)
  ds_read_b64_tr_b16 v[24:25], v3 offset:8704
  ds_read_b64_tr_b16 v[26:27], v3 offset:10752
  v_add_f32 v184, v208, v184
  v_exp_f32 v48, v184
  v_add_f32 v60, v55, v60
  v_mfma_f32_32x32x16_bf16 v[160:175], v[32:35], v[144:147], v[160:175]
  s_waitcnt lgkmcnt(7)
  ds_read_b64_tr_b16 v[28:29], v3 offset:8960
  ds_read_b64_tr_b16 v[30:31], v3 offset:11008
  v_cvt_pk_bf16_f32 v203, v54, v55
  v_add_f32 v185, v208, v185
  v_exp_f32 v49, v185
  v_mfma_f32_32x32x16_bf16 v[160:175], v[36:39], v[148:151], v[160:175]
  s_waitcnt lgkmcnt(8)
  ds_read_b64_tr_b16 v[32:33], v3 offset:12288
  ds_read_b64_tr_b16 v[34:35], v3 offset:14336
  v_add_f32 v60, v48, v60
  v_add_f32 v186, v208, v186
  v_exp_f32 v50, v186
  v_mfma_f32_32x32x16_bf16 v[160:175], v[40:43], v[152:155], v[160:175]
  s_waitcnt lgkmcnt(8)
  ds_read_b64_tr_b16 v[36:37], v3 offset:12544
  ds_read_b64_tr_b16 v[38:39], v3 offset:14592
  v_add_f32 v60, v49, v60
  v_cvt_pk_bf16_f32 v204, v48, v49
  v_add_f32 v187, v208, v187
  v_mfma_f32_32x32x16_bf16 v[160:175], v[44:47], v[156:159], v[160:175]
  s_waitcnt lgkmcnt(8)
  ds_read_b64_tr_b16 v[40:41], v3 offset:12800
  ds_read_b64_tr_b16 v[42:43], v3 offset:14848
  v_exp_f32 v51, v187
  v_add_f32 v60, v50, v60
  v_add_f32 v188, v208, v188
  v_exp_f32 v52, v188
  v_add_f32 v60, v51, v60
  v_cvt_pk_bf16_f32 v205, v50, v51
  v_add_f32 v189, v208, v189
  v_exp_f32 v53, v189
  v_add_f32 v60, v52, v60
  v_add_f32 v190, v208, v190
  v_exp_f32 v54, v190
  v_add_f32 v60, v53, v60
  v_cvt_pk_bf16_f32 v206, v52, v53
  v_add_f32 v191, v208, v191
  v_exp_f32 v55, v191
  v_add_f32 v60, v54, v60
  v_add_f32 v60, v55, v60
  v_cvt_pk_bf16_f32 v207, v54, v55
  v_cmp_nge_f32 vcc, s54, v60
  s_cbranch_vccnz L_rare1
L_back1:
  v_mfma_f32_32x32x16_bf16 v[64:79], v[16:19], v[200:203], v[64:79]
  s_waitcnt lgkmcnt(8)
  ds_read_b64_tr_b16 v[44:45], v3 offset:13056
  ds_read_b64_tr_b16 v[46:47], v3 offset:15104
  v_add_f32 v12, v60, v12
  v_add_f32 v224, v208, v224
  v_exp_f32 v48, v224
  v_mfma_f32_32x32x16_bf16 v[80:95], v[20:23], v[200:203], v[80:95]
  s_waitcnt lgkmcnt(8)
  ds_read_b128 v[16:19], v1 offset:16384
  v_add_f32 v225, v208, v225
  v_exp_f32 v49, v225
  v_add_f32 v226, v208, v226
  v_mfma_f32_32x32x16_bf16 v[96:111], v[24:27], v[200:203], v[96:111]
  s_waitcnt lgkmcnt(7)
  ds_read_b128 v[20:23], v2 offset:16384
  v_exp_f32 v50, v226
  v_add_f32 v13, v49, v48
  v_cvt_pk_bf16_f32 v240, v48, v49
  v_add_f32 v227, v208, v227
  v_mfma_f32_32x32x16_bf16 v[112:127], v[28:31], v[200:203], v[112:127]
  s_waitcnt lgkmcnt(6)
  ds_read_b128 v[24:27], v1 offset:16640
  v_exp_f32 v51, v227
  v_add_f32 v13, v50, v13
  v_add_f32 v228, v208, v228
  v_mfma_f32_32x32x16_bf16 v[64:79], v[32:35], v[204:207], v[64:79]
  s_waitcnt lgkmcnt(5)
  ds_read_b128 v[28:31], v2 offset:16640
  v_exp_f32 v52, v228
  v_add_f32 v13, v51, v13
  v_cvt_pk_bf16_f32 v241, v50, v51
  v_add_f32 v229, v208, v229
  v_mfma_f32_32x32x16_bf16 v[80:95], v[36:39], v[204:207], v[80:95]
  s_waitcnt lgkmcnt(4)
  ds_read_b128 v[32:35], v1 offset:16896
  v_exp_f32 v53, v229
  v_add_f32 v13, v52, v13
  v_add_f32 v230, v208, v230
  v_mfma_f32_32x32x16_bf16 v[96:111], v[40:43], v[204:207], v[96:111]
  s_waitcnt lgkmcnt(4)
  ds_read_b128 v[36:39], v2 offset:16896
  v_exp_f32 v54, v230
  v_add_f32 v13, v53, v13
  v_cvt_pk_bf16_f32 v242, v52, v53
L_stub1:
  s_cbranch_execz L_warm_ret
  v_add_f32 v231, v208, v231
  v_mfma_f32_32x32x16_bf16 v[112:127], v[44:47], v[204:207], v[112:127]
  s_waitcnt lgkmcnt(4)
  ds_read_b128 v[40:43], v1 offset:17152
  v_exp_f32 v55, v231
  v_add_f32 v13, v54, v13
  v_add_f32 v232, v208, v232
  v_mfma_f32_32x32x16_bf16 v[176:191], v[16:19], v[128:131], v[208:223]
  s_waitcnt lgkmcnt(4)
  ds_read_b128 v[44:47], v2 offset:17152
  v_exp_f32 v48, v232
  v_add_f32 v13, v55, v13
  v_cvt_pk_bf16_f32 v243, v54, v55
  v_add_f32 v233, v208, v233
  v_mfma_f32_32x32x16_bf16 v[176:191], v[20:23], v[132:135], v[176:191]
  s_waitcnt lgkmcnt(4)
  ds_read_b64_tr_b16 v[16:17], v3 offset:24576
  ds_read_b64_tr_b16 v[18:19], v3 offset:26624
  v_exp_f32 v49, v233
  v_add_f32 v13, v48, v13
  v_add_f32 v234, v208, v234
  v_mfma_f32_32x32x16_bf16 v[176:191], v[24:27], v[136:139], v[176:191]
  s_waitcnt lgkmcnt(5)
  ds_read_b64_tr_b16 v[20:21], v3 offset:24832
  ds_read_b64_tr_b16 v[22:23], v3 offset:26880
  v_exp_f32 v50, v234
  v_add_f32 v13, v49, v13
  v_cvt_pk_bf16_f32 v244, v48, v49
  v_mfma_f32_32x32x16_bf16 v[176:191], v[28:31], v[140:143], v[176:191]
  s_waitcnt lgkmcnt(6)
  ds_read_b64_tr_b16 v[24:25], v3 offset:25088
  ds_read_b64_tr_b16 v[26:27], v3 offset:27136
  v_add_f32 v235, v208, v235
  v_exp_f32 v51, v235
  v_add_f32 v13, v50, v13
  v_mfma_f32_32x32x16_bf16 v[176:191], v[32:35], v[144:147], v[176:191]
  s_waitcnt lgkmcnt(7)
  ds_read_b64_tr_b16 v[28:29], v3 offset:25344
  ds_read_b64_tr_b16 v[30:31], v3 offset:27392
  v_add_f32 v236, v208, v236
  v_exp_f32 v52, v236
  v_add_f32 v13, v51, v13
  v_mfma_f32_32x32x16_bf16 v[176:191], v[36:39], v[148:151], v[176:191]
  s_waitcnt lgkmcnt(8)
  ds_read_b64_tr_b16 v[32:33], v3 offset:28672
  ds_read_b64_tr_b16 v[34:35], v3 offset:30720
  v_cvt_pk_bf16_f32 v245, v50, v51
  v_add_f32 v237, v208, v237
  v_exp_f32 v53, v237
  v_mfma_f32_32x32x16_bf16 v[176:191], v[40:43], v[152:155], v[176:191]
  s_waitcnt lgkmcnt(8)
  ds_read_b64_tr_b16 v[36:37], v3 offset:28928
  ds_read_b64_tr_b16 v[38:39], v3 offset:30976
  v_add_f32 v13, v52, v13
  v_add_f32 v238, v208, v238
  v_exp_f32 v54, v238
  v_mfma_f32_32x32x16_bf16 v[176:191], v[44:47], v[156:159], v[176:191]
  s_waitcnt lgkmcnt(8)
  ds_read_b64_tr_b16 v[40:41], v3 offset:29184
  ds_read_b64_tr_b16 v[42:43], v3 offset:31232
  v_add_f32 v13, v53, v13
  v_cvt_pk_bf16_f32 v246, v52, v53
  v_add_f32 v239, v208, v239
  v_exp_f32 v55, v239
  v_add_f32 v13, v54, v13
  v_add_f32 v13, v55, v13
  v_cvt_pk_bf16_f32 v247, v54, v55
  v_cmp_nge_f32 vcc, s54, v13
  s_cbranch_vccnz L_rare2
L_back2:
  v_mfma_f32_32x32x16_bf16 v[64:79], v[16:19], v[240:243], v[64:79]
  s_waitcnt lgkmcnt(8)
  ds_read_b64_tr_b16 v[44:45], v3 offset:29440
  ds_read_b64_tr_b16 v[46:47], v3 offset:31488
  v_add_f32 v12, v13, v12
  v_exp_f32 v48, v160
  v_mfma_f32_32x32x16_bf16 v[80:95], v[20:23], v[240:243], v[80:95]
  s_waitcnt lgkmcnt(8)
  v_add_u32 v1, 81920, v5
  v_exp_f32 v49, v161
  v_exp_f32 v50, v162
  v_add_f32 v60, v49, v48
  v_mfma_f32_32x32x16_bf16 v[96:111], v[24:27], v[240:243], v[96:111]
  s_waitcnt lgkmcnt(6)
  v_add_u32 v3, 81920, v7
  v_cvt_pk_bf16_f32 v192, v48, v49
  v_exp_f32 v51, v163
  v_add_f32 v60, v50, v60
  v_mfma_f32_32x32x16_bf16 v[112:127], v[28:31], v[240:243], v[112:127]
  s_waitcnt lgkmcnt(4)
  v_xor_b32 v2, 32, v1
  v_exp_f32 v52, v164
  v_add_f32 v60, v51, v60
  v_cvt_pk_bf16_f32 v193, v50, v51
  v_mfma_f32_32x32x16_bf16 v[64:79], v[32:35], v[244:247], v[64:79]
  s_waitcnt lgkmcnt(0)
  s_barrier
  ds_read_b128 v[16:19], v1 offset:0
  ds_read_b128 v[20:23], v2 offset:0
  v_exp_f32 v53, v165
  v_add_f32 v60, v52, v60
  v_mfma_f32_32x32x16_bf16 v[80:95], v[36:39], v[244:247], v[80:95]
  ds_read_b128 v[24:27], v1 offset:256
  ds_read_b128 v[28:31], v2 offset:256
  ds_read_b128 v[32:35], v1 offset:512
  v_exp_f32 v54, v166
  v_add_f32 v60, v53, v60
  v_mfma_f32_32x32x16_bf16 v[96:111], v[40:43], v[244:247], v[96:111]
  ds_read_b128 v[36:39], v2 offset:512
  v_cvt_pk_bf16_f32 v194, v52, v53
  v_exp_f32 v55, v167
  v_add_f32 v60, v54, v60
  v_mfma_f32_32x32x16_bf16 v[112:127], v[44:47], v[244:247], v[112:127]
  s_waitcnt lgkmcnt(4)
  ds_read_b128 v[40:43], v1 offset:768
  v_exp_f32 v48, v168
  v_add_f32 v60, v55, v60
  v_cvt_pk_bf16_f32 v195, v54, v55
  v_mfma_f32_32x32x16_bf16 v[224:239], v[16:19], v[128:131], v[208:223]
  s_waitcnt lgkmcnt(4)
  ds_read_b128 v[44:47], v2 offset:768
  v_exp_f32 v49, v169
  v_add_f32 v60, v48, v60
  v_exp_f32 v50, v170
  v_mfma_f32_32x32x16_bf16 v[224:239], v[20:23], v[132:135], v[224:239]
  s_waitcnt lgkmcnt(4)
  ds_read_b64_tr_b16 v[16:17], v3 offset:8192
  ds_read_b64_tr_b16 v[18:19], v3 offset:10240
  v_add_f32 v60, v49, v60
  v_cvt_pk_bf16_f32 v196, v48, v49
  v_exp_f32 v51, v171
  v_mfma_f32_32x32x16_bf16 v[224:239], v[24:27], v[136:139], v[224:239]
  s_waitcnt lgkmcnt(5)
  ds_read_b64_tr_b16 v[20:21], v3 offset:8448
  ds_read_b64_tr_b16 v[22:23], v3 offset:10496
  v_add_f32 v60, v50, v60
  v_exp_f32 v52, v172
  v_add_f32 v60, v51, v60
  v_mfma_f32_32x32x16_bf16 v[224:239], v[28:31], v[140:143], v[224:239]
  s_waitcnt lgkmcnt(6)
  ds_read_b64_tr_b16 v[24:25], v3 offset:8704
  ds_read_b64_tr_b16 v[26:27], v3 offset:10752
  v_cvt_pk_bf16_f32 v197, v50, v51
  v_exp_f32 v53, v173
  v_add_f32 v60, v52, v60
  v_mfma_f32_32x32x16_bf16 v[224:239], v[32:35], v[144:147], v[224:239]
  s_waitcnt lgkmcnt(7)
  ds_read_b64_tr_b16 v[28:29], v3 offset:8960
  ds_read_b64_tr_b16 v[30:31], v3 offset:11008
  v_exp_f32 v54, v174
  v_add_f32 v60, v53, v60
  v_cvt_pk_bf16_f32 v198, v52, v53
  v_mfma_f32_32x32x16_bf16 v[224:239], v[36:39], v[148:151], v[224:239]
  s_waitcnt lgkmcnt(8)
  ds_read_b64_tr_b16 v[32:33], v3 offset:12288
  ds_read_b64_tr_b16 v[34:35], v3 offset:14336
  v_exp_f32 v55, v175
  v_add_f32 v60, v54, v60
  v_add_f32 v60, v55, v60
  v_mfma_f32_32x32x16_bf16 v[224:239], v[40:43], v[152:155], v[224:239]
  s_waitcnt lgkmcnt(8)
  ds_read_b64_tr_b16 v[36:37], v3 offset:12544
  ds_read_b64_tr_b16 v[38:39], v3 offset:14592
  v_cvt_pk_bf16_f32 v199, v54, v55
  v_cmp_nge_f32 vcc, s54, v60
  v_mfma_f32_32x32x16_bf16 v[224:239], v[44:47], v[156:159], v[224:239]
  s_cbranch_vccnz L_rare3
L_back3:
  ds_read_b64_tr_b16 v[40:41], v3 offset:12800
  ds_read_b64_tr_b16 v[42:43], v3 offset:14848
  v_add_f32 v12, v60, v12
  v_exp_f32 v48, v176
  v_mfma_f32_32x32x16_bf16 v[64:79], v[16:19], v[192:195], v[64:79]
  s_waitcnt lgkmcnt(8)
  ds_read_b64_tr_b16 v[44:45], v3 offset:13056
  ds_read_b64_tr_b16 v[46:47], v3 offset:15104
  v_exp_f32 v49, v177
  v_exp_f32 v50, v178
  v_mfma_f32_32x32x16_bf16 v[80:95], v[20:23], v[192:195], v[80:95]
  s_waitcnt lgkmcnt(8)
  ds_read_b128 v[16:19], v1 offset:16384
  v_add_f32 v13, v49, v48
  v_cvt_pk_bf16_f32 v200, v48, v49
  v_exp_f32 v51, v179
  v_add_f32 v13, v50, v13
  v_mfma_f32_32x32x16_bf16 v[96:111], v[24:27], v[192:195], v[96:111]
  s_waitcnt lgkmcnt(7)
  ds_read_b128 v[20:23], v2 offset:16384
  v_exp_f32 v52, v180
  v_add_f32 v13, v51, v13
  v_cvt_pk_bf16_f32 v201, v50, v51
  v_mfma_f32_32x32x16_bf16 v[112:127], v[28:31], v[192:195], v[112:127]
  s_waitcnt lgkmcnt(6)
  ds_read_b128 v[24:27], v1 offset:16640
  v_exp_f32 v53, v181
  v_add_f32 v13, v52, v13
  v_exp_f32 v54, v182
  v_mfma_f32_32x32x16_bf16 v[64:79], v[32:35], v[196:199], v[64:79]
  s_waitcnt lgkmcnt(5)
  ds_read_b128 v[28:31], v2 offset:16640
  v_add_f32 v13, v53, v13
  v_cvt_pk_bf16_f32 v202, v52, v53
  v_exp_f32 v55, v183
  v_add_f32 v13, v54, v13
  v_mfma_f32_32x32x16_bf16 v[80:95], v[36:39], v[196:199], v[80:95]
  s_waitcnt lgkmcnt(4)
  ds_read_b128 v[32:35], v1 offset:16896
  v_exp_f32 v48, v184
  v_add_f32 v13, v55, v13
  v_cvt_pk_bf16_f32 v203, v54, v55
  v_mfma_f32_32x32x16_bf16 v[96:111], v[40:43], v[196:199], v[96:111]
  s_waitcnt lgkmcnt(4)
  ds_read_b128 v[36:39], v2 offset:16896
  v_exp_f32 v49, v185
  v_add_f32 v13, v48, v13
  v_exp_f32 v50, v186
  v_mfma_f32_32x32x16_bf16 v[112:127], v[44:47], v[196:199], v[112:127]
  s_waitcnt lgkmcnt(4)
  ds_read_b128 v[40:43], v1 offset:17152
  v_add_f32 v13, v49, v13
  v_cvt_pk_bf16_f32 v204, v48, v49
  v_exp_f32 v51, v187
  v_add_f32 v13, v50, v13
  v_mfma_f32_32x32x16_bf16 v[160:175], v[16:19], v[128:131], v[208:223]
  s_waitcnt lgkmcnt(4)
  ds_read_b128 v[44:47], v2 offset:17152
  v_exp_f32 v52, v188
  v_add_f32 v13, v51, v13
  v_cvt_pk_bf16_f32 v205, v50, v51
  v_mfma_f32_32x32x16_bf16 v[160:175], v[20:23], v[132:135], v[160:175]
  s_waitcnt lgkmcnt(4)
  ds_read_b64_tr_b16 v[16:17], v3 offset:24576
  ds_read_b64_tr_b16 v[18:19], v3 offset:26624
  v_exp_f32 v53, v189
  v_add_f32 v13, v52, v13
  v_mfma_f32_32x32x16_bf16 v[160:175], v[24:27], v[136:139], v[160:175]
  s_waitcnt lgkmcnt(5)
  ds_read_b64_tr_b16 v[20:21], v3 offset:24832
  ds_read_b64_tr_b16 v[22:23], v3 offset:26880
  v_exp_f32 v54, v190
  v_add_f32 v13, v53, v13
  v_cvt_pk_bf16_f32 v206, v52, v53
  v_mfma_f32_32x32x16_bf16 v[160:175], v[28:31], v[140:143], v[160:175]
  s_waitcnt lgkmcnt(6)
  ds_read_b64_tr_b16 v[24:25], v3 offset:25088
  ds_read_b64_tr_b16 v[26:27], v3 offset:27136
  v_exp_f32 v55, v191
  v_add_f32 v13, v54, v13
  v_add_f32 v13, v55, v13
  v_mfma_f32_32x32x16_bf16 v[160:175], v[32:35], v[144:147], v[160:175]
  s_waitcnt lgkmcnt(7)
  ds_read_b64_tr_b16 v[28:29], v3 offset:25344
  ds_read_b64_tr_b16 v[30:31], v3 offset:27392
  v_cvt_pk_bf16_f32 v207, v54, v55
  v_cmp_nge_f32 vcc, s54, v13
  v_mfma_f32_32x32x16_bf16 v[160:175], v[36:39], v[148:151], v[160:175]
  s_cbranch_vccnz L_rare4
L_back4:
  ds_read_b64_tr_b16 v[32:33], v3 offset:28672
  ds_read_b64_tr_b16 v[34:35], v3 offset:30720
  v_add_f32 v12, v13, v12
  v_exp_f32 v48, v224
  v_mfma_f32_32x32x16_bf16 v[160:175], v[40:43], v[152:155], v[160:175]
  s_waitcnt lgkmcnt(8)
  ds_read_b64_tr_b16 v[36:37], v3 offset:28928
  ds_read_b64_tr_b16 v[38:39], v3 offset:30976
  v_exp_f32 v49, v225
  v_exp_f32 v50, v226
  v_mfma_f32_32x32x16_bf16 v[160:175], v[44:47], v[156:159], v[160:175]
  s_waitcnt lgkmcnt(8)
  ds_read_b64_tr_b16 v[40:41], v3 offset:29184
  ds_read_b64_tr_b16 v[42:43], v3 offset:31232
  v_add_f32 v60, v49, v48
  v_cvt_pk_bf16_f32 v240, v48, v49
  v_exp_f32 v51, v227
  v_mfma_f32_32x32x16_bf16 v[64:79], v[16:19], v[200:203], v[64:79]
  s_waitcnt lgkmcnt(8)
  ds_read_b64_tr_b16 v[44:45], v3 offset:29440
  ds_read_b64_tr_b16 v[46:47], v3 offset:31488
  v_add_f32 v60, v50, v60
  v_exp_f32 v52, v228
  v_add_f32 v60, v51, v60
  v_mfma_f32_32x32x16_bf16 v[80:95], v[20:23], v[200:203], v[80:95]
  s_waitcnt lgkmcnt(8)
  v_add_u32 v1, 122880, v5
  v_cvt_pk_bf16_f32 v241, v50, v51
  v_exp_f32 v53, v229
  v_add_f32 v60, v52, v60
  v_mfma_f32_32x32x16_bf16 v[96:111], v[24:27], v[200:203], v[96:111]
  s_waitcnt lgkmcnt(6)
  v_add_u32 v3, 122880, v7
  v_exp_f32 v54, v230
  v_add_f32 v60, v53, v60
  v_cvt_pk_bf16_f32 v242, v52, v53
  v_mfma_f32_32x32x16_bf16 v[112:127], v[28:31], v[200:203], v[112:127]
  s_waitcnt lgkmcnt(4)
  v_xor_b32 v2, 32, v1
  v_exp_f32 v55, v231
  v_add_f32 v60, v54, v60
  v_exp_f32 v48, v232
  v_mfma_f32_32x32x16_bf16 v[64:79], v[32:35], v[204:207], v[64:79]
  s_waitcnt lgkmcnt(0)
  s_barrier
  ds_read_b128 v[16:19], v1 offset:0
  ds_read_b128 v[20:23], v2 offset:0
  v_add_f32 v60, v55, v60
  v_cvt_pk_bf16_f32 v243, v54, v55
  v_mfma_f32_32x32x16_bf16 v[80:95], v[36:39], v[204:207], v[80:95]
  ds_read_b128 v[24:27], v1 offset:256
  ds_read_b128 v[28:31], v2 offset:256
  ds_read_b128 v[32:35], v1 offset:512
  v_exp_f32 v49, v233
  v_add_f32 v60, v48, v60
  v_mfma_f32_32x32x16_bf16 v[96:111], v[40:43], v[204:207], v[96:111]
  ds_read_b128 v[36:39], v2 offset:512
  v_exp_f32 v50, v234
  v_add_f32 v60, v49, v60
  v_cvt_pk_bf16_f32 v244, v48, v49
  v_mfma_f32_32x32x16_bf16 v[112:127], v[44:47], v[204:207], v[112:127]
  s_waitcnt lgkmcnt(4)
  ds_read_b128 v[40:43], v1 offset:768
  v_exp_f32 v51, v235
  v_add_f32 v60, v50, v60
  v_exp_f32 v52, v236
  v_mfma_f32_32x32x16_bf16 v[176:191], v[16:19], v[128:131], v[208:223]
  s_waitcnt lgkmcnt(4)
  ds_read_b128 v[44:47], v2 offset:768
  v_add_f32 v60, v51, v60
  v_cvt_pk_bf16_f32 v245, v50, v51
  v_exp_f32 v53, v237
  v_add_f32 v60, v52, v60
  v_mfma_f32_32x32x16_bf16 v[176:191], v[20:23], v[132:135], v[176:191]
  s_waitcnt lgkmcnt(4)
  ds_read_b64_tr_b16 v[16:17], v3 offset:8192
  ds_read_b64_tr_b16 v[18:19], v3 offset:10240
  v_exp_f32 v54, v238
  v_add_f32 v60, v53, v60
  v_cvt_pk_bf16_f32 v246, v52, v53
  v_mfma_f32_32x32x16_bf16 v[176:191], v[24:27], v[136:139], v[176:191]
  s_waitcnt lgkmcnt(5)
  ds_read_b64_tr_b16 v[20:21], v3 offset:8448
  ds_read_b64_tr_b16 v[22:23], v3 offset:10496
  v_exp_f32 v55, v239
  v_add_f32 v60, v54, v60
  v_add_f32 v60, v55, v60
  v_mfma_f32_32x32x16_bf16 v[176:191], v[28:31], v[140:143], v[176:191]
  s_waitcnt lgkmcnt(6)
  ds_read_b64_tr_b16 v[24:25], v3 offset:8704
  ds_read_b64_tr_b16 v[26:27], v3 offset:10752
  v_cvt_pk_bf16_f32 v247, v54, v55
  v_cmp_nge_f32 vcc, s54, v60
  v_mfma_f32_32x32x16_bf16 v[176:191], v[32:35], v[144:147], v[176:191]
  s_cbranch_vccnz L_rare5
L_back5:
  ds_read_b64_tr_b16 v[28:29], v3 offset:8960
  ds_read_b64_tr_b16 v[30:31], v3 offset:11008
  v_add_f32 v12, v60, v12
  v_exp_f32 v48, v160
  v_mfma_f32_32x32x16_bf16 v[176:191], v[36:39], v[148:151], v[176:191]
  s_waitcnt lgkmcnt(8)
  ds_read_b64_tr_b16 v[32:33], v3 offset:12288
  ds_read_b64_tr_b16 v[34:35], v3 offset:14336
  v_exp_f32 v49, v161
  v_exp_f32 v50, v162
  v_mfma_f32_32x32x16_bf16 v[176:191], v[40:43], v[152:155], v[176:191]
  s_waitcnt lgkmcnt(8)
  ds_read_b64_tr_b16 v[36:37], v3 offset:12544
  ds_read_b64_tr_b16 v[38:39], v3 offset:14592
  v_add_f32 v13, v49, v48
  v_cvt_pk_bf16_f32 v192, v48, v49
  v_exp_f32 v51, v163
  v_mfma_f32_32x32x16_bf16 v[176:191], v[44:47], v[156:159], v[176:191]
  s_waitcnt lgkmcnt(8)
  ds_read_b64_tr_b16 v[40:41], v3 offset:12800
  ds_read_b64_tr_b16 v[42:43], v3 offset:14848
  v_add_f32 v13, v50, v13
  v_exp_f32 v52, v164
  v_add_f32 v13, v51, v13
  v_mfma_f32_32x32x16_bf16 v[64:79], v[16:19], v[240:243], v[64:79]
  s_waitcnt lgkmcnt(8)
  ds_read_b64_tr_b16 v[44:45], v3 offset:13056
  ds_read_b64_tr_b16 v[46:47], v3 offset:15104
  v_cvt_pk_bf16_f32 v193, v50, v51
  v_exp_f32 v53, v165
  v_add_f32 v13, v52, v13
  v_mfma_f32_32x32x16_bf16 v[80:95], v[20:23], v[240:243], v[80:95]
  s_waitcnt lgkmcnt(8)
  ds_read_b128 v[16:19], v1 offset:16384
  v_exp_f32 v54, v166
  v_add_f32 v13, v53, v13
  v_cvt_pk_bf16_f32 v194, v52, v53
  v_mfma_f32_32x32x16_bf16 v[96:111], v[24:27], v[240:243], v[96:111]
  s_waitcnt lgkmcnt(7)
  ds_read_b128 v[20:23], v2 offset:16384
  v_exp_f32 v55, v167
  v_add_f32 v13, v54, v13
  v_exp_f32 v48, v168
  v_mfma_f32_32x32x16_bf16 v[112:127], v[28:31], v[240:243], v[112:127]
  s_waitcnt lgkmcnt(6)
  ds_read_b128 v[24:27], v1 offset:16640
  v_add_f32 v13, v55, v13
  v_cvt_pk_bf16_f32 v195, v54, v55
  v_exp_f32 v49, v169
  v_add_f32 v13, v48, v13
  v_mfma_f32_32x32x16_bf16 v[64:79], v[32:35], v[244:247], v[64:79]
  s_waitcnt lgkmcnt(5)
  ds_read_b128 v[28:31], v2 offset:16640
  v_exp_f32 v50, v170
  v_add_f32 v13, v49, v13
  v_cvt_pk_bf16_f32 v196, v48, v49
  v_mfma_f32_32x32x16_bf16 v[80:95], v[36:39], v[244:247], v[80:95]
  s_waitcnt lgkmcnt(4)
  ds_read_b128 v[32:35], v1 offset:16896
  v_exp_f32 v51, v171
  v_add_f32 v13, v50, v13
  v_exp_f32 v52, v172
  v_mfma_f32_32x32x16_bf16 v[96:111], v[40:43], v[244:247], v[96:111]
  s_waitcnt lgkmcnt(4)
  ds_read_b128 v[36:39], v2 offset:16896
  v_add_f32 v13, v51, v13
  v_cvt_pk_bf16_f32 v197, v50, v51
  v_exp_f32 v53, v173
  v_add_f32 v13, v52, v13
  v_mfma_f32_32x32x16_bf16 v[112:127], v[44:47], v[244:247], v[112:127]
  s_waitcnt lgkmcnt(4)
  ds_read_b128 v[40:43], v1 offset:17152
  v_exp_f32 v54, v174
  v_add_f32 v13, v53, v13
  v_cvt_pk_bf16_f32 v198, v52, v53
  v_mfma_f32_32x32x16_bf16 v[224:239], v[16:19], v[128:131], v[208:223]
  s_waitcnt lgkmcnt(4)
  ds_read_b128 v[44:47], v2 offset:17152
  v_exp_f32 v55, v175
  v_add_f32 v13, v54, v13
  v_add_f32 v13, v55, v13
  v_cvt_pk_bf16_f32 v199, v54, v55
  v_mfma_f32_32x32x16_bf16 v[224:239], v[20:23], v[132:135], v[224:239]
  s_waitcnt lgkmcnt(4)
  ds_read_b64_tr_b16 v[16:17], v3 offset:24576
  ds_read_b64_tr_b16 v[18:19], v3 offset:26624
  v_cmp_nge_f32 vcc, s54, v13
  v_mfma_f32_32x32x16_bf16 v[224:239], v[24:27], v[136:139], v[224:239]
  s_cbranch_vccnz L_rare6
L_back6:
  ds_read_b64_tr_b16 v[20:21], v3 offset:24832
  ds_read_b64_tr_b16 v[22:23], v3 offset:26880
  v_add_f32 v12, v13, v12
  v_exp_f32 v48, v176
  v_mfma_f32_32x32x16_bf16 v[224:239], v[28:31], v[140:143], v[224:239]
  s_waitcnt lgkmcnt(6)
  ds_read_b64_tr_b16 v[24:25], v3 offset:25088
  ds_read_b64_tr_b16 v[26:27], v3 offset:27136
  v_exp_f32 v49, v177
  v_exp_f32 v50, v178
  v_mfma_f32_32x32x16_bf16 v[224:239], v[32:35], v[144:147], v[224:239]
  s_waitcnt lgkmcnt(7)
  ds_read_b64_tr_b16 v[28:29], v3 offset:25344
  ds_read_b64_tr_b16 v[30:31], v3 offset:27392
  v_add_f32 v60, v49, v48
  v_cvt_pk_bf16_f32 v200, v48, v49
  v_exp_f32 v51, v179
  v_mfma_f32_32x32x16_bf16 v[224:239], v[36:39], v[148:151], v[224:239]
  s_waitcnt lgkmcnt(8)
  ds_read_b64_tr_b16 v[32:33], v3 offset:28672
  ds_read_b64_tr_b16 v[34:35], v3 offset:30720
  v_add_f32 v60, v50, v60
  v_exp_f32 v52, v180
  v_add_f32 v60, v51, v60
  v_mfma_f32_32x32x16_bf16 v[224:239], v[40:43], v[152:155], v[224:239]
  s_waitcnt lgkmcnt(8)
  ds_read_b64_tr_b16 v[36:37], v3 offset:28928
  ds_read_b64_tr_b16 v[38:39], v3 offset:30976
  v_cvt_pk_bf16_f32 v201, v50, v51
  v_exp_f32 v53, v181
  v_add_f32 v60, v52, v60
  v_mfma_f32_32x32x16_bf16 v[224:239], v[44:47], v[156:159], v[224:239]
  s_waitcnt lgkmcnt(8)
  ds_read_b64_tr_b16 v[40:41], v3 offset:29184
  ds_read_b64_tr_b16 v[42:43], v3 offset:31232
  v_exp_f32 v54, v182
  v_add_f32 v60, v53, v60
  v_cvt_pk_bf16_f32 v202, v52, v53
  v_mfma_f32_32x32x16_bf16 v[64:79], v[16:19], v[192:195], v[64:79]
  s_waitcnt lgkmcnt(8)
  ds_read_b64_tr_b16 v[44:45], v3 offset:29440
  ds_read_b64_tr_b16 v[46:47], v3 offset:31488
  v_exp_f32 v55, v183
  v_add_f32 v60, v54, v60
  v_mfma_f32_32x32x16_bf16 v[80:95], v[20:23], v[192:195], v[80:95]
  s_waitcnt lgkmcnt(8)
  v_add_u32 v1, 0, v5
  v_exp_f32 v48, v184
  v_add_f32 v60, v55, v60
  v_cvt_pk_bf16_f32 v203, v54, v55
  v_mfma_f32_32x32x16_bf16 v[96:111], v[24:27], v[192:195], v[96:111]
  s_waitcnt lgkmcnt(6)
  v_add_u32 v3, 0, v7
  v_exp_f32 v49, v185
  v_add_f32 v60, v48, v60
  v_exp_f32 v50, v186
  v_mfma_f32_32x32x16_bf16 v[112:127], v[28:31], v[192:195], v[112:127]
  s_waitcnt lgkmcnt(4)
  v_xor_b32 v2, 32, v1
  v_add_f32 v60, v49, v60
  v_cvt_pk_bf16_f32 v204, v48, v49
  v_exp_f32 v51, v187
  v_add_f32 v60, v50, v60
  v_mfma_f32_32x32x16_bf16 v[64:79], v[32:35], v[196:199], v[64:79]
  s_waitcnt lgkmcnt(0)
  s_barrier
  ds_read_b128 v[16:19], v1 offset:0
  ds_read_b128 v[20:23], v2 offset:0
  v_exp_f32 v52, v188
  v_add_f32 v60, v51, v60
  v_mfma_f32_32x32x16_bf16 v[80:95], v[36:39], v[196:199], v[80:95]
  ds_read_b128 v[24:27], v1 offset:256
  ds_read_b128 v[28:31], v2 offset:256
  ds_read_b128 v[32:35], v1 offset:512
  v_cvt_pk_bf16_f32 v205, v50, v51
  v_exp_f32 v53, v189
  v_mfma_f32_32x32x16_bf16 v[96:111], v[40:43], v[196:199], v[96:111]
  ds_read_b128 v[36:39], v2 offset:512
  v_add_f32 v60, v52, v60
  v_exp_f32 v54, v190
  v_add_f32 v60, v53, v60
  v_cvt_pk_bf16_f32 v206, v52, v53
  v_mfma_f32_32x32x16_bf16 v[112:127], v[44:47], v[196:199], v[112:127]
  s_waitcnt lgkmcnt(4)
  ds_read_b128 v[40:43], v1 offset:768
  v_exp_f32 v55, v191
  v_add_f32 v60, v54, v60
  v_add_f32 v60, v55, v60
  v_cvt_pk_bf16_f32 v207, v54, v55
  v_mfma_f32_32x32x16_bf16 v[160:175], v[16:19], v[128:131], v[208:223]
  s_waitcnt lgkmcnt(4)
  ds_read_b128 v[44:47], v2 offset:768
  v_cmp_nge_f32 vcc, s54, v60
  v_mfma_f32_32x32x16_bf16 v[160:175], v[20:23], v[132:135], v[160:175]
  s_cbranch_vccnz L_rare7
L_back7:
  ds_read_b64_tr_b16 v[16:17], v3 offset:8192
  ds_read_b64_tr_b16 v[18:19], v3 offset:10240
  v_add_f32 v12, v60, v12
  v_exp_f32 v48, v224
  v_mfma_f32_32x32x16_bf16 v[160:175], v[24:27], v[136:139], v[160:175]
  s_waitcnt lgkmcnt(5)
  ds_read_b64_tr_b16 v[20:21], v3 offset:8448
  ds_read_b64_tr_b16 v[22:23], v3 offset:10496
  v_exp_f32 v49, v225
  v_exp_f32 v50, v226
  v_mfma_f32_32x32x16_bf16 v[160:175], v[28:31], v[140:143], v[160:175]
  s_waitcnt lgkmcnt(6)
  ds_read_b64_tr_b16 v[24:25], v3 offset:8704
  ds_read_b64_tr_b16 v[26:27], v3 offset:10752
  v_add_f32 v13, v49, v48
  v_cvt_pk_bf16_f32 v240, v48, v49
  v_exp_f32 v51, v227
  v_mfma_f32_32x32x16_bf16 v[160:175], v[32:35], v[144:147], v[160:175]
  s_waitcnt lgkmcnt(7)
  ds_read_b64_tr_b16 v[28:29], v3 offset:8960
  ds_read_b64_tr_b16 v[30:31], v3 offset:11008
  v_add_f32 v13, v50, v13
  v_exp_f32 v52, v228
  v_add_f32 v13, v51, v13
  v_mfma_f32_32x32x16_bf16 v[160:175], v[36:39], v[148:151], v[160:175]
  s_waitcnt lgkmcnt(8)
  ds_read_b64_tr_b16 v[32:33], v3 offset:12288
  ds_read_b64_tr_b16 v[34:35], v3 offset:14336
  v_cvt_pk_bf16_f32 v241, v50, v51
  v_exp_f32 v53, v229
  v_add_f32 v13, v52, v13
  v_mfma_f32_32x32x16_bf16 v[160:175], v[40:43], v[152:155], v[160:175]
  s_waitcnt lgkmcnt(8)
  ds_read_b64_tr_b16 v[36:37], v3 offset:12544
  ds_read_b64_tr_b16 v[38:39], v3 offset:14592
  v_exp_f32 v54, v230
  v_add_f32 v13, v53, v13
  v_cvt_pk_bf16_f32 v242, v52, v53
  v_mfma_f32_32x32x16_bf16 v[160:175], v[44:47], v[156:159], v[160:175]
  s_waitcnt lgkmcnt(8)
  ds_read_b64_tr_b16 v[40:41], v3 offset:12800
  ds_read_b64_tr_b16 v[42:43], v3 offset:14848
  v_exp_f32 v55, v231
  v_add_f32 v13, v54, v13
  v_mfma_f32_32x32x16_bf16 v[64:79], v[16:19], v[200:203], v[64:79]
  s_waitcnt lgkmcnt(8)
  ds_read_b64_tr_b16 v[44:45], v3 offset:13056
  ds_read_b64_tr_b16 v[46:47], v3 offset:15104
  v_exp_f32 v48, v232
  v_add_f32 v13, v55, v13
  v_cvt_pk_bf16_f32 v243, v54, v55
  v_mfma_f32_32x32x16_bf16 v[80:95], v[20:23], v[200:203], v[80:95]
  s_waitcnt lgkmcnt(8)
  ds_read_b128 v[16:19], v1 offset:16384
  v_exp_f32 v49, v233
  v_add_f32 v13, v48, v13
  v_exp_f32 v50, v234
  v_mfma_f32_32x32x16_bf16 v[96:111], v[24:27], v[200:203], v[96:111]
  s_waitcnt lgkmcnt(7)
  ds_read_b128 v[20:23], v2 offset:16384
  v_add_f32 v13, v49, v13
  v_cvt_pk_bf16_f32 v244, v48, v49
  v_exp_f32 v51, v235
  v_add_f32 v13, v50, v13
  v_mfma_f32_32x32x16_bf16 v[112:127], v[28:31], v[200:203], v[112:127]
  s_waitcnt lgkmcnt(6)
  ds_read_b128 v[24:27], v1 offset:16640
  v_exp_f32 v52, v236
  v_add_f32 v13, v51, v13
  v_cvt_pk_bf16_f32 v245, v50, v51
  v_mfma_f32_32x32x16_bf16 v[64:79], v[32:35], v[204:207], v[64:79]
  s_waitcnt lgkmcnt(5)
  ds_read_b128 v[28:31], v2 offset:16640
  v_exp_f32 v53, v237
  v_add_f32 v13, v52, v13
  v_exp_f32 v54, v238
  v_mfma_f32_32x32x16_bf16 v[80:95], v[36:39], v[204:207], v[80:95]
  s_waitcnt lgkmcnt(4)
  ds_read_b128 v[32:35], v1 offset:16896
  v_add_f32 v13, v53, v13
  v_cvt_pk_bf16_f32 v246, v52, v53
  v_exp_f32 v55, v239
  v_add_f32 v13, v54, v13
  v_mfma_f32_32x32x16_bf16 v[96:111], v[40:43], v[204:207], v[96:111]
  s_waitcnt lgkmcnt(4)
  ds_read_b128 v[36:39], v2 offset:16896
  v_add_f32 v13, v55, v13
  v_cvt_pk_bf16_f32 v247, v54, v55
  v_cmp_nge_f32 vcc, s54, v13
  v_mfma_f32_32x32x16_bf16 v[112:127], v[44:47], v[204:207], v[112:127]
  s_cbranch_vccnz L_rare8
L_back8:
  ds_read_b128 v[40:43], v1 offset:17152
  v_add_f32 v12, v13, v12
  v_exp_f32 v48, v160
  v_exp_f32 v49, v161
  v_mfma_f32_32x32x16_bf16 v[176:191], v[16:19], v[128:131], v[208:223]
  s_waitcnt lgkmcnt(4)
  ds_read_b128 v[44:47], v2 offset:17152
  v_exp_f32 v50, v162
  v_add_f32 v60, v49, v48
  v_cvt_pk_bf16_f32 v192, v48, v49
  v_mfma_f32_32x32x16_bf16 v[176:191], v[20:23], v[132:135], v[176:191]
  s_waitcnt lgkmcnt(4)
  ds_read_b64_tr_b16 v[16:17], v3 offset:24576
  ds_read_b64_tr_b16 v[18:19], v3 offset:26624
  v_exp_f32 v51, v163
  v_add_f32 v60, v50, v60
  v_mfma_f32_32x32x16_bf16 v[176:191], v[24:27], v[136:139], v[176:191]
  s_waitcnt lgkmcnt(5)
  ds_read_b64_tr_b16 v[20:21], v3 offset:24832
  ds_read_b64_tr_b16 v[22:23], v3 offset:26880
  v_exp_f32 v52, v164
  v_add_f32 v60, v51, v60
  v_cvt_pk_bf16_f32 v193, v50, v51
  v_mfma_f32_32x32x16_bf16 v[176:191], v[28:31], v[140:143], v[176:191]
  s_waitcnt lgkmcnt(6)
  ds_read_b64_tr_b16 v[24:25], v3 offset:25088
  ds_read_b64_tr_b16 v[26:27], v3 offset:27136
  v_exp_f32 v53, v165
  v_add_f32 v60, v52, v60
  v_mfma_f32_32x32x16_bf16 v[176:191], v[32:35], v[144:147], v[176:191]
  s_waitcnt lgkmcnt(7)
  ds_read_b64_tr_b16 v[28:29], v3 offset:25344
  ds_read_b64_tr_b16 v[30:31], v3 offset:27392
  v_exp_f32 v54, v166
  v_add_f32 v60, v53, v60
  v_cvt_pk_bf16_f32 v194, v52, v53
  v_mfma_f32_32x32x16_bf16 v[176:191], v[36:39], v[148:151], v[176:191]
  s_waitcnt lgkmcnt(8)
  ds_read_b64_tr_b16 v[32:33], v3 offset:28672
  ds_read_b64_tr_b16 v[34:35], v3 offset:30720
  v_exp_f32 v55, v167
  v_add_f32 v60, v54, v60
  v_mfma_f32_32x32x16_bf16 v[176:191], v[40:43], v[152:155], v[176:191]
  s_waitcnt lgkmcnt(8)
  ds_read_b64_tr_b16 v[36:37], v3 offset:28928
  ds_read_b64_tr_b16 v[38:39], v3 offset:30976
  v_exp_f32 v48, v168
  v_add_f32 v60, v55, v60
  v_cvt_pk_bf16_f32 v195, v54, v55
  v_mfma_f32_32x32x16_bf16 v[176:191], v[44:47], v[156:159], v[176:191]
  s_waitcnt lgkmcnt(8)
  ds_read_b64_tr_b16 v[40:41], v3 offset:29184
  ds_read_b64_tr_b16 v[42:43], v3 offset:31232
  v_exp_f32 v49, v169
  v_add_f32 v60, v48, v60
  v_mfma_f32_32x32x16_bf16 v[64:79], v[16:19], v[240:243], v[64:79]
  s_waitcnt lgkmcnt(8)
  ds_read_b64_tr_b16 v[44:45], v3 offset:29440
  ds_read_b64_tr_b16 v[46:47], v3 offset:31488
  v_exp_f32 v50, v170
  v_add_f32 v60, v49, v60
  v_cvt_pk_bf16_f32 v196, v48, v49
  v_mfma_f32_32x32x16_bf16 v[80:95], v[20:23], v[240:243], v[80:95]
  s_waitcnt lgkmcnt(8)
  v_add_u32 v1, 40960, v5
  v_exp_f32 v51, v171
L_stub2:
  s_cbranch_execz L_warm_ret
  v_add_f32 v60, v50, v60
  v_exp_f32 v52, v172
  v_mfma_f32_32x32x16_bf16 v[96:111], v[24:27], v[240:243], v[96:111]
  s_waitcnt lgkmcnt(6)
  v_add_u32 v3, 40960, v7
  v_add_f32 v60, v51, v60
  v_cvt_pk_bf16_f32 v197, v50, v51
  v_exp_f32 v53, v173
  v_add_f32 v60, v52, v60
  v_mfma_f32_32x32x16_bf16 v[112:127], v[28:31], v[240:243], v[112:127]
  s_waitcnt lgkmcnt(4)
  v_xor_b32 v2, 32, v1
  v_exp_f32 v54, v174
  v_add_f32 v60, v53, v60
  v_cvt_pk_bf16_f32 v198, v52, v53
  v_mfma_f32_32x32x16_bf16 v[64:79], v[32:35], v[244:247], v[64:79]
  s_waitcnt lgkmcnt(0)
  s_barrier
  ds_read_b128 v[16:19], v1 offset:0
  ds_read_b128 v[20:23], v2 offset:0
  v_exp_f32 v55, v175
  v_add_f32 v60, v54, v60
  v_mfma_f32_32x32x16_bf16 v[80:95], v[36:39], v[244:247], v[80:95]
  ds_read_b128 v[24:27], v1 offset:256
  ds_read_b128 v[28:31], v2 offset:256
  ds_read_b128 v[32:35], v1 offset:512
  v_add_f32 v60, v55, v60
  v_cvt_pk_bf16_f32 v199, v54, v55
  v_cmp_nge_f32 vcc, s54, v60
  v_mfma_f32_32x32x16_bf16 v[96:111], v[40:43], v[244:247], v[96:111]
  s_cbranch_vccnz L_rare9
L_back9:
  ds_read_b128 v[36:39], v2 offset:512
  v_add_f32 v12, v60, v12
  v_exp_f32 v48, v176
  v_exp_f32 v49, v177
  v_mfma_f32_32x32x16_bf16 v[112:127], v[44:47], v[244:247], v[112:127]
  s_waitcnt lgkmcnt(4)
  ds_read_b128 v[40:43], v1 offset:768
  v_exp_f32 v50, v178
  v_add_f32 v13, v49, v48
  v_cvt_pk_bf16_f32 v200, v48, v49
  v_mfma_f32_32x32x16_bf16 v[224:239], v[16:19], v[128:131], v[208:223]
  s_waitcnt lgkmcnt(4)
  ds_read_b128 v[44:47], v2 offset:768
  v_exp_f32 v51, v179
  v_add_f32 v13, v50, v13
  v_exp_f32 v52, v180
  v_mfma_f32_32x32x16_bf16 v[224:239], v[20:23], v[132:135], v[224:239]
  s_waitcnt lgkmcnt(4)
  ds_read_b64_tr_b16 v[16:17], v3 offset:8192
  ds_read_b64_tr_b16 v[18:19], v3 offset:10240
  v_add_f32 v13, v51, v13
  v_cvt_pk_bf16_f32 v201, v50, v51
  v_exp_f32 v53, v181
  v_mfma_f32_32x32x16_bf16 v[224:239], v[24:27], v[136:139], v[224:239]
  s_waitcnt lgkmcnt(5)
  ds_read_b64_tr_b16 v[20:21], v3 offset:8448
  ds_read_b64_tr_b16 v[22:23], v3 offset:10496
  v_add_f32 v13, v52, v13
  v_exp_f32 v54, v182
  v_add_f32 v13, v53, v13
  v_mfma_f32_32x32x16_bf16 v[224:239], v[28:31], v[140:143], v[224:239]
  s_waitcnt lgkmcnt(6)
  ds_read_b64_tr_b16 v[24:25], v3 offset:8704
  ds_read_b64_tr_b16 v[26:27], v3 offset:10752
  v_cvt_pk_bf16_f32 v202, v52, v53
  v_exp_f32 v55, v183
  v_add_f32 v13, v54, v13
  v_mfma_f32_32x32x16_bf16 v[224:239], v[32:35], v[144:147], v[224:239]
  s_waitcnt lgkmcnt(7)
  ds_read_b64_tr_b16 v[28:29], v3 offset:8960
  ds_read_b64_tr_b16 v[30:31], v3 offset:11008
  v_exp_f32 v48, v184
  v_add_f32 v13, v55, v13
  v_cvt_pk_bf16_f32 v203, v54, v55
  v_mfma_f32_32x32x16_bf16 v[224:239], v[36:39], v[148:151], v[224:239]
  s_waitcnt lgkmcnt(8)
  ds_read_b64_tr_b16 v[32:33], v3 offset:12288
  ds_read_b64_tr_b16 v[34:35], v3 offset:14336
  v_exp_f32 v49, v185
  v_add_f32 v13, v48, v13
  v_mfma_f32_32x32x16_bf16 v[224:239], v[40:43], v[152:155], v[224:239]
  s_waitcnt lgkmcnt(8)
  ds_read_b64_tr_b16 v[36:37], v3 offset:12544
  ds_read_b64_tr_b16 v[38:39], v3 offset:14592
  v_exp_f32 v50, v186
  v_add_f32 v13, v49, v13
  v_cvt_pk_bf16_f32 v204, v48, v49
  v_mfma_f32_32x32x16_bf16 v[224:239], v[44:47], v[156:159], v[224:239]
  s_waitcnt lgkmcnt(8)
  ds_read_b64_tr_b16 v[40:41], v3 offset:12800
  ds_read_b64_tr_b16 v[42:43], v3 offset:14848
  v_exp_f32 v51, v187
  v_add_f32 v13, v50, v13
  v_mfma_f32_32x32x16_bf16 v[64:79], v[16:19], v[192:195], v[64:79]
  s_waitcnt lgkmcnt(8)
  ds_read_b64_tr_b16 v[44:45], v3 offset:13056
  ds_read_b64_tr_b16 v[46:47], v3 offset:15104
  v_exp_f32 v52, v188
  v_add_f32 v13, v51, v13
  v_cvt_pk_bf16_f32 v205, v50, v51
  v_mfma_f32_32x32x16_bf16 v[80:95], v[20:23], v[192:195], v[80:95]
  s_waitcnt lgkmcnt(8)
  ds_read_b128 v[16:19], v1 offset:16384
  v_exp_f32 v53, v189
  v_add_f32 v13, v52, v13
  v_exp_f32 v54, v190
  v_mfma_f32_32x32x16_bf16 v[96:111], v[24:27], v[192:195], v[96:111]
  s_waitcnt lgkmcnt(7)
  ds_read_b128 v[20:23], v2 offset:16384
  v_add_f32 v13, v53, v13
  v_cvt_pk_bf16_f32 v206, v52, v53
  v_exp_f32 v55, v191
  v_add_f32 v13, v54, v13
  v_mfma_f32_32x32x16_bf16 v[112:127], v[28:31], v[192:195], v[112:127]
  s_waitcnt lgkmcnt(6)
  ds_read_b128 v[24:27], v1 offset:16640
  v_add_f32 v13, v55, v13
  v_cvt_pk_bf16_f32 v207, v54, v55
  v_cmp_nge_f32 vcc, s54, v13
  v_mfma_f32_32x32x16_bf16 v[64:79], v[32:35], v[196:199], v[64:79]
  s_cbranch_vccnz L_rare10
L_back10:
  ds_read_b128 v[28:31], v2 offset:16640
  v_add_f32 v12, v13, v12
  v_exp_f32 v48, v224
  v_exp_f32 v49, v225
  v_mfma_f32_32x32x16_bf16 v[80:95], v[36:39], v[196:199], v[80:95]
  s_waitcnt lgkmcnt(4)
  ds_read_b128 v[32:35], v1 offset:16896
  v_exp_f32 v50, v226
  v_add_f32 v60, v49, v48
  v_cvt_pk_bf16_f32 v240, v48, v49
  v_mfma_f32_32x32x16_bf16 v[96:111], v[40:43], v[196:199], v[96:111]
  s_waitcnt lgkmcnt(4)
  ds_read_b128 v[36:39], v2 offset:16896
  v_exp_f32 v51, v227
  v_add_f32 v60, v50, v60
  v_exp_f32 v52, v228
  v_mfma_f32_32x32x16_bf16 v[112:127], v[44:47], v[196:199], v[112:127]
  s_waitcnt lgkmcnt(4)
  ds_read_b128 v[40:43], v1 offset:17152
  v_add_f32 v60, v51, v60
  v_cvt_pk_bf16_f32 v241, v50, v51
  v_exp_f32 v53, v229
  v_add_f32 v60, v52, v60
  v_mfma_f32_32x32x16_bf16 v[160:175], v[16:19], v[128:131], v[208:223]
  s_waitcnt lgkmcnt(4)
  ds_read_b128 v[44:47], v2 offset:17152
  v_exp_f32 v54, v230
  v_add_f32 v60, v53, v60
  v_cvt_pk_bf16_f32 v242, v52, v53
  v_mfma_f32_32x32x16_bf16 v[160:175], v[20:23], v[132:135], v[160:175]
  s_waitcnt lgkmcnt(4)
  ds_read_b64_tr_b16 v[16:17], v3 offset:24576
  ds_read_b64_tr_b16 v[18:19], v3 offset:26624
  v_exp_f32 v55, v231
  v_add_f32 v60, v54, v60
  v_mfma_f32_32x32x16_bf16 v[160:175], v[24:27], v[136:139], v[160:175]
  s_waitcnt lgkmcnt(5)
  ds_read_b64_tr_b16 v[20:21], v3 offset:24832
  ds_read_b64_tr_b16 v[22:23], v3 offset:26880
  v_exp_f32 v48, v232
  v_add_f32 v60, v55, v60
  v_cvt_pk_bf16_f32 v243, v54, v55
  v_mfma_f32_32x32x16_bf16 v[160:175], v[28:31], v[140:143], v[160:175]
  s_waitcnt lgkmcnt(6)
  ds_read_b64_tr_b16 v[24:25], v3 offset:25088
  ds_read_b64_tr_b16 v[26:27], v3 offset:27136
  v_exp_f32 v49, v233
  v_add_f32 v60, v48, v60
  v_mfma_f32_32x32x16_bf16 v[160:175], v[32:35], v[144:147], v[160:175]
  s_waitcnt lgkmcnt(7)
  ds_read_b64_tr_b16 v[28:29], v3 offset:25344
  ds_read_b64_tr_b16 v[30:31], v3 offset:27392
  v_exp_f32 v50, v234
  v_add_f32 v60, v49, v60
  v_cvt_pk_bf16_f32 v244, v48, v49
  v_mfma_f32_32x32x16_bf16 v[160:175], v[36:39], v[148:151], v[160:175]
  s_waitcnt lgkmcnt(8)
  ds_read_b64_tr_b16 v[32:33], v3 offset:28672
  ds_read_b64_tr_b16 v[34:35], v3 offset:30720
  v_exp_f32 v51, v235
  v_add_f32 v60, v50, v60
  v_mfma_f32_32x32x16_bf16 v[160:175], v[40:43], v[152:155], v[160:175]
  s_waitcnt lgkmcnt(8)
  ds_read_b64_tr_b16 v[36:37], v3 offset:28928
  ds_read_b64_tr_b16 v[38:39], v3 offset:30976
  v_exp_f32 v52, v236
  v_add_f32 v60, v51, v60
  v_cvt_pk_bf16_f32 v245, v50, v51
  v_mfma_f32_32x32x16_bf16 v[160:175], v[44:47], v[156:159], v[160:175]
  s_waitcnt lgkmcnt(8)
  ds_read_b64_tr_b16 v[40:41], v3 offset:29184
  ds_read_b64_tr_b16 v[42:43], v3 offset:31232
  v_exp_f32 v53, v237
  v_add_f32 v60, v52, v60
  v_mfma_f32_32x32x16_bf16 v[64:79], v[16:19], v[200:203], v[64:79]
  s_waitcnt lgkmcnt(8)
  ds_read_b64_tr_b16 v[44:45], v3 offset:29440
  ds_read_b64_tr_b16 v[46:47], v3 offset:31488
  v_exp_f32 v54, v238
  v_add_f32 v60, v53, v60
  v_cvt_pk_bf16_f32 v246, v52, v53
  v_mfma_f32_32x32x16_bf16 v[80:95], v[20:23], v[200:203], v[80:95]
  s_waitcnt lgkmcnt(8)
  v_add_u32 v1, 81920, v5
  v_exp_f32 v55, v239
  v_add_f32 v60, v54, v60
  v_add_f32 v60, v55, v60
  v_cvt_pk_bf16_f32 v247, v54, v55
  v_mfma_f32_32x32x16_bf16 v[96:111], v[24:27], v[200:203], v[96:111]
  s_waitcnt lgkmcnt(6)
  v_add_u32 v3, 81920, v7
  v_cmp_nge_f32 vcc, s54, v60
  v_mfma_f32_32x32x16_bf16 v[112:127], v[28:31], v[200:203], v[112:127]
  s_cbranch_vccnz L_rare11
L_back11:
  v_xor_b32 v2, 32, v1
  v_add_f32 v12, v60, v12
  v_exp_f32 v48, v160
  v_exp_f32 v49, v161
  v_mfma_f32_32x32x16_bf16 v[64:79], v[32:35], v[204:207], v[64:79]
  s_waitcnt lgkmcnt(0)
  s_barrier
  ds_read_b128 v[16:19], v1 offset:0
  ds_read_b128 v[20:23], v2 offset:0
  v_exp_f32 v50, v162
  v_add_f32 v13, v49, v48
  v_mfma_f32_32x32x16_bf16 v[80:95], v[36:39], v[204:207], v[80:95]
  ds_read_b128 v[24:27], v1 offset:256
  ds_read_b128 v[28:31], v2 offset:256
  ds_read_b128 v[32:35], v1 offset:512
  v_cvt_pk_bf16_f32 v192, v48, v49
  v_exp_f32 v51, v163
  v_mfma_f32_32x32x16_bf16 v[96:111], v[40:43], v[204:207], v[96:111]
  ds_read_b128 v[36:39], v2 offset:512
  v_add_f32 v13, v50, v13
  v_exp_f32 v52, v164
  v_add_f32 v13, v51, v13
  v_cvt_pk_bf16_f32 v193, v50, v51
  v_mfma_f32_32x32x16_bf16 v[112:127], v[44:47], v[204:207], v[112:127]
  s_waitcnt lgkmcnt(4)
  ds_read_b128 v[40:43], v1 offset:768
  v_exp_f32 v53, v165
  v_add_f32 v13, v52, v13
  v_exp_f32 v54, v166
  v_mfma_f32_32x32x16_bf16 v[176:191], v[16:19], v[128:131], v[208:223]
  s_waitcnt lgkmcnt(4)
  ds_read_b128 v[44:47], v2 offset:768
  v_add_f32 v13, v53, v13
  v_cvt_pk_bf16_f32 v194, v52, v53
  v_exp_f32 v55, v167
  v_add_f32 v13, v54, v13
  v_mfma_f32_32x32x16_bf16 v[176:191], v[20:23], v[132:135], v[176:191]
  s_waitcnt lgkmcnt(4)
  ds_read_b64_tr_b16 v[16:17], v3 offset:8192
  ds_read_b64_tr_b16 v[18:19], v3 offset:10240
  v_exp_f32 v48, v168
  v_add_f32 v13, v55, v13
  v_cvt_pk_bf16_f32 v195, v54, v55
  v_mfma_f32_32x32x16_bf16 v[176:191], v[24:27], v[136:139], v[176:191]
  s_waitcnt lgkmcnt(5)
  ds_read_b64_tr_b16 v[20:21], v3 offset:8448
  ds_read_b64_tr_b16 v[22:23], v3 offset:10496
  v_exp_f32 v49, v169
  v_add_f32 v13, v48, v13
  v_mfma_f32_32x32x16_bf16 v[176:191], v[28:31], v[140:143], v[176:191]
  s_waitcnt lgkmcnt(6)
  ds_read_b64_tr_b16 v[24:25], v3 offset:8704
  ds_read_b64_tr_b16 v[26:27], v3 offset:10752
  v_exp_f32 v50, v170
  v_add_f32 v13, v49, v13
  v_cvt_pk_bf16_f32 v196, v48, v49
  v_mfma_f32_32x32x16_bf16 v[176:191], v[32:35], v[144:147], v[176:191]
  s_waitcnt lgkmcnt(7)
  ds_read_b64_tr_b16 v[28:29], v3 offset:8960
  ds_read_b64_tr_b16 v[30:31], v3 offset:11008
  v_exp_f32 v51, v171
  v_add_f32 v13, v50, v13
  v_mfma_f32_32x32x16_bf16 v[176:191], v[36:39], v[148:151], v[176:191]
  s_waitcnt lgkmcnt(8)
  ds_read_b64_tr_b16 v[32:33], v3 offset:12288
  ds_read_b64_tr_b16 v[34:35], v3 offset:14336
  v_exp_f32 v52, v172
  v_add_f32 v13, v51, v13
  v_cvt_pk_bf16_f32 v197, v50, v51
  v_mfma_f32_32x32x16_bf16 v[176:191], v[40:43], v[152:155], v[176:191]
  s_waitcnt lgkmcnt(8)
  ds_read_b64_tr_b16 v[36:37], v3 offset:12544
  ds_read_b64_tr_b16 v[38:39], v3 offset:14592
  v_exp_f32 v53, v173
  v_add_f32 v13, v52, v13
  v_mfma_f32_32x32x16_bf16 v[176:191], v[44:47], v[156:159], v[176:191]
  s_waitcnt lgkmcnt(8)
  ds_read_b64_tr_b16 v[40:41], v3 offset:12800
  ds_read_b64_tr_b16 v[42:43], v3 offset:14848
  v_exp_f32 v54, v174
  v_add_f32 v13, v53, v13
  v_cvt_pk_bf16_f32 v198, v52, v53
  v_mfma_f32_32x32x16_bf16 v[64:79], v[16:19], v[240:243], v[64:79]
  s_waitcnt lgkmcnt(8)
  ds_read_b64_tr_b16 v[44:45], v3 offset:13056
  ds_read_b64_tr_b16 v[46:47], v3 offset:15104
  v_exp_f32 v55, v175
  v_add_f32 v13, v54, v13
  v_add_f32 v13, v55, v13
  v_mfma_f32_32x32x16_bf16 v[80:95], v[20:23], v[240:243], v[80:95]
  s_waitcnt lgkmcnt(8)
  ds_read_b128 v[16:19], v1 offset:16384
  v_cvt_pk_bf16_f32 v199, v54, v55
  v_cmp_nge_f32 vcc, s54, v13
  v_mfma_f32_32x32x16_bf16 v[96:111], v[24:27], v[240:243], v[96:111]
  s_cbranch_vccnz L_rare12
L_back12:
  ds_read_b128 v[20:23], v2 offset:16384
  v_add_f32 v12, v13, v12
  v_exp_f32 v48, v176
  v_exp_f32 v49, v177
  v_mfma_f32_32x32x16_bf16 v[112:127], v[28:31], v[240:243], v[112:127]
  s_waitcnt lgkmcnt(6)
  ds_read_b128 v[24:27], v1 offset:16640
  v_exp_f32 v50, v178
  v_add_f32 v60, v49, v48
  v_cvt_pk_bf16_f32 v200, v48, v49
  v_mfma_f32_32x32x16_bf16 v[64:79], v[32:35], v[244:247], v[64:79]
  s_waitcnt lgkmcnt(5)
  ds_read_b128 v[28:31], v2 offset:16640
  v_exp_f32 v51, v179
  v_add_f32 v60, v50, v60
  v_exp_f32 v52, v180
  v_mfma_f32_32x32x16_bf16 v[80:95], v[36:39], v[244:247], v[80:95]
  s_waitcnt lgkmcnt(4)
  ds_read_b128 v[32:35], v1 offset:16896
  v_add_f32 v60, v51, v60
  v_cvt_pk_bf16_f32 v201, v50, v51
  v_exp_f32 v53, v181
  v_add_f32 v60, v52, v60
  v_mfma_f32_32x32x16_bf16 v[96:111], v[40:43], v[244:247], v[96:111]
  s_waitcnt lgkmcnt(4)
  ds_read_b128 v[36:39], v2 offset:16896
  v_exp_f32 v54, v182
  v_add_f32 v60, v53, v60
  v_cvt_pk_bf16_f32 v202, v52, v53
  v_mfma_f32_32x32x16_bf16 v[112:127], v[44:47], v[244:247], v[112:127]
  s_waitcnt lgkmcnt(4)
  ds_read_b128 v[40:43], v1 offset:17152
  v_exp_f32 v55, v183
  v_add_f32 v60, v54, v60
  v_exp_f32 v48, v184
  v_mfma_f32_32x32x16_bf16 v[224:239], v[16:19], v[128:131], v[208:223]
  s_waitcnt lgkmcnt(4)
  ds_read_b128 v[44:47], v2 offset:17152
  v_add_f32 v60, v55, v60
  v_cvt_pk_bf16_f32 v203, v54, v55
  v_exp_f32 v49, v185
  v_add_f32 v60, v48, v60
  v_mfma_f32_32x32x16_bf16 v[224:239], v[20:23], v[132:135], v[224:239]
  s_waitcnt lgkmcnt(4)
  ds_read_b64_tr_b16 v[16:17], v3 offset:24576
  ds_read_b64_tr_b16 v[18:19], v3 offset:26624
  v_exp_f32 v50, v186
  v_add_f32 v60, v49, v60
  v_cvt_pk_bf16_f32 v204, v48, v49
  v_mfma_f32_32x32x16_bf16 v[224:239], v[24:27], v[136:139], v[224:239]
  s_waitcnt lgkmcnt(5)
  ds_read_b64_tr_b16 v[20:21], v3 offset:24832
  ds_read_b64_tr_b16 v[22:23], v3 offset:26880
  v_exp_f32 v51, v187
  v_add_f32 v60, v50, v60
  v_mfma_f32_32x32x16_bf16 v[224:239], v[28:31], v[140:143], v[224:239]
  s_waitcnt lgkmcnt(6)
  ds_read_b64_tr_b16 v[24:25], v3 offset:25088
  ds_read_b64_tr_b16 v[26:27], v3 offset:27136
  v_exp_f32 v52, v188
  v_add_f32 v60, v51, v60
  v_cvt_pk_bf16_f32 v205, v50, v51
  v_mfma_f32_32x32x16_bf16 v[224:239], v[32:35], v[144:147], v[224:239]
  s_waitcnt lgkmcnt(7)
  ds_read_b64_tr_b16 v[28:29], v3 offset:25344
  ds_read_b64_tr_b16 v[30:31], v3 offset:27392
  v_exp_f32 v53, v189
  v_add_f32 v60, v52, v60
  v_mfma_f32_32x32x16_bf16 v[224:239], v[36:39], v[148:151], v[224:239]
  s_waitcnt lgkmcnt(8)
  ds_read_b64_tr_b16 v[32:33], v3 offset:28672
  ds_read_b64_tr_b16 v[34:35], v3 offset:30720
  v_exp_f32 v54, v190
  v_add_f32 v60, v53, v60
  v_cvt_pk_bf16_f32 v206, v52, v53
  v_mfma_f32_32x32x16_bf16 v[224:239], v[40:43], v[152:155], v[224:239]
  s_waitcnt lgkmcnt(8)
  ds_read_b64_tr_b16 v[36:37], v3 offset:28928
  ds_read_b64_tr_b16 v[38:39], v3 offset:30976
  v_exp_f32 v55, v191
  v_add_f32 v60, v54, v60
  v_add_f32 v60, v55, v60
  v_mfma_f32_32x32x16_bf16 v[224:239], v[44:47], v[156:159], v[224:239]
  s_waitcnt lgkmcnt(8)
  ds_read_b64_tr_b16 v[40:41], v3 offset:29184
  ds_read_b64_tr_b16 v[42:43], v3 offset:31232
  v_cvt_pk_bf16_f32 v207, v54, v55
  v_cmp_nge_f32 vcc, s54, v60
  v_mfma_f32_32x32x16_bf16 v[64:79], v[16:19], v[192:195], v[64:79]
  s_cbranch_vccnz L_rare13
L_back13:
  ds_read_b64_tr_b16 v[44:45], v3 offset:29440
  ds_read_b64_tr_b16 v[46:47], v3 offset:31488
  v_add_f32 v12, v60, v12
  v_mfma_f32_32x32x16_bf16 v[80:95], v[20:23], v[192:195], v[80:95]
  s_waitcnt lgkmcnt(8)
  v_add_u32 v1, 122880, v5
  v_exp_f32 v48, v224
  v_exp_f32 v49, v225
  v_mfma_f32_32x32x16_bf16 v[96:111], v[24:27], v[192:195], v[96:111]
  s_waitcnt lgkmcnt(6)
  v_add_u32 v3, 122880, v7
  v_exp_f32 v50, v226
  v_add_f32 v13, v49, v48
  v_cvt_pk_bf16_f32 v240, v48, v49
  v_mfma_f32_32x32x16_bf16 v[112:127], v[28:31], v[192:195], v[112:127]
  s_waitcnt lgkmcnt(4)
  v_xor_b32 v2, 32, v1
  v_exp_f32 v51, v227
  v_add_f32 v13, v50, v13
  v_exp_f32 v52, v228
  v_mfma_f32_32x32x16_bf16 v[64:79], v[32:35], v[196:199], v[64:79]
  s_waitcnt lgkmcnt(0)
  s_barrier
  ds_read_b128 v[16:19], v1 offset:0
  ds_read_b128 v[20:23], v2 offset:0
  v_add_f32 v13, v51, v13
  v_cvt_pk_bf16_f32 v241, v50, v51
  v_mfma_f32_32x32x16_bf16 v[80:95], v[36:39], v[196:199], v[80:95]
  ds_read_b128 v[24:27], v1 offset:256
  ds_read_b128 v[28:31], v2 offset:256
  ds_read_b128 v[32:35], v1 offset:512
  v_exp_f32 v53, v229
  v_add_f32 v13, v52, v13
  v_mfma_f32_32x32x16_bf16 v[96:111], v[40:43], v[196:199], v[96:111]
  ds_read_b128 v[36:39], v2 offset:512
  v_exp_f32 v54, v230
  v_add_f32 v13, v53, v13
  v_cvt_pk_bf16_f32 v242, v52, v53
  v_mfma_f32_32x32x16_bf16 v[112:127], v[44:47], v[196:199], v[112:127]
  s_waitcnt lgkmcnt(4)
  ds_read_b128 v[40:43], v1 offset:768
  v_exp_f32 v55, v231
  v_add_f32 v13, v54, v13
  v_exp_f32 v48, v232
  v_mfma_f32_32x32x16_bf16 v[160:175], v[16:19], v[128:131], v[208:223]
  s_waitcnt lgkmcnt(4)
  ds_read_b128 v[44:47], v2 offset:768
  v_add_f32 v13, v55, v13
  v_cvt_pk_bf16_f32 v243, v54, v55
  v_exp_f32 v49, v233
  v_add_f32 v13, v48, v13
  v_mfma_f32_32x32x16_bf16 v[160:175], v[20:23], v[132:135], v[160:175]
  s_waitcnt lgkmcnt(4)
  ds_read_b64_tr_b16 v[16:17], v3 offset:8192
  ds_read_b64_tr_b16 v[18:19], v3 offset:10240
  v_exp_f32 v50, v234
  v_add_f32 v13, v49, v13
  v_cvt_pk_bf16_f32 v244, v48, v49
  v_mfma_f32_32x32x16_bf16 v[160:175], v[24:27], v[136:139], v[160:175]
  s_waitcnt lgkmcnt(5)
  ds_read_b64_tr_b16 v[20:21], v3 offset:8448
  ds_read_b64_tr_b16 v[22:23], v3 offset:10496
  v_exp_f32 v51, v235
  v_add_f32 v13, v50, v13
  v_mfma_f32_32x32x16_bf16 v[160:175], v[28:31], v[140:143], v[160:175]
  s_waitcnt lgkmcnt(6)
  ds_read_b64_tr_b16 v[24:25], v3 offset:8704
  ds_read_b64_tr_b16 v[26:27], v3 offset:10752
  v_exp_f32 v52, v236
  v_add_f32 v13, v51, v13
  v_cvt_pk_bf16_f32 v245, v50, v51
  v_mfma_f32_32x32x16_bf16 v[160:175], v[32:35], v[144:147], v[160:175]
  s_waitcnt lgkmcnt(7)
  ds_read_b64_tr_b16 v[28:29], v3 offset:8960
  ds_read_b64_tr_b16 v[30:31], v3 offset:11008
  v_exp_f32 v53, v237
  v_add_f32 v13, v52, v13
  v_mfma_f32_32x32x16_bf16 v[160:175], v[36:39], v[148:151], v[160:175]
  s_waitcnt lgkmcnt(8)
  ds_read_b64_tr_b16 v[32:33], v3 offset:12288
  ds_read_b64_tr_b16 v[34:35], v3 offset:14336
  v_exp_f32 v54, v238
  v_add_f32 v13, v53, v13
  v_cvt_pk_bf16_f32 v246, v52, v53
  v_mfma_f32_32x32x16_bf16 v[160:175], v[40:43], v[152:155], v[160:175]
  s_waitcnt lgkmcnt(8)
  ds_read_b64_tr_b16 v[36:37], v3 offset:12544
  ds_read_b64_tr_b16 v[38:39], v3 offset:14592
  v_exp_f32 v55, v239
  v_add_f32 v13, v54, v13
  v_add_f32 v13, v55, v13
  v_mfma_f32_32x32x16_bf16 v[160:175], v[44:47], v[156:159], v[160:175]
  s_waitcnt lgkmcnt(8)
  ds_read_b64_tr_b16 v[40:41], v3 offset:12800
  ds_read_b64_tr_b16 v[42:43], v3 offset:14848
  v_cvt_pk_bf16_f32 v247, v54, v55
  v_cmp_nge_f32 vcc, s54, v13
  v_mfma_f32_32x32x16_bf16 v[64:79], v[16:19], v[200:203], v[64:79]
  s_cbranch_vccnz L_rare14
L_back14:
  ds_read_b64_tr_b16 v[44:45], v3 offset:13056
  ds_read_b64_tr_b16 v[46:47], v3 offset:15104
  v_add_f32 v12, v13, v12
  v_mfma_f32_32x32x16_bf16 v[80:95], v[20:23], v[200:203], v[80:95]
  s_waitcnt lgkmcnt(8)
  ds_read_b64_tr_b16 v[16:17], v3 offset:16384
  ds_read_b64_tr_b16 v[18:19], v3 offset:18432
  v_exp_f32 v48, v160
  v_exp_f32 v49, v161
  v_mfma_f32_32x32x16_bf16 v[96:111], v[24:27], v[200:203], v[96:111]
  s_waitcnt lgkmcnt(8)
  ds_read_b64_tr_b16 v[20:21], v3 offset:16640
  ds_read_b64_tr_b16 v[22:23], v3 offset:18688
  v_exp_f32 v50, v162
  v_add_f32 v60, v49, v48
  v_cvt_pk_bf16_f32 v192, v48, v49
  v_mfma_f32_32x32x16_bf16 v[112:127], v[28:31], v[200:203], v[112:127]
  s_waitcnt lgkmcnt(8)
  ds_read_b64_tr_b16 v[24:25], v3 offset:16896
  ds_read_b64_tr_b16 v[26:27], v3 offset:18944
  v_exp_f32 v51, v163
  v_add_f32 v60, v50, v60
  v_mfma_f32_32x32x16_bf16 v[64:79], v[32:35], v[204:207], v[64:79]
  s_waitcnt lgkmcnt(8)
  ds_read_b64_tr_b16 v[28:29], v3 offset:17152
  ds_read_b64_tr_b16 v[30:31], v3 offset:19200
  v_exp_f32 v52, v164
  v_add_f32 v60, v51, v60
  v_cvt_pk_bf16_f32 v193, v50, v51
  v_mfma_f32_32x32x16_bf16 v[80:95], v[36:39], v[204:207], v[80:95]
  s_waitcnt lgkmcnt(8)
  ds_read_b64_tr_b16 v[32:33], v3 offset:20480
  ds_read_b64_tr_b16 v[34:35], v3 offset:22528
  v_exp_f32 v53, v165
  v_add_f32 v60, v52, v60
  v_mfma_f32_32x32x16_bf16 v[96:111], v[40:43], v[204:207], v[96:111]
  s_waitcnt lgkmcnt(8)
  ds_read_b64_tr_b16 v[36:37], v3 offset:20736
  ds_read_b64_tr_b16 v[38:39], v3 offset:22784
  v_exp_f32 v54, v166
  v_add_f32 v60, v53, v60
  v_cvt_pk_bf16_f32 v194, v52, v53
  v_mfma_f32_32x32x16_bf16 v[112:127], v[44:47], v[204:207], v[112:127]
  s_waitcnt lgkmcnt(8)
  ds_read_b64_tr_b16 v[40:41], v3 offset:20992
  ds_read_b64_tr_b16 v[42:43], v3 offset:23040
  v_exp_f32 v55, v167
  v_add_f32 v60, v54, v60
  v_mfma_f32_32x32x16_bf16 v[64:79], v[16:19], v[240:243], v[64:79]
  s_waitcnt lgkmcnt(8)
  ds_read_b64_tr_b16 v[44:45], v3 offset:21248
  ds_read_b64_tr_b16 v[46:47], v3 offset:23296
  v_exp_f32 v48, v168
  v_add_f32 v60, v55, v60
  v_cvt_pk_bf16_f32 v195, v54, v55
  v_mfma_f32_32x32x16_bf16 v[80:95], v[20:23], v[240:243], v[80:95]
  s_waitcnt lgkmcnt(8)
  ds_read_b64_tr_b16 v[16:17], v3 offset:24576
  ds_read_b64_tr_b16 v[18:19], v3 offset:26624
  v_exp_f32 v49, v169
  v_add_f32 v60, v48, v60
  v_mfma_f32_32x32x16_bf16 v[96:111], v[24:27], v[240:243], v[96:111]
  s_waitcnt lgkmcnt(8)
  ds_read_b64_tr_b16 v[20:21], v3 offset:28672
  ds_read_b64_tr_b16 v[22:23], v3 offset:30720
  v_exp_f32 v50, v170
  v_add_f32 v60, v49, v60
  v_cvt_pk_bf16_f32 v196, v48, v49
  v_mfma_f32_32x32x16_bf16 v[112:127], v[28:31], v[240:243], v[112:127]
  s_waitcnt lgkmcnt(8)
  ds_read_b64_tr_b16 v[24:25], v3 offset:24832
  ds_read_b64_tr_b16 v[26:27], v3 offset:26880
  v_exp_f32 v51, v171
  v_add_f32 v60, v50, v60
  v_mfma_f32_32x32x16_bf16 v[64:79], v[32:35], v[244:247], v[64:79]
  s_waitcnt lgkmcnt(8)
  ds_read_b64_tr_b16 v[28:29], v3 offset:28928
  ds_read_b64_tr_b16 v[30:31], v3 offset:30976
  v_exp_f32 v52, v172
  v_add_f32 v60, v51, v60
  v_cvt_pk_bf16_f32 v197, v50, v51
  v_mfma_f32_32x32x16_bf16 v[80:95], v[36:39], v[244:247], v[80:95]
  s_waitcnt lgkmcnt(8)
  ds_read_b64_tr_b16 v[32:33], v3 offset:25088
  ds_read_b64_tr_b16 v[34:35], v3 offset:27136
  v_exp_f32 v53, v173
  v_add_f32 v60, v52, v60
  v_mfma_f32_32x32x16_bf16 v[96:111], v[40:43], v[244:247], v[96:111]
  s_waitcnt lgkmcnt(8)
  ds_read_b64_tr_b16 v[36:37], v3 offset:29184
  ds_read_b64_tr_b16 v[38:39], v3 offset:31232
  v_exp_f32 v54, v174
  v_add_f32 v60, v53, v60
  v_cvt_pk_bf16_f32 v198, v52, v53
  v_mfma_f32_32x32x16_bf16 v[112:127], v[44:47], v[244:247], v[112:127]
  s_waitcnt lgkmcnt(8)
  ds_read_b64_tr_b16 v[40:41], v3 offset:25344
  ds_read_b64_tr_b16 v[42:43], v3 offset:27392
  v_exp_f32 v55, v175
  v_add_f32 v60, v54, v60
  v_add_f32 v60, v55, v60
  v_cvt_pk_bf16_f32 v199, v54, v55
  v_cmp_nge_f32 vcc, s54, v60
  s_cbranch_vccnz L_rare15
L_back15:
  v_mfma_f32_32x32x16_bf16 v[64:79], v[16:19], v[192:195], v[64:79]
  s_waitcnt lgkmcnt(8)
  ds_read_b64_tr_b16 v[44:45], v3 offset:29440
  ds_read_b64_tr_b16 v[46:47], v3 offset:31488
  v_add_f32 v12, v60, v12
  v_mov_b32 v14, v12
  s_nop 0
  s_nop 0
  v_mfma_f32_32x32x16_bf16 v[64:79], v[20:23], v[196:199], v[64:79]
  s_waitcnt lgkmcnt(8)
  v_permlane32_swap_b32 v12, v14
  v_add_f32 v12, v12, v14
  v_rcp_f32 v12, v12
  v_mfma_f32_32x32x16_bf16 v[80:95], v[24:27], v[192:195], v[80:95]
  s_waitcnt lgkmcnt(6)
  v_mfma_f32_32x32x16_bf16 v[80:95], v[28:31], v[196:199], v[80:95]
  s_waitcnt lgkmcnt(4)
  v_mul_f32 v64, v12, v64
  v_mul_f32 v65, v12, v65
  v_mul_f32 v66, v12, v66
  v_mul_f32 v67, v12, v67
  v_mul_f32 v68, v12, v68
  v_mul_f32 v69, v12, v69
  v_mfma_f32_32x32x16_bf16 v[96:111], v[32:35], v[192:195], v[96:111]
  s_waitcnt lgkmcnt(2)
  v_mul_f32 v70, v12, v70
  v_mul_f32 v71, v12, v71
  v_cvt_pk_bf16_f32 v128, v64, v65
  v_cvt_pk_bf16_f32 v129, v66, v67
  v_cvt_pk_bf16_f32 v130, v68, v69
  v_cvt_pk_bf16_f32 v131, v70, v71
  v_mfma_f32_32x32x16_bf16 v[96:111], v[36:39], v[196:199], v[96:111]
  s_waitcnt lgkmcnt(0)
  ds_write_b128 v9, v[128:131] offset:0
  v_mul_f32 v72, v12, v72
  v_mul_f32 v73, v12, v73
  v_mul_f32 v74, v12, v74
  v_mfma_f32_32x32x16_bf16 v[112:127], v[40:43], v[192:195], v[112:127]
  v_mul_f32 v75, v12, v75
  v_mul_f32 v76, v12, v76
  v_mul_f32 v77, v12, v77
  v_mul_f32 v78, v12, v78
  v_mul_f32 v79, v12, v79
  v_cvt_pk_bf16_f32 v132, v72, v73
  v_mfma_f32_32x32x16_bf16 v[112:127], v[44:47], v[196:199], v[112:127]
  v_cvt_pk_bf16_f32 v133, v74, v75
  v_cvt_pk_bf16_f32 v134, v76, v77
  v_cvt_pk_bf16_f32 v135, v78, v79
  ds_write_b128 v9, v[132:135] offset:1024
  v_pk_mul_f32 v[80:81], v[80:81], v[12:13] op_sel_hi:[1,0]
  v_pk_mul_f32 v[82:83], v[82:83], v[12:13] op_sel_hi:[1,0]
  v_pk_mul_f32 v[84:85], v[84:85], v[12:13] op_sel_hi:[1,0]
  v_pk_mul_f32 v[86:87], v[86:87], v[12:13] op_sel_hi:[1,0]
  v_cvt_pk_bf16_f32 v136, v80, v81
  v_cvt_pk_bf16_f32 v137, v82, v83
  v_cvt_pk_bf16_f32 v138, v84, v85
  v_cvt_pk_bf16_f32 v139, v86, v87
  ds_write_b128 v9, v[136:139] offset:2048
  v_pk_mul_f32 v[88:89], v[88:89], v[12:13] op_sel_hi:[1,0]
  v_pk_mul_f32 v[90:91], v[90:91], v[12:13] op_sel_hi:[1,0]
  v_pk_mul_f32 v[92:93], v[92:93], v[12:13] op_sel_hi:[1,0]
  v_pk_mul_f32 v[94:95], v[94:95], v[12:13] op_sel_hi:[1,0]
  v_cvt_pk_bf16_f32 v140, v88, v89
  v_cvt_pk_bf16_f32 v141, v90, v91
  v_cvt_pk_bf16_f32 v142, v92, v93
  v_cvt_pk_bf16_f32 v143, v94, v95
  ds_write_b128 v9, v[140:143] offset:3072
  v_pk_mul_f32 v[96:97], v[96:97], v[12:13] op_sel_hi:[1,0]
  v_pk_mul_f32 v[98:99], v[98:99], v[12:13] op_sel_hi:[1,0]
  v_pk_mul_f32 v[100:101], v[100:101], v[12:13] op_sel_hi:[1,0]
  v_pk_mul_f32 v[102:103], v[102:103], v[12:13] op_sel_hi:[1,0]
  v_cvt_pk_bf16_f32 v144, v96, v97
  v_cvt_pk_bf16_f32 v145, v98, v99
  v_cvt_pk_bf16_f32 v146, v100, v101
L_stub3:
  s_cbranch_execz L_warm_ret
  v_cvt_pk_bf16_f32 v147, v102, v103
  ds_write_b128 v9, v[144:147] offset:4096
  v_pk_mul_f32 v[104:105], v[104:105], v[12:13] op_sel_hi:[1,0]
  v_pk_mul_f32 v[106:107], v[106:107], v[12:13] op_sel_hi:[1,0]
  v_pk_mul_f32 v[108:109], v[108:109], v[12:13] op_sel_hi:[1,0]
  v_pk_mul_f32 v[110:111], v[110:111], v[12:13] op_sel_hi:[1,0]
  v_cvt_pk_bf16_f32 v148, v104, v105
  v_cvt_pk_bf16_f32 v149, v106, v107
  v_cvt_pk_bf16_f32 v150, v108, v109
  v_cvt_pk_bf16_f32 v151, v110, v111
  ds_write_b128 v9, v[148:151] offset:5120
  v_pk_mul_f32 v[112:113], v[112:113], v[12:13] op_sel_hi:[1,0]
  v_pk_mul_f32 v[114:115], v[114:115], v[12:13] op_sel_hi:[1,0]
  v_pk_mul_f32 v[116:117], v[116:117], v[12:13] op_sel_hi:[1,0]
  v_pk_mul_f32 v[118:119], v[118:119], v[12:13] op_sel_hi:[1,0]
  v_cvt_pk_bf16_f32 v152, v112, v113
  v_cvt_pk_bf16_f32 v153, v114, v115
  v_cvt_pk_bf16_f32 v154, v116, v117
  v_cvt_pk_bf16_f32 v155, v118, v119
  ds_write_b128 v9, v[152:155] offset:6144
  v_pk_mul_f32 v[120:121], v[120:121], v[12:13] op_sel_hi:[1,0]
  v_pk_mul_f32 v[122:123], v[122:123], v[12:13] op_sel_hi:[1,0]
  v_pk_mul_f32 v[124:125], v[124:125], v[12:13] op_sel_hi:[1,0]
  v_pk_mul_f32 v[126:127], v[126:127], v[12:13] op_sel_hi:[1,0]
  v_cvt_pk_bf16_f32 v156, v120, v121
  v_cvt_pk_bf16_f32 v157, v122, v123
  v_cvt_pk_bf16_f32 v158, v124, v125
  v_cvt_pk_bf16_f32 v159, v126, v127
  ds_write_b128 v9, v[156:159] offset:7168
  s_mov_b32 s44, 0
  s_xor_b32 s44, s44, 1
  s_mul_i32 s44, s44, 81920
  s_add_u32 s44, s44, 32768
  v_and_b32 v15, 63, v0
  v_lshlrev_b32 v15, 4, v15
  v_add_u32 v1, s44, v15
  s_waitcnt lgkmcnt(0)
  s_barrier
  v_add_u32 v3, 0, v8
  ds_read_b64_tr_b16 v[16:17], v3 offset:0
  ds_read_b64_tr_b16 v[18:19], v3 offset:2048
  ds_read_b128 v[128:131], v10 offset:0
  ds_read_b128 v[160:163], v10 offset:40960
  ds_read_b64_tr_b16 v[20:21], v3 offset:4096
  ds_read_b64_tr_b16 v[22:23], v3 offset:6144
  ds_read_b128 v[132:135], v10 offset:1024
  ds_read_b128 v[164:167], v10 offset:41984
  ds_read_b64_tr_b16 v[24:25], v3 offset:8192
  ds_read_b64_tr_b16 v[26:27], v3 offset:10240
  ds_read_b128 v[136:139], v10 offset:2048
  ds_read_b128 v[168:171], v10 offset:43008
  ds_read_b64_tr_b16 v[28:29], v3 offset:12288
  ds_read_b64_tr_b16 v[30:31], v3 offset:14336
  s_waitcnt lgkmcnt(11)
  v_mfma_f32_32x32x16_bf16 v[64:79], v[16:19], v[128:131], 0
  s_waitcnt lgkmcnt(10)
  ds_read_b128 v[140:143], v10 offset:3072
  v_mfma_f32_32x32x16_bf16 v[80:95], v[16:19], v[160:163], 0
  s_waitcnt lgkmcnt(8)
  ds_read_b128 v[172:175], v10 offset:44032
  ds_read_b64_tr_b16 v[32:33], v3 offset:16384
  ds_read_b64_tr_b16 v[34:35], v3 offset:18432
  v_mfma_f32_32x32x16_bf16 v[64:79], v[20:23], v[132:135], v[64:79]
  s_waitcnt lgkmcnt(7)
  ds_read_b128 v[144:147], v10 offset:4096
  v_mfma_f32_32x32x16_bf16 v[80:95], v[20:23], v[164:167], v[80:95]
  s_waitcnt lgkmcnt(7)
  ds_read_b128 v[176:179], v10 offset:45056
  ds_read_b64_tr_b16 v[36:37], v3 offset:20480
  ds_read_b64_tr_b16 v[38:39], v3 offset:22528
  v_mfma_f32_32x32x16_bf16 v[64:79], v[24:27], v[136:139], v[64:79]
  s_waitcnt lgkmcnt(7)
  ds_read_b128 v[148:151], v10 offset:5120
  v_mfma_f32_32x32x16_bf16 v[80:95], v[24:27], v[168:171], v[80:95]
  s_waitcnt lgkmcnt(7)
  ds_read_b128 v[180:183], v10 offset:46080
  ds_read_b64_tr_b16 v[40:41], v3 offset:24576
  ds_read_b64_tr_b16 v[42:43], v3 offset:26624
  v_mfma_f32_32x32x16_bf16 v[64:79], v[28:31], v[140:143], v[64:79]
  s_waitcnt lgkmcnt(7)
  ds_read_b128 v[152:155], v10 offset:6144
  v_mfma_f32_32x32x16_bf16 v[80:95], v[28:31], v[172:175], v[80:95]
  s_waitcnt lgkmcnt(7)
  ds_read_b128 v[184:187], v10 offset:47104
  ds_read_b64_tr_b16 v[44:45], v3 offset:28672
  ds_read_b64_tr_b16 v[46:47], v3 offset:30720
  v_mfma_f32_32x32x16_bf16 v[64:79], v[32:35], v[144:147], v[64:79]
  s_waitcnt lgkmcnt(7)
  ds_read_b128 v[156:159], v10 offset:7168
  v_add_u32 v3, 40960, v8
  v_mfma_f32_32x32x16_bf16 v[80:95], v[32:35], v[176:179], v[80:95]
  s_waitcnt lgkmcnt(7)
  ds_read_b128 v[188:191], v10 offset:48128
  v_mfma_f32_32x32x16_bf16 v[64:79], v[36:39], v[148:151], v[64:79]
  s_waitcnt lgkmcnt(5)
  v_mfma_f32_32x32x16_bf16 v[80:95], v[36:39], v[180:183], v[80:95]
  s_waitcnt lgkmcnt(4)
  v_mfma_f32_32x32x16_bf16 v[64:79], v[40:43], v[152:155], v[64:79]
  s_waitcnt lgkmcnt(0)
  s_barrier
  ds_read_b64_tr_b16 v[16:17], v3 offset:0
  ds_read_b64_tr_b16 v[18:19], v3 offset:2048
  v_mfma_f32_32x32x16_bf16 v[80:95], v[40:43], v[184:187], v[80:95]
  ds_read_b128 v[192:195], v1 offset:0
  ds_read_b128 v[224:227], v1 offset:40960
  ds_read_b64_tr_b16 v[20:21], v3 offset:4096
  ds_read_b64_tr_b16 v[22:23], v3 offset:6144
  v_mfma_f32_32x32x16_bf16 v[64:79], v[44:47], v[156:159], v[64:79]
  ds_read_b128 v[196:199], v1 offset:1024
  ds_read_b128 v[228:231], v1 offset:41984
  ds_read_b64_tr_b16 v[24:25], v3 offset:8192
  ds_read_b64_tr_b16 v[26:27], v3 offset:10240
  v_mfma_f32_32x32x16_bf16 v[80:95], v[44:47], v[188:191], v[80:95]
  s_waitcnt lgkmcnt(7)
  ds_read_b128 v[200:203], v1 offset:2048
  ds_read_b128 v[232:235], v1 offset:43008
  ds_read_b64_tr_b16 v[28:29], v3 offset:12288
  ds_read_b64_tr_b16 v[30:31], v3 offset:14336
  v_mfma_f32_32x32x16_bf16 v[64:79], v[16:19], v[192:195], v[64:79]
  s_waitcnt lgkmcnt(8)
  ds_read_b128 v[204:207], v1 offset:3072
  v_mfma_f32_32x32x16_bf16 v[80:95], v[16:19], v[224:227], v[80:95]
  s_waitcnt lgkmcnt(7)
  ds_read_b128 v[236:239], v1 offset:44032
  ds_read_b64_tr_b16 v[32:33], v3 offset:16384
  ds_read_b64_tr_b16 v[34:35], v3 offset:18432
  v_mfma_f32_32x32x16_bf16 v[64:79], v[20:23], v[196:199], v[64:79]
  s_waitcnt lgkmcnt(7)
  ds_read_b128 v[208:211], v1 offset:4096
  v_mfma_f32_32x32x16_bf16 v[80:95], v[20:23], v[228:231], v[80:95]
  s_waitcnt lgkmcnt(7)
  ds_read_b128 v[240:243], v1 offset:45056
  ds_read_b64_tr_b16 v[36:37], v3 offset:20480
  ds_read_b64_tr_b16 v[38:39], v3 offset:22528
  v_mfma_f32_32x32x16_bf16 v[64:79], v[24:27], v[200:203], v[64:79]
  s_waitcnt lgkmcnt(7)
  ds_read_b128 v[212:215], v1 offset:5120
  v_mfma_f32_32x32x16_bf16 v[80:95], v[24:27], v[232:235], v[80:95]
  s_waitcnt lgkmcnt(7)
  ds_read_b128 v[244:247], v1 offset:46080
  ds_read_b64_tr_b16 v[40:41], v3 offset:24576
  ds_read_b64_tr_b16 v[42:43], v3 offset:26624
  v_mfma_f32_32x32x16_bf16 v[64:79], v[28:31], v[204:207], v[64:79]
  s_waitcnt lgkmcnt(7)
  ds_read_b128 v[216:219], v1 offset:6144
  v_mfma_f32_32x32x16_bf16 v[80:95], v[28:31], v[236:239], v[80:95]
  s_waitcnt lgkmcnt(7)
  ds_read_b128 v[248:251], v1 offset:47104
  ds_read_b64_tr_b16 v[44:45], v3 offset:28672
  ds_read_b64_tr_b16 v[46:47], v3 offset:30720
  v_mfma_f32_32x32x16_bf16 v[64:79], v[32:35], v[208:211], v[64:79]
  s_waitcnt lgkmcnt(7)
  ds_read_b128 v[220:223], v1 offset:7168
  v_add_u32 v3, 81920, v8
  v_mfma_f32_32x32x16_bf16 v[80:95], v[32:35], v[240:243], v[80:95]
  s_waitcnt lgkmcnt(7)
  ds_read_b128 v[252:255], v1 offset:48128
  v_mfma_f32_32x32x16_bf16 v[64:79], v[36:39], v[212:215], v[64:79]
  s_waitcnt lgkmcnt(5)
  v_and_b32 v12, 63, v0
  s_lshl_b32 s45, s3, 11
  s_lshl_b32 s46, s7, 3
  s_add_u32 s45, s45, s46
  v_lshlrev_b32 v13, 9, v12
  v_add_u32 v13, s45, v13
  v_mfma_f32_32x32x16_bf16 v[80:95], v[36:39], v[244:247], v[80:95]
  s_waitcnt lgkmcnt(4)
  v_mov_b32 v14, 0x7fff0000
  v_cmp_gt_u32 vcc, 4, v12
  v_mov_b32 v6, s82
  s_lshl_b32 s45, s3, 2
  v_cndmask_b32 v1, v14, v13, vcc
  v_not_b32 v7, v6
  v_mfma_f32_32x32x16_bf16 v[64:79], v[40:43], v[216:219], v[64:79]
  s_waitcnt lgkmcnt(0)
  s_barrier
  ds_read_b64_tr_b16 v[16:17], v3 offset:0
  ds_read_b64_tr_b16 v[18:19], v3 offset:2048
  v_mov_b32 v2, s45
  s_lshr_b32 s45, s7, 2
  s_bfe_u32 s94, s7, 0x10001
  v_mfma_f32_32x32x16_bf16 v[80:95], v[40:43], v[248:251], v[80:95]
  ds_read_b64_tr_b16 v[20:21], v3 offset:4096
  ds_read_b64_tr_b16 v[22:23], v3 offset:6144
  ds_read_b64_tr_b16 v[24:25], v3 offset:8192
  ds_read_b64_tr_b16 v[26:27], v3 offset:10240
  s_cmp_eq_u32 s45, s3
  s_cselect_b32 s94, s94, 2
  v_mfma_f32_32x32x16_bf16 v[64:79], v[44:47], v[220:223], v[64:79]
  ds_read_b64_tr_b16 v[28:29], v3 offset:12288
  ds_read_b64_tr_b16 v[30:31], v3 offset:14336
  v_bfe_u32 v13, v12, 4, 1
  s_and_b32 s45, s7, 1
  v_cmp_eq_u32 vcc, s45, v13
  v_mfma_f32_32x32x16_bf16 v[80:95], v[44:47], v[252:255], v[80:95]
  s_waitcnt lgkmcnt(6)
  s_cmp_eq_u32 s94, 0
  s_cselect_b64 s[96:97], vcc, 0
  s_cmp_eq_u32 s94, 1
  s_cselect_b64 vcc, vcc, 0
  v_cndmask_b32 v4, v11, v14, s[96:97]
  v_cndmask_b32 v5, v11, v14, vcc
  v_mfma_f32_32x32x16_bf16 v[96:111], v[16:19], v[128:131], 0
  s_waitcnt lgkmcnt(4)
  ds_read_b64_tr_b16 v[32:33], v3 offset:16384
  ds_read_b64_tr_b16 v[34:35], v3 offset:18432
  v_mfma_f32_32x32x16_bf16 v[112:127], v[16:19], v[160:163], 0
  s_add_u32 s50, s88, 0
  s_add_u32 s51, s88, 16384
  s_add_u32 s52, s88, 32768
  s_add_u32 s53, s88, 49152
  v_mfma_f32_32x32x16_bf16 v[96:111], v[20:23], v[132:135], v[96:111]
  s_waitcnt lgkmcnt(4)
  ds_read_b64_tr_b16 v[36:37], v3 offset:20480
  ds_read_b64_tr_b16 v[38:39], v3 offset:22528
  v_cvt_pk_bf16_f32 v48, v64, v65
  v_cvt_pk_bf16_f32 v49, v66, v67
  v_cvt_pk_bf16_f32 v50, v68, v69
  v_cvt_pk_bf16_f32 v51, v70, v71
  s_cmp_eq_u32 s94, 0
  s_cbranch_scc0 L_own00
  ds_write_b128 v9, v[48:51] offset:0
L_own00:
  v_mfma_f32_32x32x16_bf16 v[112:127], v[20:23], v[164:167], v[112:127]
  buffer_store_dwordx4 v[48:51], v4, s[40:43], s50 offen offset:0 sc1
  v_mfma_f32_32x32x16_bf16 v[96:111], v[24:27], v[136:139], v[96:111]
  s_waitcnt lgkmcnt(4)
  ds_read_b64_tr_b16 v[40:41], v3 offset:24576
  ds_read_b64_tr_b16 v[42:43], v3 offset:26624
  v_mfma_f32_32x32x16_bf16 v[112:127], v[24:27], v[168:171], v[112:127]
  v_mfma_f32_32x32x16_bf16 v[96:111], v[28:31], v[140:143], v[96:111]
  s_waitcnt lgkmcnt(4)
  ds_read_b64_tr_b16 v[44:45], v3 offset:28672
  ds_read_b64_tr_b16 v[46:47], v3 offset:30720
  v_cvt_pk_bf16_f32 v52, v72, v73
  v_cvt_pk_bf16_f32 v53, v74, v75
  v_cvt_pk_bf16_f32 v54, v76, v77
  v_cvt_pk_bf16_f32 v55, v78, v79
  s_cmp_eq_u32 s94, 0
  s_cbranch_scc0 L_own01
  ds_write_b128 v9, v[52:55] offset:1024
L_own01:
  v_mfma_f32_32x32x16_bf16 v[112:127], v[28:31], v[172:175], v[112:127]
  v_add_u32 v3, 122880, v8
  buffer_store_dwordx4 v[52:55], v4, s[40:43], s50 offen offset:1024 sc1
  v_mfma_f32_32x32x16_bf16 v[96:111], v[32:35], v[144:147], v[96:111]
  s_waitcnt lgkmcnt(4)
  v_mfma_f32_32x32x16_bf16 v[112:127], v[32:35], v[176:179], v[112:127]
  v_mfma_f32_32x32x16_bf16 v[96:111], v[36:39], v[148:151], v[96:111]
  s_waitcnt lgkmcnt(2)
  v_cvt_pk_bf16_f32 v56, v80, v81
  v_cvt_pk_bf16_f32 v57, v82, v83
  v_cvt_pk_bf16_f32 v58, v84, v85
  v_cvt_pk_bf16_f32 v59, v86, v87
  s_cmp_eq_u32 s94, 1
  s_cbranch_scc0 L_own02
  ds_write_b128 v9, v[56:59] offset:0
L_own02:
  v_mfma_f32_32x32x16_bf16 v[112:127], v[36:39], v[180:183], v[112:127]
  buffer_store_dwordx4 v[56:59], v5, s[40:43], s50 offen offset:2048 sc1
  v_mfma_f32_32x32x16_bf16 v[96:111], v[40:43], v[152:155], v[96:111]
  s_waitcnt lgkmcnt(0)
  s_barrier
  ds_read_b64_tr_b16 v[16:17], v3 offset:0
  ds_read_b64_tr_b16 v[18:19], v3 offset:2048
  v_mfma_f32_32x32x16_bf16 v[112:127], v[40:43], v[184:187], v[112:127]
  ds_read_b64_tr_b16 v[20:21], v3 offset:4096
  ds_read_b64_tr_b16 v[22:23], v3 offset:6144
  ds_read_b64_tr_b16 v[24:25], v3 offset:8192
  ds_read_b64_tr_b16 v[26:27], v3 offset:10240
  v_mfma_f32_32x32x16_bf16 v[96:111], v[44:47], v[156:159], v[96:111]
  ds_read_b64_tr_b16 v[28:29], v3 offset:12288
  ds_read_b64_tr_b16 v[30:31], v3 offset:14336
  v_cvt_pk_bf16_f32 v60, v88, v89
  v_cvt_pk_bf16_f32 v61, v90, v91
  v_cvt_pk_bf16_f32 v62, v92, v93
  v_cvt_pk_bf16_f32 v63, v94, v95
  s_cmp_eq_u32 s94, 1
  s_cbranch_scc0 L_own03
  ds_write_b128 v9, v[60:63] offset:1024
L_own03:
  v_mfma_f32_32x32x16_bf16 v[112:127], v[44:47], v[188:191], v[112:127]
  s_waitcnt lgkmcnt(6)
  buffer_store_dwordx4 v[60:63], v5, s[40:43], s50 offen offset:3072 sc1
  v_mfma_f32_32x32x16_bf16 v[96:111], v[16:19], v[192:195], v[96:111]
  s_waitcnt lgkmcnt(4)
  ds_read_b64_tr_b16 v[32:33], v3 offset:16384
  ds_read_b64_tr_b16 v[34:35], v3 offset:18432
  v_mfma_f32_32x32x16_bf16 v[112:127], v[16:19], v[224:227], v[112:127]
  v_mfma_f32_32x32x16_bf16 v[96:111], v[20:23], v[196:199], v[96:111]
  s_waitcnt lgkmcnt(4)
  ds_read_b64_tr_b16 v[36:37], v3 offset:20480
  ds_read_b64_tr_b16 v[38:39], v3 offset:22528
  v_mfma_f32_32x32x16_bf16 v[112:127], v[20:23], v[228:231], v[112:127]
  v_mfma_f32_32x32x16_bf16 v[96:111], v[24:27], v[200:203], v[96:111]
  s_waitcnt lgkmcnt(4)
  ds_read_b64_tr_b16 v[40:41], v3 offset:24576
  ds_read_b64_tr_b16 v[42:43], v3 offset:26624
  v_mfma_f32_32x32x16_bf16 v[112:127], v[24:27], v[232:235], v[112:127]
  v_mfma_f32_32x32x16_bf16 v[96:111], v[28:31], v[204:207], v[96:111]
  s_waitcnt lgkmcnt(4)
  ds_read_b64_tr_b16 v[44:45], v3 offset:28672
  ds_read_b64_tr_b16 v[46:47], v3 offset:30720
  v_mfma_f32_32x32x16_bf16 v[112:127], v[28:31], v[236:239], v[112:127]
  v_add_u32 v3, 0, v8
  v_mfma_f32_32x32x16_bf16 v[96:111], v[32:35], v[208:211], v[96:111]
  s_waitcnt lgkmcnt(4)
  v_mfma_f32_32x32x16_bf16 v[112:127], v[32:35], v[240:243], v[112:127]
  v_mfma_f32_32x32x16_bf16 v[96:111], v[36:39], v[212:215], v[96:111]
  s_waitcnt lgkmcnt(2)
  v_mfma_f32_32x32x16_bf16 v[112:127], v[36:39], v[244:247], v[112:127]
  v_mfma_f32_32x32x16_bf16 v[96:111], v[40:43], v[216:219], v[96:111]
  s_waitcnt lgkmcnt(0)
  s_barrier
  ds_read_b64_tr_b16 v[16:17], v3 offset:0
  ds_read_b64_tr_b16 v[18:19], v3 offset:2048
  v_mfma_f32_32x32x16_bf16 v[112:127], v[40:43], v[248:251], v[112:127]
  ds_read_b64_tr_b16 v[20:21], v3 offset:4096
  ds_read_b64_tr_b16 v[22:23], v3 offset:6144
  ds_read_b64_tr_b16 v[24:25], v3 offset:8192
  ds_read_b64_tr_b16 v[26:27], v3 offset:10240
  v_mfma_f32_32x32x16_bf16 v[96:111], v[44:47], v[220:223], v[96:111]
  ds_read_b64_tr_b16 v[28:29], v3 offset:12288
  ds_read_b64_tr_b16 v[30:31], v3 offset:14336
  v_mfma_f32_32x32x16_bf16 v[112:127], v[44:47], v[252:255], v[112:127]
  s_waitcnt lgkmcnt(6)
  v_mfma_f32_32x32x16_bf16 v[64:79], v[16:19], v[128:131], 0
  s_waitcnt lgkmcnt(4)
  ds_read_b64_tr_b16 v[32:33], v3 offset:16384
  ds_read_b64_tr_b16 v[34:35], v3 offset:18432
  v_mfma_f32_32x32x16_bf16 v[80:95], v[16:19], v[160:163], 0
  v_mfma_f32_32x32x16_bf16 v[64:79], v[20:23], v[132:135], v[64:79]
  s_waitcnt lgkmcnt(4)
  ds_read_b64_tr_b16 v[36:37], v3 offset:20480
  ds_read_b64_tr_b16 v[38:39], v3 offset:22528
  v_cvt_pk_bf16_f32 v48, v96, v97
  v_cvt_pk_bf16_f32 v49, v98, v99
  v_cvt_pk_bf16_f32 v50, v100, v101
  v_cvt_pk_bf16_f32 v51, v102, v103
  s_cmp_eq_u32 s94, 0
  s_cbranch_scc0 L_own10
  ds_write_b128 v9, v[48:51] offset:2048
L_own10:
  v_mfma_f32_32x32x16_bf16 v[80:95], v[20:23], v[164:167], v[80:95]
  buffer_store_dwordx4 v[48:51], v4, s[40:43], s51 offen offset:0 sc1
  v_mfma_f32_32x32x16_bf16 v[64:79], v[24:27], v[136:139], v[64:79]
  s_waitcnt lgkmcnt(4)
  ds_read_b64_tr_b16 v[40:41], v3 offset:24576
  ds_read_b64_tr_b16 v[42:43], v3 offset:26624
  v_mfma_f32_32x32x16_bf16 v[80:95], v[24:27], v[168:171], v[80:95]
  v_mfma_f32_32x32x16_bf16 v[64:79], v[28:31], v[140:143], v[64:79]
  s_waitcnt lgkmcnt(4)
  ds_read_b64_tr_b16 v[44:45], v3 offset:28672
  ds_read_b64_tr_b16 v[46:47], v3 offset:30720
  v_cvt_pk_bf16_f32 v52, v104, v105
  v_cvt_pk_bf16_f32 v53, v106, v107
  v_cvt_pk_bf16_f32 v54, v108, v109
  v_cvt_pk_bf16_f32 v55, v110, v111
  s_cmp_eq_u32 s94, 0
  s_cbranch_scc0 L_own11
  ds_write_b128 v9, v[52:55] offset:3072
L_own11:
  v_mfma_f32_32x32x16_bf16 v[80:95], v[28:31], v[172:175], v[80:95]
  v_add_u32 v3, 40960, v8
  buffer_store_dwordx4 v[52:55], v4, s[40:43], s51 offen offset:1024 sc1
  v_mfma_f32_32x32x16_bf16 v[64:79], v[32:35], v[144:147], v[64:79]
  s_waitcnt lgkmcnt(4)
  v_mfma_f32_32x32x16_bf16 v[80:95], v[32:35], v[176:179], v[80:95]
  v_mfma_f32_32x32x16_bf16 v[64:79], v[36:39], v[148:151], v[64:79]
  s_waitcnt lgkmcnt(2)
  v_cvt_pk_bf16_f32 v56, v112, v113
  v_cvt_pk_bf16_f32 v57, v114, v115
  v_cvt_pk_bf16_f32 v58, v116, v117
  v_cvt_pk_bf16_f32 v59, v118, v119
  s_cmp_eq_u32 s94, 1
  s_cbranch_scc0 L_own12
  ds_write_b128 v9, v[56:59] offset:2048
L_own12:
  v_mfma_f32_32x32x16_bf16 v[80:95], v[36:39], v[180:183], v[80:95]
  buffer_store_dwordx4 v[56:59], v5, s[40:43], s51 offen offset:2048 sc1
  v_mfma_f32_32x32x16_bf16 v[64:79], v[40:43], v[152:155], v[64:79]
  s_waitcnt lgkmcnt(0)
  s_barrier
  ds_read_b64_tr_b16 v[16:17], v3 offset:0
  ds_read_b64_tr_b16 v[18:19], v3 offset:2048
  v_mfma_f32_32x32x16_bf16 v[80:95], v[40:43], v[184:187], v[80:95]
  ds_read_b64_tr_b16 v[20:21], v3 offset:4096
  ds_read_b64_tr_b16 v[22:23], v3 offset:6144
  ds_read_b64_tr_b16 v[24:25], v3 offset:8192
  ds_read_b64_tr_b16 v[26:27], v3 offset:10240
  v_mfma_f32_32x32x16_bf16 v[64:79], v[44:47], v[156:159], v[64:79]
  ds_read_b64_tr_b16 v[28:29], v3 offset:12288
  ds_read_b64_tr_b16 v[30:31], v3 offset:14336
  v_cvt_pk_bf16_f32 v60, v120, v121
  v_cvt_pk_bf16_f32 v61, v122, v123
  v_cvt_pk_bf16_f32 v62, v124, v125
  v_cvt_pk_bf16_f32 v63, v126, v127
  s_cmp_eq_u32 s94, 1
  s_cbranch_scc0 L_own13
  ds_write_b128 v9, v[60:63] offset:3072
L_own13:
  v_mfma_f32_32x32x16_bf16 v[80:95], v[44:47], v[188:191], v[80:95]
  s_waitcnt lgkmcnt(6)
  buffer_store_dwordx4 v[60:63], v5, s[40:43], s51 offen offset:3072 sc1
  v_mfma_f32_32x32x16_bf16 v[64:79], v[16:19], v[192:195], v[64:79]
  s_waitcnt lgkmcnt(4)
  ds_read_b64_tr_b16 v[32:33], v3 offset:16384
  ds_read_b64_tr_b16 v[34:35], v3 offset:18432
  v_mfma_f32_32x32x16_bf16 v[80:95], v[16:19], v[224:227], v[80:95]
  v_mfma_f32_32x32x16_bf16 v[64:79], v[20:23], v[196:199], v[64:79]
  s_waitcnt lgkmcnt(4)
  ds_read_b64_tr_b16 v[36:37], v3 offset:20480
  ds_read_b64_tr_b16 v[38:39], v3 offset:22528
  v_mfma_f32_32x32x16_bf16 v[80:95], v[20:23], v[228:231], v[80:95]
  v_mfma_f32_32x32x16_bf16 v[64:79], v[24:27], v[200:203], v[64:79]
  s_waitcnt lgkmcnt(4)
  ds_read_b64_tr_b16 v[40:41], v3 offset:24576
  ds_read_b64_tr_b16 v[42:43], v3 offset:26624
  s_waitcnt vmcnt(4)
  buffer_store_dwordx2 v[6:7], v1, s[76:79], 0 offen offset:0 sc1
  v_mfma_f32_32x32x16_bf16 v[80:95], v[24:27], v[232:235], v[80:95]
  v_mfma_f32_32x32x16_bf16 v[64:79], v[28:31], v[204:207], v[64:79]
  s_waitcnt lgkmcnt(4)
  ds_read_b64_tr_b16 v[44:45], v3 offset:28672
  ds_read_b64_tr_b16 v[46:47], v3 offset:30720
  v_mfma_f32_32x32x16_bf16 v[80:95], v[28:31], v[236:239], v[80:95]
  v_add_u32 v3, 81920, v8
  v_mfma_f32_32x32x16_bf16 v[64:79], v[32:35], v[208:211], v[64:79]
  s_waitcnt lgkmcnt(4)
  v_mfma_f32_32x32x16_bf16 v[80:95], v[32:35], v[240:243], v[80:95]
  v_mfma_f32_32x32x16_bf16 v[64:79], v[36:39], v[212:215], v[64:79]
  s_waitcnt lgkmcnt(2)
  v_mfma_f32_32x32x16_bf16 v[80:95], v[36:39], v[244:247], v[80:95]
  v_mfma_f32_32x32x16_bf16 v[64:79], v[40:43], v[216:219], v[64:79]
  s_waitcnt lgkmcnt(0)
  s_barrier
  ds_read_b64_tr_b16 v[16:17], v3 offset:0
  ds_read_b64_tr_b16 v[18:19], v3 offset:2048
  v_mfma_f32_32x32x16_bf16 v[80:95], v[40:43], v[248:251], v[80:95]
  ds_read_b64_tr_b16 v[20:21], v3 offset:4096
  ds_read_b64_tr_b16 v[22:23], v3 offset:6144
  ds_read_b64_tr_b16 v[24:25], v3 offset:8192
  ds_read_b64_tr_b16 v[26:27], v3 offset:10240
  v_mfma_f32_32x32x16_bf16 v[64:79], v[44:47], v[220:223], v[64:79]
  ds_read_b64_tr_b16 v[28:29], v3 offset:12288
  ds_read_b64_tr_b16 v[30:31], v3 offset:14336
  v_mfma_f32_32x32x16_bf16 v[80:95], v[44:47], v[252:255], v[80:95]
  s_waitcnt lgkmcnt(6)
  v_mfma_f32_32x32x16_bf16 v[96:111], v[16:19], v[128:131], 0
  s_waitcnt lgkmcnt(4)
  ds_read_b64_tr_b16 v[32:33], v3 offset:16384
  ds_read_b64_tr_b16 v[34:35], v3 offset:18432
  v_mfma_f32_32x32x16_bf16 v[112:127], v[16:19], v[160:163], 0
  v_mfma_f32_32x32x16_bf16 v[96:111], v[20:23], v[132:135], v[96:111]
  s_waitcnt lgkmcnt(4)
  ds_read_b64_tr_b16 v[36:37], v3 offset:20480
  ds_read_b64_tr_b16 v[38:39], v3 offset:22528
  v_cvt_pk_bf16_f32 v48, v64, v65
  v_cvt_pk_bf16_f32 v49, v66, v67
  v_cvt_pk_bf16_f32 v50, v68, v69
  v_cvt_pk_bf16_f32 v51, v70, v71
  s_cmp_eq_u32 s94, 0
  s_cbranch_scc0 L_own20
  ds_write_b128 v9, v[48:51] offset:4096
L_own20:
  v_mfma_f32_32x32x16_bf16 v[112:127], v[20:23], v[164:167], v[112:127]
  buffer_store_dwordx4 v[48:51], v4, s[40:43], s52 offen offset:0 sc1
  v_mfma_f32_32x32x16_bf16 v[96:111], v[24:27], v[136:139], v[96:111]
  s_waitcnt lgkmcnt(4)
  ds_read_b64_tr_b16 v[40:41], v3 offset:24576
  ds_read_b64_tr_b16 v[42:43], v3 offset:26624
  v_mfma_f32_32x32x16_bf16 v[112:127], v[24:27], v[168:171], v[112:127]
  v_mfma_f32_32x32x16_bf16 v[96:111], v[28:31], v[140:143], v[96:111]
  s_waitcnt lgkmcnt(4)
  ds_read_b64_tr_b16 v[44:45], v3 offset:28672
  ds_read_b64_tr_b16 v[46:47], v3 offset:30720
  v_cvt_pk_bf16_f32 v52, v72, v73
  v_cvt_pk_bf16_f32 v53, v74, v75
  v_cvt_pk_bf16_f32 v54, v76, v77
  v_cvt_pk_bf16_f32 v55, v78, v79
  s_cmp_eq_u32 s94, 0
  s_cbranch_scc0 L_own21
  ds_write_b128 v9, v[52:55] offset:5120
L_own21:
  v_mfma_f32_32x32x16_bf16 v[112:127], v[28:31], v[172:175], v[112:127]
  v_add_u32 v3, 122880, v8
  buffer_store_dwordx4 v[52:55], v4, s[40:43], s52 offen offset:1024 sc1
  v_mfma_f32_32x32x16_bf16 v[96:111], v[32:35], v[144:147], v[96:111]
  s_waitcnt lgkmcnt(4)
  v_mfma_f32_32x32x16_bf16 v[112:127], v[32:35], v[176:179], v[112:127]
  v_mfma_f32_32x32x16_bf16 v[96:111], v[36:39], v[148:151], v[96:111]
  s_waitcnt lgkmcnt(2)
  v_cvt_pk_bf16_f32 v56, v80, v81
  v_cvt_pk_bf16_f32 v57, v82, v83
  v_cvt_pk_bf16_f32 v58, v84, v85
  v_cvt_pk_bf16_f32 v59, v86, v87
  s_cmp_eq_u32 s94, 1
  s_cbranch_scc0 L_own22
  ds_write_b128 v9, v[56:59] offset:4096
L_own22:
  v_mfma_f32_32x32x16_bf16 v[112:127], v[36:39], v[180:183], v[112:127]
  buffer_store_dwordx4 v[56:59], v5, s[40:43], s52 offen offset:2048 sc1
  v_mfma_f32_32x32x16_bf16 v[96:111], v[40:43], v[152:155], v[96:111]
  ds_read_b64_tr_b16 v[16:17], v3 offset:0
  ds_read_b64_tr_b16 v[18:19], v3 offset:2048
  v_mfma_f32_32x32x16_bf16 v[112:127], v[40:43], v[184:187], v[112:127]
  s_waitcnt lgkmcnt(2)
  ds_read_b64_tr_b16 v[20:21], v3 offset:4096
  ds_read_b64_tr_b16 v[22:23], v3 offset:6144
  ds_read_b64_tr_b16 v[24:25], v3 offset:8192
  ds_read_b64_tr_b16 v[26:27], v3 offset:10240
  v_mfma_f32_32x32x16_bf16 v[96:111], v[44:47], v[156:159], v[96:111]
  ds_read_b64_tr_b16 v[28:29], v3 offset:12288
  ds_read_b64_tr_b16 v[30:31], v3 offset:14336
  v_cvt_pk_bf16_f32 v60, v88, v89
  v_cvt_pk_bf16_f32 v61, v90, v91
  v_cvt_pk_bf16_f32 v62, v92, v93
  v_cvt_pk_bf16_f32 v63, v94, v95
  s_cmp_eq_u32 s94, 1
  s_cbranch_scc0 L_own23
  ds_write_b128 v9, v[60:63] offset:5120
L_own23:
  v_mfma_f32_32x32x16_bf16 v[112:127], v[44:47], v[188:191], v[112:127]
  s_waitcnt lgkmcnt(6)
  buffer_store_dwordx4 v[60:63], v5, s[40:43], s52 offen offset:3072 sc1
  v_mfma_f32_32x32x16_bf16 v[96:111], v[16:19], v[192:195], v[96:111]
  s_waitcnt lgkmcnt(4)
  ds_read_b64_tr_b16 v[32:33], v3 offset:16384
  ds_read_b64_tr_b16 v[34:35], v3 offset:18432
  v_mfma_f32_32x32x16_bf16 v[112:127], v[16:19], v[224:227], v[112:127]
  v_mfma_f32_32x32x16_bf16 v[96:111], v[20:23], v[196:199], v[96:111]
  s_waitcnt lgkmcnt(4)
  ds_read_b64_tr_b16 v[36:37], v3 offset:20480
  ds_read_b64_tr_b16 v[38:39], v3 offset:22528
  v_mfma_f32_32x32x16_bf16 v[112:127], v[20:23], v[228:231], v[112:127]
  v_mfma_f32_32x32x16_bf16 v[96:111], v[24:27], v[200:203], v[96:111]
  s_waitcnt lgkmcnt(4)
  ds_read_b64_tr_b16 v[40:41], v3 offset:24576
  ds_read_b64_tr_b16 v[42:43], v3 offset:26624
  s_waitcnt vmcnt(5)
  buffer_store_dwordx2 v[6:7], v1, s[76:79], 0 offen offset:128 sc1
  v_mfma_f32_32x32x16_bf16 v[112:127], v[24:27], v[232:235], v[112:127]
  v_mfma_f32_32x32x16_bf16 v[96:111], v[28:31], v[204:207], v[96:111]
  s_waitcnt lgkmcnt(4)
  ds_read_b64_tr_b16 v[44:45], v3 offset:28672
  ds_read_b64_tr_b16 v[46:47], v3 offset:30720
  v_mfma_f32_32x32x16_bf16 v[112:127], v[28:31], v[236:239], v[112:127]
  v_mfma_f32_32x32x16_bf16 v[96:111], v[32:35], v[208:211], v[96:111]
  s_waitcnt lgkmcnt(4)
  v_mfma_f32_32x32x16_bf16 v[112:127], v[32:35], v[240:243], v[112:127]
  v_mfma_f32_32x32x16_bf16 v[96:111], v[36:39], v[212:215], v[96:111]
  s_waitcnt lgkmcnt(2)
  v_mfma_f32_32x32x16_bf16 v[112:127], v[36:39], v[244:247], v[112:127]
  v_mfma_f32_32x32x16_bf16 v[96:111], v[40:43], v[216:219], v[96:111]
  s_waitcnt lgkmcnt(0)
  v_mfma_f32_32x32x16_bf16 v[112:127], v[40:43], v[248:251], v[112:127]
  v_mfma_f32_32x32x16_bf16 v[96:111], v[44:47], v[220:223], v[96:111]
  v_mfma_f32_32x32x16_bf16 v[112:127], v[44:47], v[252:255], v[112:127]
  s_nop 3
  v_cvt_pk_bf16_f32 v48, v96, v97
  v_cvt_pk_bf16_f32 v49, v98, v99
  v_cvt_pk_bf16_f32 v50, v100, v101
  v_cvt_pk_bf16_f32 v51, v102, v103
  s_cmp_eq_u32 s94, 0
  s_cbranch_scc0 L_own30
  ds_write_b128 v9, v[48:51] offset:6144
L_own30:
  buffer_store_dwordx4 v[48:51], v4, s[40:43], s53 offen offset:0 sc1
  v_cvt_pk_bf16_f32 v52, v104, v105
  v_cvt_pk_bf16_f32 v53, v106, v107
  v_cvt_pk_bf16_f32 v54, v108, v109
  v_cvt_pk_bf16_f32 v55, v110, v111
  s_cmp_eq_u32 s94, 0
  s_cbranch_scc0 L_own31
  ds_write_b128 v9, v[52:55] offset:7168
L_own31:
  buffer_store_dwordx4 v[52:55], v4, s[40:43], s53 offen offset:1024 sc1
  v_cvt_pk_bf16_f32 v56, v112, v113
  v_cvt_pk_bf16_f32 v57, v114, v115
  v_cvt_pk_bf16_f32 v58, v116, v117
  v_cvt_pk_bf16_f32 v59, v118, v119
  s_cmp_eq_u32 s94, 1
  s_cbranch_scc0 L_own32
  ds_write_b128 v9, v[56:59] offset:6144
L_own32:
  buffer_store_dwordx4 v[56:59], v5, s[40:43], s53 offen offset:2048 sc1
  v_cvt_pk_bf16_f32 v60, v120, v121
  v_cvt_pk_bf16_f32 v61, v122, v123
  v_cvt_pk_bf16_f32 v62, v124, v125
  v_cvt_pk_bf16_f32 v63, v126, v127
  s_cmp_eq_u32 s94, 1
  s_cbranch_scc0 L_own33
  ds_write_b128 v9, v[60:63] offset:7168
L_own33:
  buffer_store_dwordx4 v[60:63], v5, s[40:43], s53 offen offset:3072 sc1
  ds_write_b32 v2, v6
  s_waitcnt vmcnt(5)
  buffer_store_dwordx2 v[6:7], v1, s[76:79], 0 offen offset:256 sc1
  s_waitcnt vmcnt(1)
  buffer_store_dwordx2 v[6:7], v1, s[76:79], 0 offen offset:384 sc1
  s_endpgm
L_main_end:
L_rare1:
  s_nop 15
  s_nop 3
  v_max3_f32 v14, v176, v177, v178
  v_max3_f32 v14, v14, v179, v180
  v_max3_f32 v14, v14, v181, v182
  v_max3_f32 v14, v14, v183, v184
  v_max3_f32 v14, v14, v185, v186
  v_max3_f32 v14, v14, v187, v188
  v_max3_f32 v14, v14, v189, v190
  v_max3_f32 v14, v14, v191, 0
  v_mov_b32 v15, v14
  s_nop 1
  v_permlane32_swap_b32 v14, v15
  v_max_f32 v14, v14, v15
  v_ceil_f32 v14, v14
  v_sub_f32 v15, 0, v14
  v_exp_f32 v15, v15
  v_sub_f32 v208, v208, v14
  v_sub_f32 v176, v176, v14
  v_sub_f32 v160, v160, v14
  v_sub_f32 v209, v209, v14
  v_sub_f32 v177, v177, v14
  v_sub_f32 v161, v161, v14
  v_sub_f32 v210, v210, v14
  v_sub_f32 v178, v178, v14
  v_sub_f32 v162, v162, v14
  v_sub_f32 v211, v211, v14
  v_sub_f32 v179, v179, v14
  v_sub_f32 v163, v163, v14
  v_sub_f32 v212, v212, v14
  v_sub_f32 v180, v180, v14
  v_sub_f32 v164, v164, v14
  v_sub_f32 v213, v213, v14
  v_sub_f32 v181, v181, v14
  v_sub_f32 v165, v165, v14
  v_sub_f32 v214, v214, v14
  v_sub_f32 v182, v182, v14
  v_sub_f32 v166, v166, v14
  v_sub_f32 v215, v215, v14
  v_sub_f32 v183, v183, v14
  v_sub_f32 v167, v167, v14
  v_sub_f32 v216, v216, v14
  v_sub_f32 v184, v184, v14
  v_sub_f32 v168, v168, v14
  v_sub_f32 v217, v217, v14
  v_sub_f32 v185, v185, v14
  v_sub_f32 v169, v169, v14
  v_sub_f32 v218, v218, v14
  v_sub_f32 v186, v186, v14
  v_sub_f32 v170, v170, v14
  v_sub_f32 v219, v219, v14
  v_sub_f32 v187, v187, v14
  v_sub_f32 v171, v171, v14
  v_sub_f32 v220, v220, v14
  v_sub_f32 v188, v188, v14
  v_sub_f32 v172, v172, v14
  v_sub_f32 v221, v221, v14
  v_sub_f32 v189, v189, v14
  v_sub_f32 v173, v173, v14
  v_sub_f32 v222, v222, v14
  v_sub_f32 v190, v190, v14
  v_sub_f32 v174, v174, v14
  v_sub_f32 v223, v223, v14
  v_sub_f32 v191, v191, v14
  v_sub_f32 v175, v175, v14
  v_mul_f32 v12, v12, v15
  v_mul_f32 v64, v64, v15
  v_mul_f32 v65, v65, v15
  v_mul_f32 v66, v66, v15
  v_mul_f32 v67, v67, v15
  v_mul_f32 v68, v68, v15
  v_mul_f32 v69, v69, v15
  v_mul_f32 v70, v70, v15
  v_mul_f32 v71, v71, v15
  v_mul_f32 v72, v72, v15
  v_mul_f32 v73, v73, v15
  v_mul_f32 v74, v74, v15
  v_mul_f32 v75, v75, v15
  v_mul_f32 v76, v76, v15
  v_mul_f32 v77, v77, v15
  v_mul_f32 v78, v78, v15
  v_mul_f32 v79, v79, v15
  v_mul_f32 v80, v80, v15
  v_mul_f32 v81, v81, v15
  v_mul_f32 v82, v82, v15
  v_mul_f32 v83, v83, v15
  v_mul_f32 v84, v84, v15
  v_mul_f32 v85, v85, v15
  v_mul_f32 v86, v86, v15
  v_mul_f32 v87, v87, v15
  v_mul_f32 v88, v88, v15
  v_mul_f32 v89, v89, v15
  v_mul_f32 v90, v90, v15
  v_mul_f32 v91, v91, v15
  v_mul_f32 v92, v92, v15
  v_mul_f32 v93, v93, v15
  v_mul_f32 v94, v94, v15
  v_mul_f32 v95, v95, v15
  v_mul_f32 v96, v96, v15
  v_mul_f32 v97, v97, v15
  v_mul_f32 v98, v98, v15
  v_mul_f32 v99, v99, v15
  v_mul_f32 v100, v100, v15
  v_mul_f32 v101, v101, v15
  v_mul_f32 v102, v102, v15
  v_mul_f32 v103, v103, v15
  v_mul_f32 v104, v104, v15
  v_mul_f32 v105, v105, v15
  v_mul_f32 v106, v106, v15
  v_mul_f32 v107, v107, v15
  v_mul_f32 v108, v108, v15
  v_mul_f32 v109, v109, v15
  v_mul_f32 v110, v110, v15
  v_mul_f32 v111, v111, v15
  v_mul_f32 v112, v112, v15
  v_mul_f32 v113, v113, v15
  v_mul_f32 v114, v114, v15
  v_mul_f32 v115, v115, v15
  v_mul_f32 v116, v116, v15
  v_mul_f32 v117, v117, v15
  v_mul_f32 v118, v118, v15
  v_mul_f32 v119, v119, v15
  v_mul_f32 v120, v120, v15
  v_mul_f32 v121, v121, v15
  v_mul_f32 v122, v122, v15
  v_mul_f32 v123, v123, v15
  v_mul_f32 v124, v124, v15
  v_mul_f32 v125, v125, v15
  v_mul_f32 v126, v126, v15
  v_mul_f32 v127, v127, v15
  v_exp_f32 v48, v176
  v_exp_f32 v49, v177
  v_exp_f32 v50, v178
  v_add_f32 v60, v49, v48
  v_cvt_pk_bf16_f32 v200, v48, v49
  v_exp_f32 v51, v179
  v_add_f32 v60, v50, v60
  v_exp_f32 v52, v180
  v_add_f32 v60, v51, v60
  v_cvt_pk_bf16_f32 v201, v50, v51
  v_exp_f32 v53, v181
  v_add_f32 v60, v52, v60
  v_exp_f32 v54, v182
  v_add_f32 v60, v53, v60
  v_cvt_pk_bf16_f32 v202, v52, v53
  v_exp_f32 v55, v183
  v_add_f32 v60, v54, v60
  v_exp_f32 v48, v184
  v_add_f32 v60, v55, v60
  v_cvt_pk_bf16_f32 v203, v54, v55
  v_exp_f32 v49, v185
  v_add_f32 v60, v48, v60
  v_exp_f32 v50, v186
  v_add_f32 v60, v49, v60
  v_cvt_pk_bf16_f32 v204, v48, v49
  v_exp_f32 v51, v187
  v_add_f32 v60, v50, v60
  v_exp_f32 v52, v188
  v_add_f32 v60, v51, v60
  v_cvt_pk_bf16_f32 v205, v50, v51
  v_exp_f32 v53, v189
  v_add_f32 v60, v52, v60
  v_exp_f32 v54, v190
  v_add_f32 v60, v53, v60
  v_cvt_pk_bf16_f32 v206, v52, v53
  v_exp_f32 v55, v191
  v_add_f32 v60, v54, v60
  v_add_f32 v60, v55, v60
  v_cvt_pk_bf16_f32 v207, v54, v55
  s_nop 1
  s_branch L_back1
L_rare2:
  s_nop 15
  s_nop 3
  v_max3_f32 v14, v224, v225, v226
  v_max3_f32 v14, v14, v227, v228
  v_max3_f32 v14, v14, v229, v230
  v_max3_f32 v14, v14, v231, v232
  v_max3_f32 v14, v14, v233, v234
  v_max3_f32 v14, v14, v235, v236
  v_max3_f32 v14, v14, v237, v238
  v_max3_f32 v14, v14, v239, 0
  v_mov_b32 v15, v14
  s_nop 1
  v_permlane32_swap_b32 v14, v15
  v_max_f32 v14, v14, v15
  v_ceil_f32 v14, v14
  v_sub_f32 v15, 0, v14
  v_exp_f32 v15, v15
  v_sub_f32 v208, v208, v14
  v_sub_f32 v224, v224, v14
  v_sub_f32 v160, v160, v14
  v_sub_f32 v176, v176, v14
  v_sub_f32 v209, v209, v14
  v_sub_f32 v225, v225, v14
  v_sub_f32 v161, v161, v14
  v_sub_f32 v177, v177, v14
  v_sub_f32 v210, v210, v14
  v_sub_f32 v226, v226, v14
  v_sub_f32 v162, v162, v14
  v_sub_f32 v178, v178, v14
  v_sub_f32 v211, v211, v14
  v_sub_f32 v227, v227, v14
  v_sub_f32 v163, v163, v14
  v_sub_f32 v179, v179, v14
  v_sub_f32 v212, v212, v14
  v_sub_f32 v228, v228, v14
  v_sub_f32 v164, v164, v14
  v_sub_f32 v180, v180, v14
  v_sub_f32 v213, v213, v14
  v_sub_f32 v229, v229, v14
  v_sub_f32 v165, v165, v14
  v_sub_f32 v181, v181, v14
  v_sub_f32 v214, v214, v14
  v_sub_f32 v230, v230, v14
  v_sub_f32 v166, v166, v14
  v_sub_f32 v182, v182, v14
  v_sub_f32 v215, v215, v14
  v_sub_f32 v231, v231, v14
  v_sub_f32 v167, v167, v14
  v_sub_f32 v183, v183, v14
  v_sub_f32 v216, v216, v14
  v_sub_f32 v232, v232, v14
  v_sub_f32 v168, v168, v14
  v_sub_f32 v184, v184, v14
  v_sub_f32 v217, v217, v14
  v_sub_f32 v233, v233, v14
  v_sub_f32 v169, v169, v14
  v_sub_f32 v185, v185, v14
  v_sub_f32 v218, v218, v14
  v_sub_f32 v234, v234, v14
  v_sub_f32 v170, v170, v14
  v_sub_f32 v186, v186, v14
  v_sub_f32 v219, v219, v14
  v_sub_f32 v235, v235, v14
  v_sub_f32 v171, v171, v14
  v_sub_f32 v187, v187, v14
  v_sub_f32 v220, v220, v14
  v_sub_f32 v236, v236, v14
  v_sub_f32 v172, v172, v14
  v_sub_f32 v188, v188, v14
  v_sub_f32 v221, v221, v14
  v_sub_f32 v237, v237, v14
  v_sub_f32 v173, v173, v14
  v_sub_f32 v189, v189, v14
  v_sub_f32 v222, v222, v14
  v_sub_f32 v238, v238, v14
  v_sub_f32 v174, v174, v14
  v_sub_f32 v190, v190, v14
  v_sub_f32 v223, v223, v14
  v_sub_f32 v239, v239, v14
  v_sub_f32 v175, v175, v14
  v_sub_f32 v191, v191, v14
  v_mul_f32 v12, v12, v15
  v_mul_f32 v64, v64, v15
  v_mul_f32 v65, v65, v15
  v_mul_f32 v66, v66, v15
  v_mul_f32 v67, v67, v15
  v_mul_f32 v68, v68, v15
  v_mul_f32 v69, v69, v15
  v_mul_f32 v70, v70, v15
  v_mul_f32 v71, v71, v15
  v_mul_f32 v72, v72, v15
  v_mul_f32 v73, v73, v15
  v_mul_f32 v74, v74, v15
  v_mul_f32 v75, v75, v15
  v_mul_f32 v76, v76, v15
  v_mul_f32 v77, v77, v15
  v_mul_f32 v78, v78, v15
  v_mul_f32 v79, v79, v15
  v_mul_f32 v80, v80, v15
  v_mul_f32 v81, v81, v15
  v_mul_f32 v82, v82, v15
  v_mul_f32 v83, v83, v15
  v_mul_f32 v84, v84, v15
  v_mul_f32 v85, v85, v15
  v_mul_f32 v86, v86, v15
  v_mul_f32 v87, v87, v15
  v_mul_f32 v88, v88, v15
  v_mul_f32 v89, v89, v15
  v_mul_f32 v90, v90, v15
  v_mul_f32 v91, v91, v15
  v_mul_f32 v92, v92, v15
  v_mul_f32 v93, v93, v15
  v_mul_f32 v94, v94, v15
  v_mul_f32 v95, v95, v15
  v_mul_f32 v96, v96, v15
  v_mul_f32 v97, v97, v15
  v_mul_f32 v98, v98, v15
  v_mul_f32 v99, v99, v15
  v_mul_f32 v100, v100, v15
  v_mul_f32 v101, v101, v15
  v_mul_f32 v102, v102, v15
  v_mul_f32 v103, v103, v15
  v_mul_f32 v104, v104, v15
  v_mul_f32 v105, v105, v15
  v_mul_f32 v106, v106, v15
  v_mul_f32 v107, v107, v15
  v_mul_f32 v108, v108, v15
  v_mul_f32 v109, v109, v15
  v_mul_f32 v110, v110, v15
  v_mul_f32 v111, v111, v15
  v_mul_f32 v112, v112, v15
  v_mul_f32 v113, v113, v15
  v_mul_f32 v114, v114, v15
  v_mul_f32 v115, v115, v15
  v_mul_f32 v116, v116, v15
  v_mul_f32 v117, v117, v15
  v_mul_f32 v118, v118, v15
  v_mul_f32 v119, v119, v15
  v_mul_f32 v120, v120, v15
  v_mul_f32 v121, v121, v15
  v_mul_f32 v122, v122, v15
  v_mul_f32 v123, v123, v15
  v_mul_f32 v124, v124, v15
  v_mul_f32 v125, v125, v15
  v_mul_f32 v126, v126, v15
  v_mul_f32 v127, v127, v15
  v_exp_f32 v48, v224
  v_exp_f32 v49, v225
  v_exp_f32 v50, v226
  v_add_f32 v13, v49, v48
  v_cvt_pk_bf16_f32 v240, v48, v49
  v_exp_f32 v51, v227
  v_add_f32 v13, v50, v13
  v_exp_f32 v52, v228
  v_add_f32 v13, v51, v13
  v_cvt_pk_bf16_f32 v241, v50, v51
  v_exp_f32 v53, v229
  v_add_f32 v13, v52, v13
  v_exp_f32 v54, v230
  v_add_f32 v13, v53, v13
  v_cvt_pk_bf16_f32 v242, v52, v53
  v_exp_f32 v55, v231
  v_add_f32 v13, v54, v13
  v_exp_f32 v48, v232
  v_add_f32 v13, v55, v13
  v_cvt_pk_bf16_f32 v243, v54, v55
  v_exp_f32 v49, v233
  v_add_f32 v13, v48, v13
  v_exp_f32 v50, v234
  v_add_f32 v13, v49, v13
  v_cvt_pk_bf16_f32 v244, v48, v49
  v_exp_f32 v51, v235
  v_add_f32 v13, v50, v13
  v_exp_f32 v52, v236
  v_add_f32 v13, v51, v13
  v_cvt_pk_bf16_f32 v245, v50, v51
  v_exp_f32 v53, v237
  v_add_f32 v13, v52, v13
  v_exp_f32 v54, v238
  v_add_f32 v13, v53, v13
  v_cvt_pk_bf16_f32 v246, v52, v53
  v_exp_f32 v55, v239
  v_add_f32 v13, v54, v13
  v_add_f32 v13, v55, v13
  v_cvt_pk_bf16_f32 v247, v54, v55
  s_nop 1
  s_branch L_back2
L_rare3:
  s_nop 15
  s_nop 3
  v_max3_f32 v14, v160, v161, v162
  v_max3_f32 v14, v14, v163, v164
  v_max3_f32 v14, v14, v165, v166
  v_max3_f32 v14, v14, v167, v168
  v_max3_f32 v14, v14, v169, v170
  v_max3_f32 v14, v14, v171, v172
  v_max3_f32 v14, v14, v173, v174
  v_max3_f32 v14, v14, v175, 0
  v_mov_b32 v15, v14
  s_nop 1
  v_permlane32_swap_b32 v14, v15
  v_max_f32 v14, v14, v15
  v_ceil_f32 v14, v14
  v_sub_f32 v15, 0, v14
  v_exp_f32 v15, v15
  v_sub_f32 v208, v208, v14
  v_sub_f32 v160, v160, v14
  v_sub_f32 v176, v176, v14
  v_sub_f32 v224, v224, v14
  v_sub_f32 v209, v209, v14
  v_sub_f32 v161, v161, v14
  v_sub_f32 v177, v177, v14
  v_sub_f32 v225, v225, v14
  v_sub_f32 v210, v210, v14
  v_sub_f32 v162, v162, v14
  v_sub_f32 v178, v178, v14
  v_sub_f32 v226, v226, v14
  v_sub_f32 v211, v211, v14
  v_sub_f32 v163, v163, v14
  v_sub_f32 v179, v179, v14
  v_sub_f32 v227, v227, v14
  v_sub_f32 v212, v212, v14
  v_sub_f32 v164, v164, v14
  v_sub_f32 v180, v180, v14
  v_sub_f32 v228, v228, v14
  v_sub_f32 v213, v213, v14
  v_sub_f32 v165, v165, v14
  v_sub_f32 v181, v181, v14
  v_sub_f32 v229, v229, v14
  v_sub_f32 v214, v214, v14
  v_sub_f32 v166, v166, v14
  v_sub_f32 v182, v182, v14
  v_sub_f32 v230, v230, v14
  v_sub_f32 v215, v215, v14
  v_sub_f32 v167, v167, v14
  v_sub_f32 v183, v183, v14
  v_sub_f32 v231, v231, v14
  v_sub_f32 v216, v216, v14
  v_sub_f32 v168, v168, v14
  v_sub_f32 v184, v184, v14
  v_sub_f32 v232, v232, v14
  v_sub_f32 v217, v217, v14
  v_sub_f32 v169, v169, v14
  v_sub_f32 v185, v185, v14
  v_sub_f32 v233, v233, v14
  v_sub_f32 v218, v218, v14
  v_sub_f32 v170, v170, v14
  v_sub_f32 v186, v186, v14
  v_sub_f32 v234, v234, v14
  v_sub_f32 v219, v219, v14
  v_sub_f32 v171, v171, v14
  v_sub_f32 v187, v187, v14
  v_sub_f32 v235, v235, v14
  v_sub_f32 v220, v220, v14
  v_sub_f32 v172, v172, v14
  v_sub_f32 v188, v188, v14
  v_sub_f32 v236, v236, v14
  v_sub_f32 v221, v221, v14
  v_sub_f32 v173, v173, v14
  v_sub_f32 v189, v189, v14
  v_sub_f32 v237, v237, v14
  v_sub_f32 v222, v222, v14
  v_sub_f32 v174, v174, v14
  v_sub_f32 v190, v190, v14
  v_sub_f32 v238, v238, v14
  v_sub_f32 v223, v223, v14
  v_sub_f32 v175, v175, v14
  v_sub_f32 v191, v191, v14
  v_sub_f32 v239, v239, v14
  v_mul_f32 v12, v12, v15
  v_mul_f32 v64, v64, v15
  v_mul_f32 v65, v65, v15
  v_mul_f32 v66, v66, v15
  v_mul_f32 v67, v67, v15
  v_mul_f32 v68, v68, v15
  v_mul_f32 v69, v69, v15
  v_mul_f32 v70, v70, v15
  v_mul_f32 v71, v71, v15
  v_mul_f32 v72, v72, v15
  v_mul_f32 v73, v73, v15
  v_mul_f32 v74, v74, v15
  v_mul_f32 v75, v75, v15
  v_mul_f32 v76, v76, v15
  v_mul_f32 v77, v77, v15
  v_mul_f32 v78, v78, v15
  v_mul_f32 v79, v79, v15
  v_mul_f32 v80, v80, v15
  v_mul_f32 v81, v81, v15
  v_mul_f32 v82, v82, v15
  v_mul_f32 v83, v83, v15
  v_mul_f32 v84, v84, v15
  v_mul_f32 v85, v85, v15
  v_mul_f32 v86, v86, v15
  v_mul_f32 v87, v87, v15
  v_mul_f32 v88, v88, v15
  v_mul_f32 v89, v89, v15
  v_mul_f32 v90, v90, v15
  v_mul_f32 v91, v91, v15
  v_mul_f32 v92, v92, v15
  v_mul_f32 v93, v93, v15
  v_mul_f32 v94, v94, v15
  v_mul_f32 v95, v95, v15
  v_mul_f32 v96, v96, v15
  v_mul_f32 v97, v97, v15
  v_mul_f32 v98, v98, v15
  v_mul_f32 v99, v99, v15
  v_mul_f32 v100, v100, v15
  v_mul_f32 v101, v101, v15
  v_mul_f32 v102, v102, v15
  v_mul_f32 v103, v103, v15
  v_mul_f32 v104, v104, v15
  v_mul_f32 v105, v105, v15
  v_mul_f32 v106, v106, v15
  v_mul_f32 v107, v107, v15
  v_mul_f32 v108, v108, v15
  v_mul_f32 v109, v109, v15
  v_mul_f32 v110, v110, v15
  v_mul_f32 v111, v111, v15
  v_mul_f32 v112, v112, v15
  v_mul_f32 v113, v113, v15
  v_mul_f32 v114, v114, v15
  v_mul_f32 v115, v115, v15
  v_mul_f32 v116, v116, v15
  v_mul_f32 v117, v117, v15
  v_mul_f32 v118, v118, v15
  v_mul_f32 v119, v119, v15
  v_mul_f32 v120, v120, v15
  v_mul_f32 v121, v121, v15
  v_mul_f32 v122, v122, v15
  v_mul_f32 v123, v123, v15
  v_mul_f32 v124, v124, v15
  v_mul_f32 v125, v125, v15
  v_mul_f32 v126, v126, v15
  v_mul_f32 v127, v127, v15
  v_exp_f32 v48, v160
  v_exp_f32 v49, v161
  v_exp_f32 v50, v162
  v_add_f32 v60, v49, v48
  v_cvt_pk_bf16_f32 v192, v48, v49
  v_exp_f32 v51, v163
  v_add_f32 v60, v50, v60
  v_exp_f32 v52, v164
  v_add_f32 v60, v51, v60
  v_cvt_pk_bf16_f32 v193, v50, v51
  v_exp_f32 v53, v165
  v_add_f32 v60, v52, v60
  v_exp_f32 v54, v166
  v_add_f32 v60, v53, v60
  v_cvt_pk_bf16_f32 v194, v52, v53
  v_exp_f32 v55, v167
  v_add_f32 v60, v54, v60
  v_exp_f32 v48, v168
  v_add_f32 v60, v55, v60
  v_cvt_pk_bf16_f32 v195, v54, v55
  v_exp_f32 v49, v169
  v_add_f32 v60, v48, v60
  v_exp_f32 v50, v170
  v_add_f32 v60, v49, v60
  v_cvt_pk_bf16_f32 v196, v48, v49
  v_exp_f32 v51, v171
  v_add_f32 v60, v50, v60
  v_exp_f32 v52, v172
  v_add_f32 v60, v51, v60
  v_cvt_pk_bf16_f32 v197, v50, v51
  v_exp_f32 v53, v173
  v_add_f32 v60, v52, v60
  v_exp_f32 v54, v174
  v_add_f32 v60, v53, v60
  v_cvt_pk_bf16_f32 v198, v52, v53
  v_exp_f32 v55, v175
  v_add_f32 v60, v54, v60
  v_add_f32 v60, v55, v60
  v_cvt_pk_bf16_f32 v199, v54, v55
  s_nop 1
  s_branch L_back3
L_rare4:
  s_nop 15
  s_nop 3
  v_max3_f32 v14, v176, v177, v178
  v_max3_f32 v14, v14, v179, v180
  v_max3_f32 v14, v14, v181, v182
  v_max3_f32 v14, v14, v183, v184
  v_max3_f32 v14, v14, v185, v186
  v_max3_f32 v14, v14, v187, v188
  v_max3_f32 v14, v14, v189, v190
  v_max3_f32 v14, v14, v191, 0
  v_mov_b32 v15, v14
  s_nop 1
  v_permlane32_swap_b32 v14, v15
  v_max_f32 v14, v14, v15
  v_ceil_f32 v14, v14
  v_sub_f32 v15, 0, v14
  v_exp_f32 v15, v15
  v_sub_f32 v208, v208, v14
  v_sub_f32 v176, v176, v14
  v_sub_f32 v224, v224, v14
  v_sub_f32 v160, v160, v14
  v_sub_f32 v209, v209, v14
  v_sub_f32 v177, v177, v14
  v_sub_f32 v225, v225, v14
  v_sub_f32 v161, v161, v14
  v_sub_f32 v210, v210, v14
  v_sub_f32 v178, v178, v14
  v_sub_f32 v226, v226, v14
  v_sub_f32 v162, v162, v14
  v_sub_f32 v211, v211, v14
  v_sub_f32 v179, v179, v14
  v_sub_f32 v227, v227, v14
  v_sub_f32 v163, v163, v14
  v_sub_f32 v212, v212, v14
  v_sub_f32 v180, v180, v14
  v_sub_f32 v228, v228, v14
  v_sub_f32 v164, v164, v14
  v_sub_f32 v213, v213, v14
  v_sub_f32 v181, v181, v14
  v_sub_f32 v229, v229, v14
  v_sub_f32 v165, v165, v14
  v_sub_f32 v214, v214, v14
  v_sub_f32 v182, v182, v14
  v_sub_f32 v230, v230, v14
  v_sub_f32 v166, v166, v14
  v_sub_f32 v215, v215, v14
  v_sub_f32 v183, v183, v14
  v_sub_f32 v231, v231, v14
  v_sub_f32 v167, v167, v14
  v_sub_f32 v216, v216, v14
  v_sub_f32 v184, v184, v14
  v_sub_f32 v232, v232, v14
  v_sub_f32 v168, v168, v14
  v_sub_f32 v217, v217, v14
  v_sub_f32 v185, v185, v14
  v_sub_f32 v233, v233, v14
  v_sub_f32 v169, v169, v14
  v_sub_f32 v218, v218, v14
  v_sub_f32 v186, v186, v14
  v_sub_f32 v234, v234, v14
  v_sub_f32 v170, v170, v14
  v_sub_f32 v219, v219, v14
  v_sub_f32 v187, v187, v14
  v_sub_f32 v235, v235, v14
  v_sub_f32 v171, v171, v14
  v_sub_f32 v220, v220, v14
  v_sub_f32 v188, v188, v14
  v_sub_f32 v236, v236, v14
  v_sub_f32 v172, v172, v14
  v_sub_f32 v221, v221, v14
  v_sub_f32 v189, v189, v14
  v_sub_f32 v237, v237, v14
  v_sub_f32 v173, v173, v14
  v_sub_f32 v222, v222, v14
  v_sub_f32 v190, v190, v14
  v_sub_f32 v238, v238, v14
  v_sub_f32 v174, v174, v14
  v_sub_f32 v223, v223, v14
  v_sub_f32 v191, v191, v14
  v_sub_f32 v239, v239, v14
  v_sub_f32 v175, v175, v14
  v_mul_f32 v12, v12, v15
  v_mul_f32 v64, v64, v15
  v_mul_f32 v65, v65, v15
  v_mul_f32 v66, v66, v15
  v_mul_f32 v67, v67, v15
  v_mul_f32 v68, v68, v15
  v_mul_f32 v69, v69, v15
  v_mul_f32 v70, v70, v15
  v_mul_f32 v71, v71, v15
  v_mul_f32 v72, v72, v15
  v_mul_f32 v73, v73, v15
  v_mul_f32 v74, v74, v15
  v_mul_f32 v75, v75, v15
  v_mul_f32 v76, v76, v15
  v_mul_f32 v77, v77, v15
  v_mul_f32 v78, v78, v15
  v_mul_f32 v79, v79, v15
  v_mul_f32 v80, v80, v15
  v_mul_f32 v81, v81, v15
  v_mul_f32 v82, v82, v15
  v_mul_f32 v83, v83, v15
  v_mul_f32 v84, v84, v15
  v_mul_f32 v85, v85, v15
  v_mul_f32 v86, v86, v15
  v_mul_f32 v87, v87, v15
  v_mul_f32 v88, v88, v15
  v_mul_f32 v89, v89, v15
  v_mul_f32 v90, v90, v15
  v_mul_f32 v91, v91, v15
  v_mul_f32 v92, v92, v15
  v_mul_f32 v93, v93, v15
  v_mul_f32 v94, v94, v15
  v_mul_f32 v95, v95, v15
  v_mul_f32 v96, v96, v15
  v_mul_f32 v97, v97, v15
  v_mul_f32 v98, v98, v15
  v_mul_f32 v99, v99, v15
  v_mul_f32 v100, v100, v15
  v_mul_f32 v101, v101, v15
  v_mul_f32 v102, v102, v15
  v_mul_f32 v103, v103, v15
  v_mul_f32 v104, v104, v15
  v_mul_f32 v105, v105, v15
  v_mul_f32 v106, v106, v15
  v_mul_f32 v107, v107, v15
  v_mul_f32 v108, v108, v15
  v_mul_f32 v109, v109, v15
  v_mul_f32 v110, v110, v15
  v_mul_f32 v111, v111, v15
  v_mul_f32 v112, v112, v15
  v_mul_f32 v113, v113, v15
  v_mul_f32 v114, v114, v15
  v_mul_f32 v115, v115, v15
  v_mul_f32 v116, v116, v15
  v_mul_f32 v117, v117, v15
  v_mul_f32 v118, v118, v15
  v_mul_f32 v119, v119, v15
  v_mul_f32 v120, v120, v15
  v_mul_f32 v121, v121, v15
  v_mul_f32 v122, v122, v15
  v_mul_f32 v123, v123, v15
  v_mul_f32 v124, v124, v15
  v_mul_f32 v125, v125, v15
  v_mul_f32 v126, v126, v15
  v_mul_f32 v127, v127, v15
  v_exp_f32 v48, v176
  v_exp_f32 v49, v177
  v_exp_f32 v50, v178
  v_add_f32 v13, v49, v48
  v_cvt_pk_bf16_f32 v200, v48, v49
  v_exp_f32 v51, v179
  v_add_f32 v13, v50, v13
  v_exp_f32 v52, v180
  v_add_f32 v13, v51, v13
  v_cvt_pk_bf16_f32 v201, v50, v51
  v_exp_f32 v53, v181
  v_add_f32 v13, v52, v13
  v_exp_f32 v54, v182
  v_add_f32 v13, v53, v13
  v_cvt_pk_bf16_f32 v202, v52, v53
  v_exp_f32 v55, v183
  v_add_f32 v13, v54, v13
  v_exp_f32 v48, v184
  v_add_f32 v13, v55, v13
  v_cvt_pk_bf16_f32 v203, v54, v55
  v_exp_f32 v49, v185
  v_add_f32 v13, v48, v13
  v_exp_f32 v50, v186
  v_add_f32 v13, v49, v13
  v_cvt_pk_bf16_f32 v204, v48, v49
  v_exp_f32 v51, v187
  v_add_f32 v13, v50, v13
  v_exp_f32 v52, v188
  v_add_f32 v13, v51, v13
  v_cvt_pk_bf16_f32 v205, v50, v51
  v_exp_f32 v53, v189
  v_add_f32 v13, v52, v13
  v_exp_f32 v54, v190
  v_add_f32 v13, v53, v13
  v_cvt_pk_bf16_f32 v206, v52, v53
  v_exp_f32 v55, v191
  v_add_f32 v13, v54, v13
  v_add_f32 v13, v55, v13
  v_cvt_pk_bf16_f32 v207, v54, v55
  s_nop 1
  s_branch L_back4
L_rare5:
  s_nop 15
  s_nop 3
  v_max3_f32 v14, v224, v225, v226
  v_max3_f32 v14, v14, v227, v228
  v_max3_f32 v14, v14, v229, v230
  v_max3_f32 v14, v14, v231, v232
  v_max3_f32 v14, v14, v233, v234
  v_max3_f32 v14, v14, v235, v236
  v_max3_f32 v14, v14, v237, v238
  v_max3_f32 v14, v14, v239, 0
  v_mov_b32 v15, v14
  s_nop 1
  v_permlane32_swap_b32 v14, v15
  v_max_f32 v14, v14, v15
  v_ceil_f32 v14, v14
  v_sub_f32 v15, 0, v14
  v_exp_f32 v15, v15
  v_sub_f32 v208, v208, v14
  v_sub_f32 v224, v224, v14
  v_sub_f32 v160, v160, v14
  v_sub_f32 v176, v176, v14
  v_sub_f32 v209, v209, v14
  v_sub_f32 v225, v225, v14
  v_sub_f32 v161, v161, v14
  v_sub_f32 v177, v177, v14
  v_sub_f32 v210, v210, v14
  v_sub_f32 v226, v226, v14
  v_sub_f32 v162, v162, v14
  v_sub_f32 v178, v178, v14
  v_sub_f32 v211, v211, v14
  v_sub_f32 v227, v227, v14
  v_sub_f32 v163, v163, v14
  v_sub_f32 v179, v179, v14
  v_sub_f32 v212, v212, v14
  v_sub_f32 v228, v228, v14
  v_sub_f32 v164, v164, v14
  v_sub_f32 v180, v180, v14
  v_sub_f32 v213, v213, v14
  v_sub_f32 v229, v229, v14
  v_sub_f32 v165, v165, v14
  v_sub_f32 v181, v181, v14
  v_sub_f32 v214, v214, v14
  v_sub_f32 v230, v230, v14
  v_sub_f32 v166, v166, v14
  v_sub_f32 v182, v182, v14
  v_sub_f32 v215, v215, v14
  v_sub_f32 v231, v231, v14
  v_sub_f32 v167, v167, v14
  v_sub_f32 v183, v183, v14
  v_sub_f32 v216, v216, v14
  v_sub_f32 v232, v232, v14
  v_sub_f32 v168, v168, v14
  v_sub_f32 v184, v184, v14
  v_sub_f32 v217, v217, v14
  v_sub_f32 v233, v233, v14
  v_sub_f32 v169, v169, v14
  v_sub_f32 v185, v185, v14
  v_sub_f32 v218, v218, v14
  v_sub_f32 v234, v234, v14
  v_sub_f32 v170, v170, v14
  v_sub_f32 v186, v186, v14
  v_sub_f32 v219, v219, v14
  v_sub_f32 v235, v235, v14
  v_sub_f32 v171, v171, v14
  v_sub_f32 v187, v187, v14
  v_sub_f32 v220, v220, v14
  v_sub_f32 v236, v236, v14
  v_sub_f32 v172, v172, v14
  v_sub_f32 v188, v188, v14
  v_sub_f32 v221, v221, v14
  v_sub_f32 v237, v237, v14
  v_sub_f32 v173, v173, v14
  v_sub_f32 v189, v189, v14
  v_sub_f32 v222, v222, v14
  v_sub_f32 v238, v238, v14
  v_sub_f32 v174, v174, v14
  v_sub_f32 v190, v190, v14
  v_sub_f32 v223, v223, v14
  v_sub_f32 v239, v239, v14
  v_sub_f32 v175, v175, v14
  v_sub_f32 v191, v191, v14
  v_mul_f32 v12, v12, v15
  v_mul_f32 v64, v64, v15
  v_mul_f32 v65, v65, v15
  v_mul_f32 v66, v66, v15
  v_mul_f32 v67, v67, v15
  v_mul_f32 v68, v68, v15
  v_mul_f32 v69, v69, v15
  v_mul_f32 v70, v70, v15
  v_mul_f32 v71, v71, v15
  v_mul_f32 v72, v72, v15
  v_mul_f32 v73, v73, v15
  v_mul_f32 v74, v74, v15
  v_mul_f32 v75, v75, v15
  v_mul_f32 v76, v76, v15
  v_mul_f32 v77, v77, v15
  v_mul_f32 v78, v78, v15
  v_mul_f32 v79, v79, v15
  v_mul_f32 v80, v80, v15
  v_mul_f32 v81, v81, v15
  v_mul_f32 v82, v82, v15
  v_mul_f32 v83, v83, v15
  v_mul_f32 v84, v84, v15
  v_mul_f32 v85, v85, v15
  v_mul_f32 v86, v86, v15
  v_mul_f32 v87, v87, v15
  v_mul_f32 v88, v88, v15
  v_mul_f32 v89, v89, v15
  v_mul_f32 v90, v90, v15
  v_mul_f32 v91, v91, v15
  v_mul_f32 v92, v92, v15
  v_mul_f32 v93, v93, v15
  v_mul_f32 v94, v94, v15
  v_mul_f32 v95, v95, v15
  v_mul_f32 v96, v96, v15
  v_mul_f32 v97, v97, v15
  v_mul_f32 v98, v98, v15
  v_mul_f32 v99, v99, v15
  v_mul_f32 v100, v100, v15
  v_mul_f32 v101, v101, v15
  v_mul_f32 v102, v102, v15
  v_mul_f32 v103, v103, v15
  v_mul_f32 v104, v104, v15
  v_mul_f32 v105, v105, v15
  v_mul_f32 v106, v106, v15
  v_mul_f32 v107, v107, v15
  v_mul_f32 v108, v108, v15
  v_mul_f32 v109, v109, v15
  v_mul_f32 v110, v110, v15
  v_mul_f32 v111, v111, v15
  v_mul_f32 v112, v112, v15
  v_mul_f32 v113, v113, v15
  v_mul_f32 v114, v114, v15
  v_mul_f32 v115, v115, v15
  v_mul_f32 v116, v116, v15
  v_mul_f32 v117, v117, v15
  v_mul_f32 v118, v118, v15
  v_mul_f32 v119, v119, v15
  v_mul_f32 v120, v120, v15
  v_mul_f32 v121, v121, v15
  v_mul_f32 v122, v122, v15
  v_mul_f32 v123, v123, v15
  v_mul_f32 v124, v124, v15
  v_mul_f32 v125, v125, v15
  v_mul_f32 v126, v126, v15
  v_mul_f32 v127, v127, v15
  v_exp_f32 v48, v224
  v_exp_f32 v49, v225
  v_exp_f32 v50, v226
  v_add_f32 v60, v49, v48
  v_cvt_pk_bf16_f32 v240, v48, v49
  v_exp_f32 v51, v227
  v_add_f32 v60, v50, v60
  v_exp_f32 v52, v228
  v_add_f32 v60, v51, v60
  v_cvt_pk_bf16_f32 v241, v50, v51
  v_exp_f32 v53, v229
  v_add_f32 v60, v52, v60
  v_exp_f32 v54, v230
  v_add_f32 v60, v53, v60
  v_cvt_pk_bf16_f32 v242, v52, v53
  v_exp_f32 v55, v231
  v_add_f32 v60, v54, v60
  v_exp_f32 v48, v232
  v_add_f32 v60, v55, v60
  v_cvt_pk_bf16_f32 v243, v54, v55
  v_exp_f32 v49, v233
  v_add_f32 v60, v48, v60
  v_exp_f32 v50, v234
  v_add_f32 v60, v49, v60
  v_cvt_pk_bf16_f32 v244, v48, v49
  v_exp_f32 v51, v235
  v_add_f32 v60, v50, v60
  v_exp_f32 v52, v236
  v_add_f32 v60, v51, v60
  v_cvt_pk_bf16_f32 v245, v50, v51
  v_exp_f32 v53, v237
  v_add_f32 v60, v52, v60
  v_exp_f32 v54, v238
  v_add_f32 v60, v53, v60
  v_cvt_pk_bf16_f32 v246, v52, v53
  v_exp_f32 v55, v239
  v_add_f32 v60, v54, v60
  v_add_f32 v60, v55, v60
  v_cvt_pk_bf16_f32 v247, v54, v55
  s_nop 1
  s_branch L_back5
L_rare6:
  s_nop 15
  s_nop 3
  v_max3_f32 v14, v160, v161, v162
  v_max3_f32 v14, v14, v163, v164
  v_max3_f32 v14, v14, v165, v166
  v_max3_f32 v14, v14, v167, v168
  v_max3_f32 v14, v14, v169, v170
  v_max3_f32 v14, v14, v171, v172
  v_max3_f32 v14, v14, v173, v174
  v_max3_f32 v14, v14, v175, 0
  v_mov_b32 v15, v14
  s_nop 1
  v_permlane32_swap_b32 v14, v15
  v_max_f32 v14, v14, v15
  v_ceil_f32 v14, v14
  v_sub_f32 v15, 0, v14
  v_exp_f32 v15, v15
  v_sub_f32 v208, v208, v14
  v_sub_f32 v160, v160, v14
  v_sub_f32 v176, v176, v14
  v_sub_f32 v224, v224, v14
  v_sub_f32 v209, v209, v14
  v_sub_f32 v161, v161, v14
  v_sub_f32 v177, v177, v14
  v_sub_f32 v225, v225, v14
  v_sub_f32 v210, v210, v14
  v_sub_f32 v162, v162, v14
  v_sub_f32 v178, v178, v14
  v_sub_f32 v226, v226, v14
  v_sub_f32 v211, v211, v14
  v_sub_f32 v163, v163, v14
  v_sub_f32 v179, v179, v14
  v_sub_f32 v227, v227, v14
  v_sub_f32 v212, v212, v14
  v_sub_f32 v164, v164, v14
  v_sub_f32 v180, v180, v14
  v_sub_f32 v228, v228, v14
  v_sub_f32 v213, v213, v14
  v_sub_f32 v165, v165, v14
  v_sub_f32 v181, v181, v14
  v_sub_f32 v229, v229, v14
  v_sub_f32 v214, v214, v14
  v_sub_f32 v166, v166, v14
  v_sub_f32 v182, v182, v14
  v_sub_f32 v230, v230, v14
  v_sub_f32 v215, v215, v14
  v_sub_f32 v167, v167, v14
  v_sub_f32 v183, v183, v14
  v_sub_f32 v231, v231, v14
  v_sub_f32 v216, v216, v14
  v_sub_f32 v168, v168, v14
  v_sub_f32 v184, v184, v14
  v_sub_f32 v232, v232, v14
  v_sub_f32 v217, v217, v14
  v_sub_f32 v169, v169, v14
  v_sub_f32 v185, v185, v14
  v_sub_f32 v233, v233, v14
  v_sub_f32 v218, v218, v14
  v_sub_f32 v170, v170, v14
  v_sub_f32 v186, v186, v14
  v_sub_f32 v234, v234, v14
  v_sub_f32 v219, v219, v14
  v_sub_f32 v171, v171, v14
  v_sub_f32 v187, v187, v14
  v_sub_f32 v235, v235, v14
  v_sub_f32 v220, v220, v14
  v_sub_f32 v172, v172, v14
  v_sub_f32 v188, v188, v14
  v_sub_f32 v236, v236, v14
  v_sub_f32 v221, v221, v14
  v_sub_f32 v173, v173, v14
  v_sub_f32 v189, v189, v14
  v_sub_f32 v237, v237, v14
  v_sub_f32 v222, v222, v14
  v_sub_f32 v174, v174, v14
  v_sub_f32 v190, v190, v14
  v_sub_f32 v238, v238, v14
  v_sub_f32 v223, v223, v14
  v_sub_f32 v175, v175, v14
  v_sub_f32 v191, v191, v14
  v_sub_f32 v239, v239, v14
  v_mul_f32 v12, v12, v15
  v_mul_f32 v64, v64, v15
  v_mul_f32 v65, v65, v15
  v_mul_f32 v66, v66, v15
  v_mul_f32 v67, v67, v15
  v_mul_f32 v68, v68, v15
  v_mul_f32 v69, v69, v15
  v_mul_f32 v70, v70, v15
  v_mul_f32 v71, v71, v15
  v_mul_f32 v72, v72, v15
  v_mul_f32 v73, v73, v15
  v_mul_f32 v74, v74, v15
  v_mul_f32 v75, v75, v15
  v_mul_f32 v76, v76, v15
  v_mul_f32 v77, v77, v15
  v_mul_f32 v78, v78, v15
  v_mul_f32 v79, v79, v15
  v_mul_f32 v80, v80, v15
  v_mul_f32 v81, v81, v15
  v_mul_f32 v82, v82, v15
  v_mul_f32 v83, v83, v15
  v_mul_f32 v84, v84, v15
  v_mul_f32 v85, v85, v15
  v_mul_f32 v86, v86, v15
  v_mul_f32 v87, v87, v15
  v_mul_f32 v88, v88, v15
  v_mul_f32 v89, v89, v15
  v_mul_f32 v90, v90, v15
  v_mul_f32 v91, v91, v15
  v_mul_f32 v92, v92, v15
  v_mul_f32 v93, v93, v15
  v_mul_f32 v94, v94, v15
  v_mul_f32 v95, v95, v15
  v_mul_f32 v96, v96, v15
  v_mul_f32 v97, v97, v15
  v_mul_f32 v98, v98, v15
  v_mul_f32 v99, v99, v15
  v_mul_f32 v100, v100, v15
  v_mul_f32 v101, v101, v15
  v_mul_f32 v102, v102, v15
  v_mul_f32 v103, v103, v15
  v_mul_f32 v104, v104, v15
  v_mul_f32 v105, v105, v15
  v_mul_f32 v106, v106, v15
  v_mul_f32 v107, v107, v15
  v_mul_f32 v108, v108, v15
  v_mul_f32 v109, v109, v15
  v_mul_f32 v110, v110, v15
  v_mul_f32 v111, v111, v15
  v_mul_f32 v112, v112, v15
  v_mul_f32 v113, v113, v15
  v_mul_f32 v114, v114, v15
  v_mul_f32 v115, v115, v15
  v_mul_f32 v116, v116, v15
  v_mul_f32 v117, v117, v15
  v_mul_f32 v118, v118, v15
  v_mul_f32 v119, v119, v15
  v_mul_f32 v120, v120, v15
  v_mul_f32 v121, v121, v15
  v_mul_f32 v122, v122, v15
  v_mul_f32 v123, v123, v15
  v_mul_f32 v124, v124, v15
  v_mul_f32 v125, v125, v15
  v_mul_f32 v126, v126, v15
  v_mul_f32 v127, v127, v15
  v_exp_f32 v48, v160
  v_exp_f32 v49, v161
  v_exp_f32 v50, v162
  v_add_f32 v13, v49, v48
  v_cvt_pk_bf16_f32 v192, v48, v49
  v_exp_f32 v51, v163
  v_add_f32 v13, v50, v13
  v_exp_f32 v52, v164
  v_add_f32 v13, v51, v13
  v_cvt_pk_bf16_f32 v193, v50, v51
  v_exp_f32 v53, v165
  v_add_f32 v13, v52, v13
  v_exp_f32 v54, v166
  v_add_f32 v13, v53, v13
  v_cvt_pk_bf16_f32 v194, v52, v53
  v_exp_f32 v55, v167
  v_add_f32 v13, v54, v13
  v_exp_f32 v48, v168
  v_add_f32 v13, v55, v13
  v_cvt_pk_bf16_f32 v195, v54, v55
  v_exp_f32 v49, v169
  v_add_f32 v13, v48, v13
  v_exp_f32 v50, v170
  v_add_f32 v13, v49, v13
  v_cvt_pk_bf16_f32 v196, v48, v49
  v_exp_f32 v51, v171
  v_add_f32 v13, v50, v13
  v_exp_f32 v52, v172
  v_add_f32 v13, v51, v13
  v_cvt_pk_bf16_f32 v197, v50, v51
  v_exp_f32 v53, v173
  v_add_f32 v13, v52, v13
  v_exp_f32 v54, v174
  v_add_f32 v13, v53, v13
  v_cvt_pk_bf16_f32 v198, v52, v53
  v_exp_f32 v55, v175
  v_add_f32 v13, v54, v13
  v_add_f32 v13, v55, v13
  v_cvt_pk_bf16_f32 v199, v54, v55
  s_nop 1
  s_branch L_back6
L_rare7:
  s_nop 15
  s_nop 3
  v_max3_f32 v14, v176, v177, v178
  v_max3_f32 v14, v14, v179, v180
  v_max3_f32 v14, v14, v181, v182
  v_max3_f32 v14, v14, v183, v184
  v_max3_f32 v14, v14, v185, v186
  v_max3_f32 v14, v14, v187, v188
  v_max3_f32 v14, v14, v189, v190
  v_max3_f32 v14, v14, v191, 0
  v_mov_b32 v15, v14
  s_nop 1
  v_permlane32_swap_b32 v14, v15
  v_max_f32 v14, v14, v15
  v_ceil_f32 v14, v14
  v_sub_f32 v15, 0, v14
  v_exp_f32 v15, v15
  v_sub_f32 v208, v208, v14
  v_sub_f32 v176, v176, v14
  v_sub_f32 v224, v224, v14
  v_sub_f32 v160, v160, v14
  v_sub_f32 v209, v209, v14
  v_sub_f32 v177, v177, v14
  v_sub_f32 v225, v225, v14
  v_sub_f32 v161, v161, v14
  v_sub_f32 v210, v210, v14
  v_sub_f32 v178, v178, v14
  v_sub_f32 v226, v226, v14
  v_sub_f32 v162, v162, v14
  v_sub_f32 v211, v211, v14
  v_sub_f32 v179, v179, v14
  v_sub_f32 v227, v227, v14
  v_sub_f32 v163, v163, v14
  v_sub_f32 v212, v212, v14
  v_sub_f32 v180, v180, v14
  v_sub_f32 v228, v228, v14
  v_sub_f32 v164, v164, v14
  v_sub_f32 v213, v213, v14
  v_sub_f32 v181, v181, v14
  v_sub_f32 v229, v229, v14
  v_sub_f32 v165, v165, v14
  v_sub_f32 v214, v214, v14
  v_sub_f32 v182, v182, v14
  v_sub_f32 v230, v230, v14
  v_sub_f32 v166, v166, v14
  v_sub_f32 v215, v215, v14
  v_sub_f32 v183, v183, v14
  v_sub_f32 v231, v231, v14
  v_sub_f32 v167, v167, v14
  v_sub_f32 v216, v216, v14
  v_sub_f32 v184, v184, v14
  v_sub_f32 v232, v232, v14
  v_sub_f32 v168, v168, v14
  v_sub_f32 v217, v217, v14
  v_sub_f32 v185, v185, v14
  v_sub_f32 v233, v233, v14
  v_sub_f32 v169, v169, v14
  v_sub_f32 v218, v218, v14
  v_sub_f32 v186, v186, v14
  v_sub_f32 v234, v234, v14
  v_sub_f32 v170, v170, v14
  v_sub_f32 v219, v219, v14
  v_sub_f32 v187, v187, v14
  v_sub_f32 v235, v235, v14
  v_sub_f32 v171, v171, v14
  v_sub_f32 v220, v220, v14
  v_sub_f32 v188, v188, v14
  v_sub_f32 v236, v236, v14
  v_sub_f32 v172, v172, v14
  v_sub_f32 v221, v221, v14
  v_sub_f32 v189, v189, v14
  v_sub_f32 v237, v237, v14
  v_sub_f32 v173, v173, v14
  v_sub_f32 v222, v222, v14
  v_sub_f32 v190, v190, v14
  v_sub_f32 v238, v238, v14
  v_sub_f32 v174, v174, v14
  v_sub_f32 v223, v223, v14
  v_sub_f32 v191, v191, v14
  v_sub_f32 v239, v239, v14
  v_sub_f32 v175, v175, v14
  v_mul_f32 v12, v12, v15
  v_mul_f32 v64, v64, v15
  v_mul_f32 v65, v65, v15
  v_mul_f32 v66, v66, v15
  v_mul_f32 v67, v67, v15
  v_mul_f32 v68, v68, v15
  v_mul_f32 v69, v69, v15
  v_mul_f32 v70, v70, v15
  v_mul_f32 v71, v71, v15
  v_mul_f32 v72, v72, v15
  v_mul_f32 v73, v73, v15
  v_mul_f32 v74, v74, v15
  v_mul_f32 v75, v75, v15
  v_mul_f32 v76, v76, v15
  v_mul_f32 v77, v77, v15
  v_mul_f32 v78, v78, v15
  v_mul_f32 v79, v79, v15
  v_mul_f32 v80, v80, v15
  v_mul_f32 v81, v81, v15
  v_mul_f32 v82, v82, v15
  v_mul_f32 v83, v83, v15
  v_mul_f32 v84, v84, v15
  v_mul_f32 v85, v85, v15
  v_mul_f32 v86, v86, v15
  v_mul_f32 v87, v87, v15
  v_mul_f32 v88, v88, v15
  v_mul_f32 v89, v89, v15
  v_mul_f32 v90, v90, v15
  v_mul_f32 v91, v91, v15
  v_mul_f32 v92, v92, v15
  v_mul_f32 v93, v93, v15
  v_mul_f32 v94, v94, v15
  v_mul_f32 v95, v95, v15
  v_mul_f32 v96, v96, v15
  v_mul_f32 v97, v97, v15
  v_mul_f32 v98, v98, v15
  v_mul_f32 v99, v99, v15
  v_mul_f32 v100, v100, v15
  v_mul_f32 v101, v101, v15
  v_mul_f32 v102, v102, v15
  v_mul_f32 v103, v103, v15
  v_mul_f32 v104, v104, v15
  v_mul_f32 v105, v105, v15
  v_mul_f32 v106, v106, v15
  v_mul_f32 v107, v107, v15
  v_mul_f32 v108, v108, v15
  v_mul_f32 v109, v109, v15
  v_mul_f32 v110, v110, v15
  v_mul_f32 v111, v111, v15
  v_mul_f32 v112, v112, v15
  v_mul_f32 v113, v113, v15
  v_mul_f32 v114, v114, v15
  v_mul_f32 v115, v115, v15
  v_mul_f32 v116, v116, v15
  v_mul_f32 v117, v117, v15
  v_mul_f32 v118, v118, v15
  v_mul_f32 v119, v119, v15
  v_mul_f32 v120, v120, v15
  v_mul_f32 v121, v121, v15
  v_mul_f32 v122, v122, v15
  v_mul_f32 v123, v123, v15
  v_mul_f32 v124, v124, v15
  v_mul_f32 v125, v125, v15
  v_mul_f32 v126, v126, v15
  v_mul_f32 v127, v127, v15
  v_exp_f32 v48, v176
  v_exp_f32 v49, v177
  v_exp_f32 v50, v178
  v_add_f32 v60, v49, v48
  v_cvt_pk_bf16_f32 v200, v48, v49
  v_exp_f32 v51, v179
  v_add_f32 v60, v50, v60
  v_exp_f32 v52, v180
  v_add_f32 v60, v51, v60
  v_cvt_pk_bf16_f32 v201, v50, v51
  v_exp_f32 v53, v181
  v_add_f32 v60, v52, v60
  v_exp_f32 v54, v182
  v_add_f32 v60, v53, v60
  v_cvt_pk_bf16_f32 v202, v52, v53
  v_exp_f32 v55, v183
  v_add_f32 v60, v54, v60
  v_exp_f32 v48, v184
  v_add_f32 v60, v55, v60
  v_cvt_pk_bf16_f32 v203, v54, v55
  v_exp_f32 v49, v185
  v_add_f32 v60, v48, v60
  v_exp_f32 v50, v186
  v_add_f32 v60, v49, v60
  v_cvt_pk_bf16_f32 v204, v48, v49
  v_exp_f32 v51, v187
  v_add_f32 v60, v50, v60
  v_exp_f32 v52, v188
  v_add_f32 v60, v51, v60
  v_cvt_pk_bf16_f32 v205, v50, v51
  v_exp_f32 v53, v189
  v_add_f32 v60, v52, v60
  v_exp_f32 v54, v190
  v_add_f32 v60, v53, v60
  v_cvt_pk_bf16_f32 v206, v52, v53
  v_exp_f32 v55, v191
  v_add_f32 v60, v54, v60
  v_add_f32 v60, v55, v60
  v_cvt_pk_bf16_f32 v207, v54, v55
  s_nop 1
  s_branch L_back7
L_rare8:
  s_nop 15
  s_nop 3
  v_max3_f32 v14, v224, v225, v226
  v_max3_f32 v14, v14, v227, v228
  v_max3_f32 v14, v14, v229, v230
  v_max3_f32 v14, v14, v231, v232
  v_max3_f32 v14, v14, v233, v234
  v_max3_f32 v14, v14, v235, v236
  v_max3_f32 v14, v14, v237, v238
  v_max3_f32 v14, v14, v239, 0
  v_mov_b32 v15, v14
  s_nop 1
  v_permlane32_swap_b32 v14, v15
  v_max_f32 v14, v14, v15
  v_ceil_f32 v14, v14
  v_sub_f32 v15, 0, v14
  v_exp_f32 v15, v15
  v_sub_f32 v208, v208, v14
  v_sub_f32 v224, v224, v14
  v_sub_f32 v160, v160, v14
  v_sub_f32 v209, v209, v14
  v_sub_f32 v225, v225, v14
  v_sub_f32 v161, v161, v14
  v_sub_f32 v210, v210, v14
  v_sub_f32 v226, v226, v14
  v_sub_f32 v162, v162, v14
  v_sub_f32 v211, v211, v14
  v_sub_f32 v227, v227, v14
  v_sub_f32 v163, v163, v14
  v_sub_f32 v212, v212, v14
  v_sub_f32 v228, v228, v14
  v_sub_f32 v164, v164, v14
  v_sub_f32 v213, v213, v14
  v_sub_f32 v229, v229, v14
  v_sub_f32 v165, v165, v14
  v_sub_f32 v214, v214, v14
  v_sub_f32 v230, v230, v14
  v_sub_f32 v166, v166, v14
  v_sub_f32 v215, v215, v14
  v_sub_f32 v231, v231, v14
  v_sub_f32 v167, v167, v14
  v_sub_f32 v216, v216, v14
  v_sub_f32 v232, v232, v14
  v_sub_f32 v168, v168, v14
  v_sub_f32 v217, v217, v14
  v_sub_f32 v233, v233, v14
  v_sub_f32 v169, v169, v14
  v_sub_f32 v218, v218, v14
  v_sub_f32 v234, v234, v14
  v_sub_f32 v170, v170, v14
  v_sub_f32 v219, v219, v14
  v_sub_f32 v235, v235, v14
  v_sub_f32 v171, v171, v14
  v_sub_f32 v220, v220, v14
  v_sub_f32 v236, v236, v14
  v_sub_f32 v172, v172, v14
  v_sub_f32 v221, v221, v14
  v_sub_f32 v237, v237, v14
  v_sub_f32 v173, v173, v14
  v_sub_f32 v222, v222, v14
  v_sub_f32 v238, v238, v14
  v_sub_f32 v174, v174, v14
  v_sub_f32 v223, v223, v14
  v_sub_f32 v239, v239, v14
  v_sub_f32 v175, v175, v14
  v_mul_f32 v12, v12, v15
  v_mul_f32 v64, v64, v15
  v_mul_f32 v65, v65, v15
  v_mul_f32 v66, v66, v15
  v_mul_f32 v67, v67, v15
  v_mul_f32 v68, v68, v15
  v_mul_f32 v69, v69, v15
  v_mul_f32 v70, v70, v15
  v_mul_f32 v71, v71, v15
  v_mul_f32 v72, v72, v15
  v_mul_f32 v73, v73, v15
  v_mul_f32 v74, v74, v15
  v_mul_f32 v75, v75, v15
  v_mul_f32 v76, v76, v15
  v_mul_f32 v77, v77, v15
  v_mul_f32 v78, v78, v15
  v_mul_f32 v79, v79, v15
  v_mul_f32 v80, v80, v15
  v_mul_f32 v81, v81, v15
  v_mul_f32 v82, v82, v15
  v_mul_f32 v83, v83, v15
  v_mul_f32 v84, v84, v15
  v_mul_f32 v85, v85, v15
  v_mul_f32 v86, v86, v15
  v_mul_f32 v87, v87, v15
  v_mul_f32 v88, v88, v15
  v_mul_f32 v89, v89, v15
  v_mul_f32 v90, v90, v15
  v_mul_f32 v91, v91, v15
  v_mul_f32 v92, v92, v15
  v_mul_f32 v93, v93, v15
  v_mul_f32 v94, v94, v15
  v_mul_f32 v95, v95, v15
  v_mul_f32 v96, v96, v15
  v_mul_f32 v97, v97, v15
  v_mul_f32 v98, v98, v15
  v_mul_f32 v99, v99, v15
  v_mul_f32 v100, v100, v15
  v_mul_f32 v101, v101, v15
  v_mul_f32 v102, v102, v15
  v_mul_f32 v103, v103, v15
  v_mul_f32 v104, v104, v15
  v_mul_f32 v105, v105, v15
  v_mul_f32 v106, v106, v15
  v_mul_f32 v107, v107, v15
  v_mul_f32 v108, v108, v15
  v_mul_f32 v109, v109, v15
  v_mul_f32 v110, v110, v15
  v_mul_f32 v111, v111, v15
  v_mul_f32 v112, v112, v15
  v_mul_f32 v113, v113, v15
  v_mul_f32 v114, v114, v15
  v_mul_f32 v115, v115, v15
  v_mul_f32 v116, v116, v15
  v_mul_f32 v117, v117, v15
  v_mul_f32 v118, v118, v15
  v_mul_f32 v119, v119, v15
  v_mul_f32 v120, v120, v15
  v_mul_f32 v121, v121, v15
  v_mul_f32 v122, v122, v15
  v_mul_f32 v123, v123, v15
  v_mul_f32 v124, v124, v15
  v_mul_f32 v125, v125, v15
  v_mul_f32 v126, v126, v15
  v_mul_f32 v127, v127, v15
  v_exp_f32 v48, v224
  v_exp_f32 v49, v225
  v_exp_f32 v50, v226
  v_add_f32 v13, v49, v48
  v_cvt_pk_bf16_f32 v240, v48, v49
  v_exp_f32 v51, v227
  v_add_f32 v13, v50, v13
  v_exp_f32 v52, v228
  v_add_f32 v13, v51, v13
  v_cvt_pk_bf16_f32 v241, v50, v51
  v_exp_f32 v53, v229
  v_add_f32 v13, v52, v13
  v_exp_f32 v54, v230
  v_add_f32 v13, v53, v13
  v_cvt_pk_bf16_f32 v242, v52, v53
  v_exp_f32 v55, v231
  v_add_f32 v13, v54, v13
  v_exp_f32 v48, v232
  v_add_f32 v13, v55, v13
  v_cvt_pk_bf16_f32 v243, v54, v55
  v_exp_f32 v49, v233
  v_add_f32 v13, v48, v13
  v_exp_f32 v50, v234
  v_add_f32 v13, v49, v13
  v_cvt_pk_bf16_f32 v244, v48, v49
  v_exp_f32 v51, v235
  v_add_f32 v13, v50, v13
  v_exp_f32 v52, v236
  v_add_f32 v13, v51, v13
  v_cvt_pk_bf16_f32 v245, v50, v51
  v_exp_f32 v53, v237
  v_add_f32 v13, v52, v13
  v_exp_f32 v54, v238
  v_add_f32 v13, v53, v13
  v_cvt_pk_bf16_f32 v246, v52, v53
  v_exp_f32 v55, v239
  v_add_f32 v13, v54, v13
  v_add_f32 v13, v55, v13
  v_cvt_pk_bf16_f32 v247, v54, v55
  s_nop 1
  s_branch L_back8
L_rare9:
  s_nop 15
  s_nop 3
  v_max3_f32 v14, v160, v161, v162
  v_max3_f32 v14, v14, v163, v164
  v_max3_f32 v14, v14, v165, v166
  v_max3_f32 v14, v14, v167, v168
  v_max3_f32 v14, v14, v169, v170
  v_max3_f32 v14, v14, v171, v172
  v_max3_f32 v14, v14, v173, v174
  v_max3_f32 v14, v14, v175, 0
  v_mov_b32 v15, v14
  s_nop 1
  v_permlane32_swap_b32 v14, v15
  v_max_f32 v14, v14, v15
  v_ceil_f32 v14, v14
  v_sub_f32 v15, 0, v14
  v_exp_f32 v15, v15
  v_sub_f32 v208, v208, v14
  v_sub_f32 v160, v160, v14
  v_sub_f32 v176, v176, v14
  v_sub_f32 v209, v209, v14
  v_sub_f32 v161, v161, v14
  v_sub_f32 v177, v177, v14
  v_sub_f32 v210, v210, v14
  v_sub_f32 v162, v162, v14
  v_sub_f32 v178, v178, v14
  v_sub_f32 v211, v211, v14
  v_sub_f32 v163, v163, v14
  v_sub_f32 v179, v179, v14
  v_sub_f32 v212, v212, v14
  v_sub_f32 v164, v164, v14
  v_sub_f32 v180, v180, v14
  v_sub_f32 v213, v213, v14
  v_sub_f32 v165, v165, v14
  v_sub_f32 v181, v181, v14
  v_sub_f32 v214, v214, v14
  v_sub_f32 v166, v166, v14
  v_sub_f32 v182, v182, v14
  v_sub_f32 v215, v215, v14
  v_sub_f32 v167, v167, v14
  v_sub_f32 v183, v183, v14
  v_sub_f32 v216, v216, v14
  v_sub_f32 v168, v168, v14
  v_sub_f32 v184, v184, v14
  v_sub_f32 v217, v217, v14
  v_sub_f32 v169, v169, v14
  v_sub_f32 v185, v185, v14
  v_sub_f32 v218, v218, v14
  v_sub_f32 v170, v170, v14
  v_sub_f32 v186, v186, v14
  v_sub_f32 v219, v219, v14
  v_sub_f32 v171, v171, v14
  v_sub_f32 v187, v187, v14
  v_sub_f32 v220, v220, v14
  v_sub_f32 v172, v172, v14
  v_sub_f32 v188, v188, v14
  v_sub_f32 v221, v221, v14
  v_sub_f32 v173, v173, v14
  v_sub_f32 v189, v189, v14
  v_sub_f32 v222, v222, v14
  v_sub_f32 v174, v174, v14
  v_sub_f32 v190, v190, v14
  v_sub_f32 v223, v223, v14
  v_sub_f32 v175, v175, v14
  v_sub_f32 v191, v191, v14
  v_mul_f32 v12, v12, v15
  v_mul_f32 v64, v64, v15
  v_mul_f32 v65, v65, v15
  v_mul_f32 v66, v66, v15
  v_mul_f32 v67, v67, v15
  v_mul_f32 v68, v68, v15
  v_mul_f32 v69, v69, v15
  v_mul_f32 v70, v70, v15
  v_mul_f32 v71, v71, v15
  v_mul_f32 v72, v72, v15
  v_mul_f32 v73, v73, v15
  v_mul_f32 v74, v74, v15
  v_mul_f32 v75, v75, v15
  v_mul_f32 v76, v76, v15
  v_mul_f32 v77, v77, v15
  v_mul_f32 v78, v78, v15
  v_mul_f32 v79, v79, v15
  v_mul_f32 v80, v80, v15
  v_mul_f32 v81, v81, v15
  v_mul_f32 v82, v82, v15
  v_mul_f32 v83, v83, v15
  v_mul_f32 v84, v84, v15
  v_mul_f32 v85, v85, v15
  v_mul_f32 v86, v86, v15
  v_mul_f32 v87, v87, v15
  v_mul_f32 v88, v88, v15
  v_mul_f32 v89, v89, v15
  v_mul_f32 v90, v90, v15
  v_mul_f32 v91, v91, v15
  v_mul_f32 v92, v92, v15
  v_mul_f32 v93, v93, v15
  v_mul_f32 v94, v94, v15
  v_mul_f32 v95, v95, v15
  v_mul_f32 v96, v96, v15
  v_mul_f32 v97, v97, v15
  v_mul_f32 v98, v98, v15
  v_mul_f32 v99, v99, v15
  v_mul_f32 v100, v100, v15
  v_mul_f32 v101, v101, v15
  v_mul_f32 v102, v102, v15
  v_mul_f32 v103, v103, v15
  v_mul_f32 v104, v104, v15
  v_mul_f32 v105, v105, v15
  v_mul_f32 v106, v106, v15
  v_mul_f32 v107, v107, v15
  v_mul_f32 v108, v108, v15
  v_mul_f32 v109, v109, v15
  v_mul_f32 v110, v110, v15
  v_mul_f32 v111, v111, v15
  v_mul_f32 v112, v112, v15
  v_mul_f32 v113, v113, v15
  v_mul_f32 v114, v114, v15
  v_mul_f32 v115, v115, v15
  v_mul_f32 v116, v116, v15
  v_mul_f32 v117, v117, v15
  v_mul_f32 v118, v118, v15
  v_mul_f32 v119, v119, v15
  v_mul_f32 v120, v120, v15
  v_mul_f32 v121, v121, v15
  v_mul_f32 v122, v122, v15
  v_mul_f32 v123, v123, v15
  v_mul_f32 v124, v124, v15
  v_mul_f32 v125, v125, v15
  v_mul_f32 v126, v126, v15
  v_mul_f32 v127, v127, v15
  v_lshlrev_b32 v48, 16, v240
  v_and_b32 v49, 0xffff0000, v240
  v_mul_f32 v48, v48, v15
  v_mul_f32 v49, v49, v15
  v_cvt_pk_bf16_f32 v240, v48, v49
  v_lshlrev_b32 v48, 16, v241
  v_and_b32 v49, 0xffff0000, v241
  v_mul_f32 v48, v48, v15
  v_mul_f32 v49, v49, v15
  v_cvt_pk_bf16_f32 v241, v48, v49
  v_lshlrev_b32 v48, 16, v242
  v_and_b32 v49, 0xffff0000, v242
  v_mul_f32 v48, v48, v15
  v_mul_f32 v49, v49, v15
  v_cvt_pk_bf16_f32 v242, v48, v49
  v_lshlrev_b32 v48, 16, v243
  v_and_b32 v49, 0xffff0000, v243
  v_mul_f32 v48, v48, v15
  v_mul_f32 v49, v49, v15
  v_cvt_pk_bf16_f32 v243, v48, v49
  v_lshlrev_b32 v48, 16, v244
  v_and_b32 v49, 0xffff0000, v244
  v_mul_f32 v48, v48, v15
  v_mul_f32 v49, v49, v15
  v_cvt_pk_bf16_f32 v244, v48, v49
  v_lshlrev_b32 v48, 16, v245
  v_and_b32 v49, 0xffff0000, v245
  v_mul_f32 v48, v48, v15
  v_mul_f32 v49, v49, v15
  v_cvt_pk_bf16_f32 v245, v48, v49
  v_lshlrev_b32 v48, 16, v246
  v_and_b32 v49, 0xffff0000, v246
  v_mul_f32 v48, v48, v15
  v_mul_f32 v49, v49, v15
  v_cvt_pk_bf16_f32 v246, v48, v49
  v_lshlrev_b32 v48, 16, v247
  v_and_b32 v49, 0xffff0000, v247
  v_mul_f32 v48, v48, v15
  v_mul_f32 v49, v49, v15
  v_cvt_pk_bf16_f32 v247, v48, v49
  v_exp_f32 v48, v160
  v_exp_f32 v49, v161
  v_exp_f32 v50, v162
  v_add_f32 v60, v49, v48
  v_cvt_pk_bf16_f32 v192, v48, v49
  v_exp_f32 v51, v163
  v_add_f32 v60, v50, v60
  v_exp_f32 v52, v164
  v_add_f32 v60, v51, v60
  v_cvt_pk_bf16_f32 v193, v50, v51
  v_exp_f32 v53, v165
  v_add_f32 v60, v52, v60
  v_exp_f32 v54, v166
  v_add_f32 v60, v53, v60
  v_cvt_pk_bf16_f32 v194, v52, v53
  v_exp_f32 v55, v167
  v_add_f32 v60, v54, v60
  v_exp_f32 v48, v168
  v_add_f32 v60, v55, v60
  v_cvt_pk_bf16_f32 v195, v54, v55
  v_exp_f32 v49, v169
  v_add_f32 v60, v48, v60
  v_exp_f32 v50, v170
  v_add_f32 v60, v49, v60
  v_cvt_pk_bf16_f32 v196, v48, v49
  v_exp_f32 v51, v171
  v_add_f32 v60, v50, v60
  v_exp_f32 v52, v172
  v_add_f32 v60, v51, v60
  v_cvt_pk_bf16_f32 v197, v50, v51
  v_exp_f32 v53, v173
  v_add_f32 v60, v52, v60
  v_exp_f32 v54, v174
  v_add_f32 v60, v53, v60
  v_cvt_pk_bf16_f32 v198, v52, v53
  v_exp_f32 v55, v175
  v_add_f32 v60, v54, v60
  v_add_f32 v60, v55, v60
  v_cvt_pk_bf16_f32 v199, v54, v55
  s_nop 1
  s_branch L_back9
L_rare10:
  s_nop 15
  s_nop 3
  v_max3_f32 v14, v176, v177, v178
  v_max3_f32 v14, v14, v179, v180
  v_max3_f32 v14, v14, v181, v182
  v_max3_f32 v14, v14, v183, v184
  v_max3_f32 v14, v14, v185, v186
  v_max3_f32 v14, v14, v187, v188
  v_max3_f32 v14, v14, v189, v190
  v_max3_f32 v14, v14, v191, 0
  v_mov_b32 v15, v14
  s_nop 1
  v_permlane32_swap_b32 v14, v15
  v_max_f32 v14, v14, v15
  v_ceil_f32 v14, v14
  v_sub_f32 v15, 0, v14
  v_exp_f32 v15, v15
  v_sub_f32 v208, v208, v14
  v_sub_f32 v176, v176, v14
  v_sub_f32 v224, v224, v14
  v_sub_f32 v209, v209, v14
  v_sub_f32 v177, v177, v14
  v_sub_f32 v225, v225, v14
  v_sub_f32 v210, v210, v14
  v_sub_f32 v178, v178, v14
  v_sub_f32 v226, v226, v14
  v_sub_f32 v211, v211, v14
  v_sub_f32 v179, v179, v14
  v_sub_f32 v227, v227, v14
  v_sub_f32 v212, v212, v14
  v_sub_f32 v180, v180, v14
  v_sub_f32 v228, v228, v14
  v_sub_f32 v213, v213, v14
  v_sub_f32 v181, v181, v14
  v_sub_f32 v229, v229, v14
  v_sub_f32 v214, v214, v14
  v_sub_f32 v182, v182, v14
  v_sub_f32 v230, v230, v14
  v_sub_f32 v215, v215, v14
  v_sub_f32 v183, v183, v14
  v_sub_f32 v231, v231, v14
  v_sub_f32 v216, v216, v14
  v_sub_f32 v184, v184, v14
  v_sub_f32 v232, v232, v14
  v_sub_f32 v217, v217, v14
  v_sub_f32 v185, v185, v14
  v_sub_f32 v233, v233, v14
  v_sub_f32 v218, v218, v14
  v_sub_f32 v186, v186, v14
  v_sub_f32 v234, v234, v14
  v_sub_f32 v219, v219, v14
  v_sub_f32 v187, v187, v14
  v_sub_f32 v235, v235, v14
  v_sub_f32 v220, v220, v14
  v_sub_f32 v188, v188, v14
  v_sub_f32 v236, v236, v14
  v_sub_f32 v221, v221, v14
  v_sub_f32 v189, v189, v14
  v_sub_f32 v237, v237, v14
  v_sub_f32 v222, v222, v14
  v_sub_f32 v190, v190, v14
  v_sub_f32 v238, v238, v14
  v_sub_f32 v223, v223, v14
  v_sub_f32 v191, v191, v14
  v_sub_f32 v239, v239, v14
  v_mul_f32 v12, v12, v15
  v_mul_f32 v64, v64, v15
  v_mul_f32 v65, v65, v15
  v_mul_f32 v66, v66, v15
  v_mul_f32 v67, v67, v15
  v_mul_f32 v68, v68, v15
  v_mul_f32 v69, v69, v15
  v_mul_f32 v70, v70, v15
  v_mul_f32 v71, v71, v15
  v_mul_f32 v72, v72, v15
  v_mul_f32 v73, v73, v15
  v_mul_f32 v74, v74, v15
  v_mul_f32 v75, v75, v15
  v_mul_f32 v76, v76, v15
  v_mul_f32 v77, v77, v15
  v_mul_f32 v78, v78, v15
  v_mul_f32 v79, v79, v15
  v_mul_f32 v80, v80, v15
  v_mul_f32 v81, v81, v15
  v_mul_f32 v82, v82, v15
  v_mul_f32 v83, v83, v15
  v_mul_f32 v84, v84, v15
  v_mul_f32 v85, v85, v15
  v_mul_f32 v86, v86, v15
  v_mul_f32 v87, v87, v15
  v_mul_f32 v88, v88, v15
  v_mul_f32 v89, v89, v15
  v_mul_f32 v90, v90, v15
  v_mul_f32 v91, v91, v15
  v_mul_f32 v92, v92, v15
  v_mul_f32 v93, v93, v15
  v_mul_f32 v94, v94, v15
  v_mul_f32 v95, v95, v15
  v_mul_f32 v96, v96, v15
  v_mul_f32 v97, v97, v15
  v_mul_f32 v98, v98, v15
  v_mul_f32 v99, v99, v15
  v_mul_f32 v100, v100, v15
  v_mul_f32 v101, v101, v15
  v_mul_f32 v102, v102, v15
  v_mul_f32 v103, v103, v15
  v_mul_f32 v104, v104, v15
  v_mul_f32 v105, v105, v15
  v_mul_f32 v106, v106, v15
  v_mul_f32 v107, v107, v15
  v_mul_f32 v108, v108, v15
  v_mul_f32 v109, v109, v15
  v_mul_f32 v110, v110, v15
  v_mul_f32 v111, v111, v15
  v_mul_f32 v112, v112, v15
  v_mul_f32 v113, v113, v15
  v_mul_f32 v114, v114, v15
  v_mul_f32 v115, v115, v15
  v_mul_f32 v116, v116, v15
  v_mul_f32 v117, v117, v15
  v_mul_f32 v118, v118, v15
  v_mul_f32 v119, v119, v15
  v_mul_f32 v120, v120, v15
  v_mul_f32 v121, v121, v15
  v_mul_f32 v122, v122, v15
  v_mul_f32 v123, v123, v15
  v_mul_f32 v124, v124, v15
  v_mul_f32 v125, v125, v15
  v_mul_f32 v126, v126, v15
  v_mul_f32 v127, v127, v15
  v_lshlrev_b32 v48, 16, v192
  v_and_b32 v49, 0xffff0000, v192
  v_mul_f32 v48, v48, v15
  v_mul_f32 v49, v49, v15
  v_cvt_pk_bf16_f32 v192, v48, v49
  v_lshlrev_b32 v48, 16, v193
  v_and_b32 v49, 0xffff0000, v193
  v_mul_f32 v48, v48, v15
  v_mul_f32 v49, v49, v15
  v_cvt_pk_bf16_f32 v193, v48, v49
  v_lshlrev_b32 v48, 16, v194
  v_and_b32 v49, 0xffff0000, v194
  v_mul_f32 v48, v48, v15
  v_mul_f32 v49, v49, v15
  v_cvt_pk_bf16_f32 v194, v48, v49
  v_lshlrev_b32 v48, 16, v195
  v_and_b32 v49, 0xffff0000, v195
  v_mul_f32 v48, v48, v15
  v_mul_f32 v49, v49, v15
  v_cvt_pk_bf16_f32 v195, v48, v49
  v_lshlrev_b32 v48, 16, v196
  v_and_b32 v49, 0xffff0000, v196
  v_mul_f32 v48, v48, v15
  v_mul_f32 v49, v49, v15
  v_cvt_pk_bf16_f32 v196, v48, v49
  v_lshlrev_b32 v48, 16, v197
  v_and_b32 v49, 0xffff0000, v197
  v_mul_f32 v48, v48, v15
  v_mul_f32 v49, v49, v15
  v_cvt_pk_bf16_f32 v197, v48, v49
  v_lshlrev_b32 v48, 16, v198
  v_and_b32 v49, 0xffff0000, v198
  v_mul_f32 v48, v48, v15
  v_mul_f32 v49, v49, v15
  v_cvt_pk_bf16_f32 v198, v48, v49
  v_lshlrev_b32 v48, 16, v199
  v_and_b32 v49, 0xffff0000, v199
  v_mul_f32 v48, v48, v15
  v_mul_f32 v49, v49, v15
  v_cvt_pk_bf16_f32 v199, v48, v49
  v_exp_f32 v48, v176
  v_exp_f32 v49, v177
  v_exp_f32 v50, v178
  v_add_f32 v13, v49, v48
  v_cvt_pk_bf16_f32 v200, v48, v49
  v_exp_f32 v51, v179
  v_add_f32 v13, v50, v13
  v_exp_f32 v52, v180
  v_add_f32 v13, v51, v13
  v_cvt_pk_bf16_f32 v201, v50, v51
  v_exp_f32 v53, v181
  v_add_f32 v13, v52, v13
  v_exp_f32 v54, v182
  v_add_f32 v13, v53, v13
  v_cvt_pk_bf16_f32 v202, v52, v53
  v_exp_f32 v55, v183
  v_add_f32 v13, v54, v13
  v_exp_f32 v48, v184
  v_add_f32 v13, v55, v13
  v_cvt_pk_bf16_f32 v203, v54, v55
  v_exp_f32 v49, v185
  v_add_f32 v13, v48, v13
  v_exp_f32 v50, v186
  v_add_f32 v13, v49, v13
  v_cvt_pk_bf16_f32 v204, v48, v49
  v_exp_f32 v51, v187
  v_add_f32 v13, v50, v13
  v_exp_f32 v52, v188
  v_add_f32 v13, v51, v13
  v_cvt_pk_bf16_f32 v205, v50, v51
  v_exp_f32 v53, v189
  v_add_f32 v13, v52, v13
  v_exp_f32 v54, v190
  v_add_f32 v13, v53, v13
  v_cvt_pk_bf16_f32 v206, v52, v53
  v_exp_f32 v55, v191
  v_add_f32 v13, v54, v13
  v_add_f32 v13, v55, v13
  v_cvt_pk_bf16_f32 v207, v54, v55
  s_nop 1
  s_branch L_back10
L_rare11:
  s_nop 15
  s_nop 3
  v_max3_f32 v14, v224, v225, v226
  v_max3_f32 v14, v14, v227, v228
  v_max3_f32 v14, v14, v229, v230
  v_max3_f32 v14, v14, v231, v232
  v_max3_f32 v14, v14, v233, v234
  v_max3_f32 v14, v14, v235, v236
  v_max3_f32 v14, v14, v237, v238
  v_max3_f32 v14, v14, v239, 0
  v_mov_b32 v15, v14
  s_nop 1
  v_permlane32_swap_b32 v14, v15
  v_max_f32 v14, v14, v15
  v_ceil_f32 v14, v14
  v_sub_f32 v15, 0, v14
  v_exp_f32 v15, v15
  v_sub_f32 v208, v208, v14
  v_sub_f32 v224, v224, v14
  v_sub_f32 v160, v160, v14
  v_sub_f32 v209, v209, v14
  v_sub_f32 v225, v225, v14
  v_sub_f32 v161, v161, v14
  v_sub_f32 v210, v210, v14
  v_sub_f32 v226, v226, v14
  v_sub_f32 v162, v162, v14
  v_sub_f32 v211, v211, v14
  v_sub_f32 v227, v227, v14
  v_sub_f32 v163, v163, v14
  v_sub_f32 v212, v212, v14
  v_sub_f32 v228, v228, v14
  v_sub_f32 v164, v164, v14
  v_sub_f32 v213, v213, v14
  v_sub_f32 v229, v229, v14
  v_sub_f32 v165, v165, v14
  v_sub_f32 v214, v214, v14
  v_sub_f32 v230, v230, v14
  v_sub_f32 v166, v166, v14
  v_sub_f32 v215, v215, v14
  v_sub_f32 v231, v231, v14
  v_sub_f32 v167, v167, v14
  v_sub_f32 v216, v216, v14
  v_sub_f32 v232, v232, v14
  v_sub_f32 v168, v168, v14
  v_sub_f32 v217, v217, v14
  v_sub_f32 v233, v233, v14
  v_sub_f32 v169, v169, v14
  v_sub_f32 v218, v218, v14
  v_sub_f32 v234, v234, v14
  v_sub_f32 v170, v170, v14
  v_sub_f32 v219, v219, v14
  v_sub_f32 v235, v235, v14
  v_sub_f32 v171, v171, v14
  v_sub_f32 v220, v220, v14
  v_sub_f32 v236, v236, v14
  v_sub_f32 v172, v172, v14
  v_sub_f32 v221, v221, v14
  v_sub_f32 v237, v237, v14
  v_sub_f32 v173, v173, v14
  v_sub_f32 v222, v222, v14
  v_sub_f32 v238, v238, v14
  v_sub_f32 v174, v174, v14
  v_sub_f32 v223, v223, v14
  v_sub_f32 v239, v239, v14
  v_sub_f32 v175, v175, v14
  v_mul_f32 v12, v12, v15
  v_mul_f32 v64, v64, v15
  v_mul_f32 v65, v65, v15
  v_mul_f32 v66, v66, v15
  v_mul_f32 v67, v67, v15
  v_mul_f32 v68, v68, v15
  v_mul_f32 v69, v69, v15
  v_mul_f32 v70, v70, v15
  v_mul_f32 v71, v71, v15
  v_mul_f32 v72, v72, v15
  v_mul_f32 v73, v73, v15
  v_mul_f32 v74, v74, v15
  v_mul_f32 v75, v75, v15
  v_mul_f32 v76, v76, v15
  v_mul_f32 v77, v77, v15
  v_mul_f32 v78, v78, v15
  v_mul_f32 v79, v79, v15
  v_mul_f32 v80, v80, v15
  v_mul_f32 v81, v81, v15
  v_mul_f32 v82, v82, v15
  v_mul_f32 v83, v83, v15
  v_mul_f32 v84, v84, v15
  v_mul_f32 v85, v85, v15
  v_mul_f32 v86, v86, v15
  v_mul_f32 v87, v87, v15
  v_mul_f32 v88, v88, v15
  v_mul_f32 v89, v89, v15
  v_mul_f32 v90, v90, v15
  v_mul_f32 v91, v91, v15
  v_mul_f32 v92, v92, v15
  v_mul_f32 v93, v93, v15
  v_mul_f32 v94, v94, v15
  v_mul_f32 v95, v95, v15
  v_mul_f32 v96, v96, v15
  v_mul_f32 v97, v97, v15
  v_mul_f32 v98, v98, v15
  v_mul_f32 v99, v99, v15
  v_mul_f32 v100, v100, v15
  v_mul_f32 v101, v101, v15
  v_mul_f32 v102, v102, v15
  v_mul_f32 v103, v103, v15
  v_mul_f32 v104, v104, v15
  v_mul_f32 v105, v105, v15
  v_mul_f32 v106, v106, v15
  v_mul_f32 v107, v107, v15
  v_mul_f32 v108, v108, v15
  v_mul_f32 v109, v109, v15
  v_mul_f32 v110, v110, v15
  v_mul_f32 v111, v111, v15
  v_mul_f32 v112, v112, v15
  v_mul_f32 v113, v113, v15
  v_mul_f32 v114, v114, v15
  v_mul_f32 v115, v115, v15
  v_mul_f32 v116, v116, v15
  v_mul_f32 v117, v117, v15
  v_mul_f32 v118, v118, v15
  v_mul_f32 v119, v119, v15
  v_mul_f32 v120, v120, v15
  v_mul_f32 v121, v121, v15
  v_mul_f32 v122, v122, v15
  v_mul_f32 v123, v123, v15
  v_mul_f32 v124, v124, v15
  v_mul_f32 v125, v125, v15
  v_mul_f32 v126, v126, v15
  v_mul_f32 v127, v127, v15
  v_lshlrev_b32 v48, 16, v200
  v_and_b32 v49, 0xffff0000, v200
  v_mul_f32 v48, v48, v15
  v_mul_f32 v49, v49, v15
  v_cvt_pk_bf16_f32 v200, v48, v49
  v_lshlrev_b32 v48, 16, v201
  v_and_b32 v49, 0xffff0000, v201
  v_mul_f32 v48, v48, v15
  v_mul_f32 v49, v49, v15
  v_cvt_pk_bf16_f32 v201, v48, v49
  v_lshlrev_b32 v48, 16, v202
  v_and_b32 v49, 0xffff0000, v202
  v_mul_f32 v48, v48, v15
  v_mul_f32 v49, v49, v15
  v_cvt_pk_bf16_f32 v202, v48, v49
  v_lshlrev_b32 v48, 16, v203
  v_and_b32 v49, 0xffff0000, v203
  v_mul_f32 v48, v48, v15
  v_mul_f32 v49, v49, v15
  v_cvt_pk_bf16_f32 v203, v48, v49
  v_lshlrev_b32 v48, 16, v204
  v_and_b32 v49, 0xffff0000, v204
  v_mul_f32 v48, v48, v15
  v_mul_f32 v49, v49, v15
  v_cvt_pk_bf16_f32 v204, v48, v49
  v_lshlrev_b32 v48, 16, v205
  v_and_b32 v49, 0xffff0000, v205
  v_mul_f32 v48, v48, v15
  v_mul_f32 v49, v49, v15
  v_cvt_pk_bf16_f32 v205, v48, v49
  v_lshlrev_b32 v48, 16, v206
  v_and_b32 v49, 0xffff0000, v206
  v_mul_f32 v48, v48, v15
  v_mul_f32 v49, v49, v15
  v_cvt_pk_bf16_f32 v206, v48, v49
  v_lshlrev_b32 v48, 16, v207
  v_and_b32 v49, 0xffff0000, v207
  v_mul_f32 v48, v48, v15
  v_mul_f32 v49, v49, v15
  v_cvt_pk_bf16_f32 v207, v48, v49
  v_exp_f32 v48, v224
  v_exp_f32 v49, v225
  v_exp_f32 v50, v226
  v_add_f32 v60, v49, v48
  v_cvt_pk_bf16_f32 v240, v48, v49
  v_exp_f32 v51, v227
  v_add_f32 v60, v50, v60
  v_exp_f32 v52, v228
  v_add_f32 v60, v51, v60
  v_cvt_pk_bf16_f32 v241, v50, v51
  v_exp_f32 v53, v229
  v_add_f32 v60, v52, v60
  v_exp_f32 v54, v230
  v_add_f32 v60, v53, v60
  v_cvt_pk_bf16_f32 v242, v52, v53
  v_exp_f32 v55, v231
  v_add_f32 v60, v54, v60
  v_exp_f32 v48, v232
  v_add_f32 v60, v55, v60
  v_cvt_pk_bf16_f32 v243, v54, v55
  v_exp_f32 v49, v233
  v_add_f32 v60, v48, v60
  v_exp_f32 v50, v234
  v_add_f32 v60, v49, v60
  v_cvt_pk_bf16_f32 v244, v48, v49
  v_exp_f32 v51, v235
  v_add_f32 v60, v50, v60
  v_exp_f32 v52, v236
  v_add_f32 v60, v51, v60
  v_cvt_pk_bf16_f32 v245, v50, v51
  v_exp_f32 v53, v237
  v_add_f32 v60, v52, v60
  v_exp_f32 v54, v238
  v_add_f32 v60, v53, v60
  v_cvt_pk_bf16_f32 v246, v52, v53
  v_exp_f32 v55, v239
  v_add_f32 v60, v54, v60
  v_add_f32 v60, v55, v60
  v_cvt_pk_bf16_f32 v247, v54, v55
  s_nop 1
  s_branch L_back11
L_rare12:
  s_nop 15
  s_nop 3
  v_max3_f32 v14, v160, v161, v162
  v_max3_f32 v14, v14, v163, v164
  v_max3_f32 v14, v14, v165, v166
  v_max3_f32 v14, v14, v167, v168
  v_max3_f32 v14, v14, v169, v170
  v_max3_f32 v14, v14, v171, v172
  v_max3_f32 v14, v14, v173, v174
  v_max3_f32 v14, v14, v175, 0
  v_mov_b32 v15, v14
  s_nop 1
  v_permlane32_swap_b32 v14, v15
  v_max_f32 v14, v14, v15
  v_ceil_f32 v14, v14
  v_sub_f32 v15, 0, v14
  v_exp_f32 v15, v15
  v_sub_f32 v208, v208, v14
  v_sub_f32 v160, v160, v14
  v_sub_f32 v176, v176, v14
  v_sub_f32 v209, v209, v14
  v_sub_f32 v161, v161, v14
  v_sub_f32 v177, v177, v14
  v_sub_f32 v210, v210, v14
  v_sub_f32 v162, v162, v14
  v_sub_f32 v178, v178, v14
  v_sub_f32 v211, v211, v14
  v_sub_f32 v163, v163, v14
  v_sub_f32 v179, v179, v14
  v_sub_f32 v212, v212, v14
  v_sub_f32 v164, v164, v14
  v_sub_f32 v180, v180, v14
  v_sub_f32 v213, v213, v14
  v_sub_f32 v165, v165, v14
  v_sub_f32 v181, v181, v14
  v_sub_f32 v214, v214, v14
  v_sub_f32 v166, v166, v14
  v_sub_f32 v182, v182, v14
  v_sub_f32 v215, v215, v14
  v_sub_f32 v167, v167, v14
  v_sub_f32 v183, v183, v14
  v_sub_f32 v216, v216, v14
  v_sub_f32 v168, v168, v14
  v_sub_f32 v184, v184, v14
  v_sub_f32 v217, v217, v14
  v_sub_f32 v169, v169, v14
  v_sub_f32 v185, v185, v14
  v_sub_f32 v218, v218, v14
  v_sub_f32 v170, v170, v14
  v_sub_f32 v186, v186, v14
  v_sub_f32 v219, v219, v14
  v_sub_f32 v171, v171, v14
  v_sub_f32 v187, v187, v14
  v_sub_f32 v220, v220, v14
  v_sub_f32 v172, v172, v14
  v_sub_f32 v188, v188, v14
  v_sub_f32 v221, v221, v14
  v_sub_f32 v173, v173, v14
  v_sub_f32 v189, v189, v14
  v_sub_f32 v222, v222, v14
  v_sub_f32 v174, v174, v14
  v_sub_f32 v190, v190, v14
  v_sub_f32 v223, v223, v14
  v_sub_f32 v175, v175, v14
  v_sub_f32 v191, v191, v14
  v_mul_f32 v12, v12, v15
  v_mul_f32 v64, v64, v15
  v_mul_f32 v65, v65, v15
  v_mul_f32 v66, v66, v15
  v_mul_f32 v67, v67, v15
  v_mul_f32 v68, v68, v15
  v_mul_f32 v69, v69, v15
  v_mul_f32 v70, v70, v15
  v_mul_f32 v71, v71, v15
  v_mul_f32 v72, v72, v15
  v_mul_f32 v73, v73, v15
  v_mul_f32 v74, v74, v15
  v_mul_f32 v75, v75, v15
  v_mul_f32 v76, v76, v15
  v_mul_f32 v77, v77, v15
  v_mul_f32 v78, v78, v15
  v_mul_f32 v79, v79, v15
  v_mul_f32 v80, v80, v15
  v_mul_f32 v81, v81, v15
  v_mul_f32 v82, v82, v15
  v_mul_f32 v83, v83, v15
  v_mul_f32 v84, v84, v15
  v_mul_f32 v85, v85, v15
  v_mul_f32 v86, v86, v15
  v_mul_f32 v87, v87, v15
  v_mul_f32 v88, v88, v15
  v_mul_f32 v89, v89, v15
  v_mul_f32 v90, v90, v15
  v_mul_f32 v91, v91, v15
  v_mul_f32 v92, v92, v15
  v_mul_f32 v93, v93, v15
  v_mul_f32 v94, v94, v15
  v_mul_f32 v95, v95, v15
  v_mul_f32 v96, v96, v15
  v_mul_f32 v97, v97, v15
  v_mul_f32 v98, v98, v15
  v_mul_f32 v99, v99, v15
  v_mul_f32 v100, v100, v15
  v_mul_f32 v101, v101, v15
  v_mul_f32 v102, v102, v15
  v_mul_f32 v103, v103, v15
  v_mul_f32 v104, v104, v15
  v_mul_f32 v105, v105, v15
  v_mul_f32 v106, v106, v15
  v_mul_f32 v107, v107, v15
  v_mul_f32 v108, v108, v15
  v_mul_f32 v109, v109, v15
  v_mul_f32 v110, v110, v15
  v_mul_f32 v111, v111, v15
  v_mul_f32 v112, v112, v15
  v_mul_f32 v113, v113, v15
  v_mul_f32 v114, v114, v15
  v_mul_f32 v115, v115, v15
  v_mul_f32 v116, v116, v15
  v_mul_f32 v117, v117, v15
  v_mul_f32 v118, v118, v15
  v_mul_f32 v119, v119, v15
  v_mul_f32 v120, v120, v15
  v_mul_f32 v121, v121, v15
  v_mul_f32 v122, v122, v15
  v_mul_f32 v123, v123, v15
  v_mul_f32 v124, v124, v15
  v_mul_f32 v125, v125, v15
  v_mul_f32 v126, v126, v15
  v_mul_f32 v127, v127, v15
  v_lshlrev_b32 v48, 16, v240
  v_and_b32 v49, 0xffff0000, v240
  v_mul_f32 v48, v48, v15
  v_mul_f32 v49, v49, v15
  v_cvt_pk_bf16_f32 v240, v48, v49
  v_lshlrev_b32 v48, 16, v241
  v_and_b32 v49, 0xffff0000, v241
  v_mul_f32 v48, v48, v15
  v_mul_f32 v49, v49, v15
  v_cvt_pk_bf16_f32 v241, v48, v49
  v_lshlrev_b32 v48, 16, v242
  v_and_b32 v49, 0xffff0000, v242
  v_mul_f32 v48, v48, v15
  v_mul_f32 v49, v49, v15
  v_cvt_pk_bf16_f32 v242, v48, v49
  v_lshlrev_b32 v48, 16, v243
  v_and_b32 v49, 0xffff0000, v243
  v_mul_f32 v48, v48, v15
  v_mul_f32 v49, v49, v15
  v_cvt_pk_bf16_f32 v243, v48, v49
  v_lshlrev_b32 v48, 16, v244
  v_and_b32 v49, 0xffff0000, v244
  v_mul_f32 v48, v48, v15
  v_mul_f32 v49, v49, v15
  v_cvt_pk_bf16_f32 v244, v48, v49
  v_lshlrev_b32 v48, 16, v245
  v_and_b32 v49, 0xffff0000, v245
  v_mul_f32 v48, v48, v15
  v_mul_f32 v49, v49, v15
  v_cvt_pk_bf16_f32 v245, v48, v49
  v_lshlrev_b32 v48, 16, v246
  v_and_b32 v49, 0xffff0000, v246
  v_mul_f32 v48, v48, v15
  v_mul_f32 v49, v49, v15
  v_cvt_pk_bf16_f32 v246, v48, v49
  v_lshlrev_b32 v48, 16, v247
  v_and_b32 v49, 0xffff0000, v247
  v_mul_f32 v48, v48, v15
  v_mul_f32 v49, v49, v15
  v_cvt_pk_bf16_f32 v247, v48, v49
  v_exp_f32 v48, v160
  v_exp_f32 v49, v161
  v_exp_f32 v50, v162
  v_add_f32 v13, v49, v48
  v_cvt_pk_bf16_f32 v192, v48, v49
  v_exp_f32 v51, v163
  v_add_f32 v13, v50, v13
  v_exp_f32 v52, v164
  v_add_f32 v13, v51, v13
  v_cvt_pk_bf16_f32 v193, v50, v51
  v_exp_f32 v53, v165
  v_add_f32 v13, v52, v13
  v_exp_f32 v54, v166
  v_add_f32 v13, v53, v13
  v_cvt_pk_bf16_f32 v194, v52, v53
  v_exp_f32 v55, v167
  v_add_f32 v13, v54, v13
  v_exp_f32 v48, v168
  v_add_f32 v13, v55, v13
  v_cvt_pk_bf16_f32 v195, v54, v55
  v_exp_f32 v49, v169
  v_add_f32 v13, v48, v13
  v_exp_f32 v50, v170
  v_add_f32 v13, v49, v13
  v_cvt_pk_bf16_f32 v196, v48, v49
  v_exp_f32 v51, v171
  v_add_f32 v13, v50, v13
  v_exp_f32 v52, v172
  v_add_f32 v13, v51, v13
  v_cvt_pk_bf16_f32 v197, v50, v51
  v_exp_f32 v53, v173
  v_add_f32 v13, v52, v13
  v_exp_f32 v54, v174
  v_add_f32 v13, v53, v13
  v_cvt_pk_bf16_f32 v198, v52, v53
  v_exp_f32 v55, v175
  v_add_f32 v13, v54, v13
  v_add_f32 v13, v55, v13
  v_cvt_pk_bf16_f32 v199, v54, v55
  s_nop 1
  s_branch L_back12
L_rare13:
  s_nop 15
  s_nop 3
  v_max3_f32 v14, v176, v177, v178
  v_max3_f32 v14, v14, v179, v180
  v_max3_f32 v14, v14, v181, v182
  v_max3_f32 v14, v14, v183, v184
  v_max3_f32 v14, v14, v185, v186
  v_max3_f32 v14, v14, v187, v188
  v_max3_f32 v14, v14, v189, v190
  v_max3_f32 v14, v14, v191, 0
  v_mov_b32 v15, v14
  s_nop 1
  v_permlane32_swap_b32 v14, v15
  v_max_f32 v14, v14, v15
  v_ceil_f32 v14, v14
  v_sub_f32 v15, 0, v14
  v_exp_f32 v15, v15
  v_sub_f32 v208, v208, v14
  v_sub_f32 v176, v176, v14
  v_sub_f32 v224, v224, v14
  v_sub_f32 v209, v209, v14
  v_sub_f32 v177, v177, v14
  v_sub_f32 v225, v225, v14
  v_sub_f32 v210, v210, v14
  v_sub_f32 v178, v178, v14
  v_sub_f32 v226, v226, v14
  v_sub_f32 v211, v211, v14
  v_sub_f32 v179, v179, v14
  v_sub_f32 v227, v227, v14
  v_sub_f32 v212, v212, v14
  v_sub_f32 v180, v180, v14
  v_sub_f32 v228, v228, v14
  v_sub_f32 v213, v213, v14
  v_sub_f32 v181, v181, v14
  v_sub_f32 v229, v229, v14
  v_sub_f32 v214, v214, v14
  v_sub_f32 v182, v182, v14
  v_sub_f32 v230, v230, v14
  v_sub_f32 v215, v215, v14
  v_sub_f32 v183, v183, v14
  v_sub_f32 v231, v231, v14
  v_sub_f32 v216, v216, v14
  v_sub_f32 v184, v184, v14
  v_sub_f32 v232, v232, v14
  v_sub_f32 v217, v217, v14
  v_sub_f32 v185, v185, v14
  v_sub_f32 v233, v233, v14
  v_sub_f32 v218, v218, v14
  v_sub_f32 v186, v186, v14
  v_sub_f32 v234, v234, v14
  v_sub_f32 v219, v219, v14
  v_sub_f32 v187, v187, v14
  v_sub_f32 v235, v235, v14
  v_sub_f32 v220, v220, v14
  v_sub_f32 v188, v188, v14
  v_sub_f32 v236, v236, v14
  v_sub_f32 v221, v221, v14
  v_sub_f32 v189, v189, v14
  v_sub_f32 v237, v237, v14
  v_sub_f32 v222, v222, v14
  v_sub_f32 v190, v190, v14
  v_sub_f32 v238, v238, v14
  v_sub_f32 v223, v223, v14
  v_sub_f32 v191, v191, v14
  v_sub_f32 v239, v239, v14
  v_mul_f32 v12, v12, v15
  v_mul_f32 v64, v64, v15
  v_mul_f32 v65, v65, v15
  v_mul_f32 v66, v66, v15
  v_mul_f32 v67, v67, v15
  v_mul_f32 v68, v68, v15
  v_mul_f32 v69, v69, v15
  v_mul_f32 v70, v70, v15
  v_mul_f32 v71, v71, v15
  v_mul_f32 v72, v72, v15
  v_mul_f32 v73, v73, v15
  v_mul_f32 v74, v74, v15
  v_mul_f32 v75, v75, v15
  v_mul_f32 v76, v76, v15
  v_mul_f32 v77, v77, v15
  v_mul_f32 v78, v78, v15
  v_mul_f32 v79, v79, v15
  v_mul_f32 v80, v80, v15
  v_mul_f32 v81, v81, v15
  v_mul_f32 v82, v82, v15
  v_mul_f32 v83, v83, v15
  v_mul_f32 v84, v84, v15
  v_mul_f32 v85, v85, v15
  v_mul_f32 v86, v86, v15
  v_mul_f32 v87, v87, v15
  v_mul_f32 v88, v88, v15
  v_mul_f32 v89, v89, v15
  v_mul_f32 v90, v90, v15
  v_mul_f32 v91, v91, v15
  v_mul_f32 v92, v92, v15
  v_mul_f32 v93, v93, v15
  v_mul_f32 v94, v94, v15
  v_mul_f32 v95, v95, v15
  v_mul_f32 v96, v96, v15
  v_mul_f32 v97, v97, v15
  v_mul_f32 v98, v98, v15
  v_mul_f32 v99, v99, v15
  v_mul_f32 v100, v100, v15
  v_mul_f32 v101, v101, v15
  v_mul_f32 v102, v102, v15
  v_mul_f32 v103, v103, v15
  v_mul_f32 v104, v104, v15
  v_mul_f32 v105, v105, v15
  v_mul_f32 v106, v106, v15
  v_mul_f32 v107, v107, v15
  v_mul_f32 v108, v108, v15
  v_mul_f32 v109, v109, v15
  v_mul_f32 v110, v110, v15
  v_mul_f32 v111, v111, v15
  v_mul_f32 v112, v112, v15
  v_mul_f32 v113, v113, v15
  v_mul_f32 v114, v114, v15
  v_mul_f32 v115, v115, v15
  v_mul_f32 v116, v116, v15
  v_mul_f32 v117, v117, v15
  v_mul_f32 v118, v118, v15
  v_mul_f32 v119, v119, v15
  v_mul_f32 v120, v120, v15
  v_mul_f32 v121, v121, v15
  v_mul_f32 v122, v122, v15
  v_mul_f32 v123, v123, v15
  v_mul_f32 v124, v124, v15
  v_mul_f32 v125, v125, v15
  v_mul_f32 v126, v126, v15
  v_mul_f32 v127, v127, v15
  v_lshlrev_b32 v48, 16, v192
  v_and_b32 v49, 0xffff0000, v192
  v_mul_f32 v48, v48, v15
  v_mul_f32 v49, v49, v15
  v_cvt_pk_bf16_f32 v192, v48, v49
  v_lshlrev_b32 v48, 16, v193
  v_and_b32 v49, 0xffff0000, v193
  v_mul_f32 v48, v48, v15
  v_mul_f32 v49, v49, v15
  v_cvt_pk_bf16_f32 v193, v48, v49
  v_lshlrev_b32 v48, 16, v194
  v_and_b32 v49, 0xffff0000, v194
  v_mul_f32 v48, v48, v15
  v_mul_f32 v49, v49, v15
  v_cvt_pk_bf16_f32 v194, v48, v49
  v_lshlrev_b32 v48, 16, v195
  v_and_b32 v49, 0xffff0000, v195
  v_mul_f32 v48, v48, v15
  v_mul_f32 v49, v49, v15
  v_cvt_pk_bf16_f32 v195, v48, v49
  v_lshlrev_b32 v48, 16, v196
  v_and_b32 v49, 0xffff0000, v196
  v_mul_f32 v48, v48, v15
  v_mul_f32 v49, v49, v15
  v_cvt_pk_bf16_f32 v196, v48, v49
  v_lshlrev_b32 v48, 16, v197
  v_and_b32 v49, 0xffff0000, v197
  v_mul_f32 v48, v48, v15
  v_mul_f32 v49, v49, v15
  v_cvt_pk_bf16_f32 v197, v48, v49
  v_lshlrev_b32 v48, 16, v198
  v_and_b32 v49, 0xffff0000, v198
  v_mul_f32 v48, v48, v15
  v_mul_f32 v49, v49, v15
  v_cvt_pk_bf16_f32 v198, v48, v49
  v_lshlrev_b32 v48, 16, v199
  v_and_b32 v49, 0xffff0000, v199
  v_mul_f32 v48, v48, v15
  v_mul_f32 v49, v49, v15
  v_cvt_pk_bf16_f32 v199, v48, v49
  v_exp_f32 v48, v176
  v_exp_f32 v49, v177
  v_exp_f32 v50, v178
  v_add_f32 v60, v49, v48
  v_cvt_pk_bf16_f32 v200, v48, v49
  v_exp_f32 v51, v179
  v_add_f32 v60, v50, v60
  v_exp_f32 v52, v180
  v_add_f32 v60, v51, v60
  v_cvt_pk_bf16_f32 v201, v50, v51
  v_exp_f32 v53, v181
  v_add_f32 v60, v52, v60
  v_exp_f32 v54, v182
  v_add_f32 v60, v53, v60
  v_cvt_pk_bf16_f32 v202, v52, v53
  v_exp_f32 v55, v183
  v_add_f32 v60, v54, v60
  v_exp_f32 v48, v184
  v_add_f32 v60, v55, v60
  v_cvt_pk_bf16_f32 v203, v54, v55
  v_exp_f32 v49, v185
  v_add_f32 v60, v48, v60
  v_exp_f32 v50, v186
  v_add_f32 v60, v49, v60
  v_cvt_pk_bf16_f32 v204, v48, v49
  v_exp_f32 v51, v187
  v_add_f32 v60, v50, v60
  v_exp_f32 v52, v188
  v_add_f32 v60, v51, v60
  v_cvt_pk_bf16_f32 v205, v50, v51
  v_exp_f32 v53, v189
  v_add_f32 v60, v52, v60
  v_exp_f32 v54, v190
  v_add_f32 v60, v53, v60
  v_cvt_pk_bf16_f32 v206, v52, v53
  v_exp_f32 v55, v191
  v_add_f32 v60, v54, v60
  v_add_f32 v60, v55, v60
  v_cvt_pk_bf16_f32 v207, v54, v55
  s_nop 1
  s_branch L_back13
L_rare14:
  s_nop 15
  s_nop 3
  v_max3_f32 v14, v224, v225, v226
  v_max3_f32 v14, v14, v227, v228
  v_max3_f32 v14, v14, v229, v230
  v_max3_f32 v14, v14, v231, v232
  v_max3_f32 v14, v14, v233, v234
  v_max3_f32 v14, v14, v235, v236
  v_max3_f32 v14, v14, v237, v238
  v_max3_f32 v14, v14, v239, 0
  v_mov_b32 v15, v14
  s_nop 1
  v_permlane32_swap_b32 v14, v15
  v_max_f32 v14, v14, v15
  v_ceil_f32 v14, v14
  v_sub_f32 v15, 0, v14
  v_exp_f32 v15, v15
  v_sub_f32 v208, v208, v14
  v_sub_f32 v224, v224, v14
  v_sub_f32 v160, v160, v14
  v_sub_f32 v209, v209, v14
  v_sub_f32 v225, v225, v14
  v_sub_f32 v161, v161, v14
  v_sub_f32 v210, v210, v14
  v_sub_f32 v226, v226, v14
  v_sub_f32 v162, v162, v14
  v_sub_f32 v211, v211, v14
  v_sub_f32 v227, v227, v14
  v_sub_f32 v163, v163, v14
  v_sub_f32 v212, v212, v14
  v_sub_f32 v228, v228, v14
  v_sub_f32 v164, v164, v14
  v_sub_f32 v213, v213, v14
  v_sub_f32 v229, v229, v14
  v_sub_f32 v165, v165, v14
  v_sub_f32 v214, v214, v14
  v_sub_f32 v230, v230, v14
  v_sub_f32 v166, v166, v14
  v_sub_f32 v215, v215, v14
  v_sub_f32 v231, v231, v14
  v_sub_f32 v167, v167, v14
  v_sub_f32 v216, v216, v14
  v_sub_f32 v232, v232, v14
  v_sub_f32 v168, v168, v14
  v_sub_f32 v217, v217, v14
  v_sub_f32 v233, v233, v14
  v_sub_f32 v169, v169, v14
  v_sub_f32 v218, v218, v14
  v_sub_f32 v234, v234, v14
  v_sub_f32 v170, v170, v14
  v_sub_f32 v219, v219, v14
  v_sub_f32 v235, v235, v14
  v_sub_f32 v171, v171, v14
  v_sub_f32 v220, v220, v14
  v_sub_f32 v236, v236, v14
  v_sub_f32 v172, v172, v14
  v_sub_f32 v221, v221, v14
  v_sub_f32 v237, v237, v14
  v_sub_f32 v173, v173, v14
  v_sub_f32 v222, v222, v14
  v_sub_f32 v238, v238, v14
  v_sub_f32 v174, v174, v14
  v_sub_f32 v223, v223, v14
  v_sub_f32 v239, v239, v14
  v_sub_f32 v175, v175, v14
  v_mul_f32 v12, v12, v15
  v_mul_f32 v64, v64, v15
  v_mul_f32 v65, v65, v15
  v_mul_f32 v66, v66, v15
  v_mul_f32 v67, v67, v15
  v_mul_f32 v68, v68, v15
  v_mul_f32 v69, v69, v15
  v_mul_f32 v70, v70, v15
  v_mul_f32 v71, v71, v15
  v_mul_f32 v72, v72, v15
  v_mul_f32 v73, v73, v15
  v_mul_f32 v74, v74, v15
  v_mul_f32 v75, v75, v15
  v_mul_f32 v76, v76, v15
  v_mul_f32 v77, v77, v15
  v_mul_f32 v78, v78, v15
  v_mul_f32 v79, v79, v15
  v_mul_f32 v80, v80, v15
  v_mul_f32 v81, v81, v15
  v_mul_f32 v82, v82, v15
  v_mul_f32 v83, v83, v15
  v_mul_f32 v84, v84, v15
  v_mul_f32 v85, v85, v15
  v_mul_f32 v86, v86, v15
  v_mul_f32 v87, v87, v15
  v_mul_f32 v88, v88, v15
  v_mul_f32 v89, v89, v15
  v_mul_f32 v90, v90, v15
  v_mul_f32 v91, v91, v15
  v_mul_f32 v92, v92, v15
  v_mul_f32 v93, v93, v15
  v_mul_f32 v94, v94, v15
  v_mul_f32 v95, v95, v15
  v_mul_f32 v96, v96, v15
  v_mul_f32 v97, v97, v15
  v_mul_f32 v98, v98, v15
  v_mul_f32 v99, v99, v15
  v_mul_f32 v100, v100, v15
  v_mul_f32 v101, v101, v15
  v_mul_f32 v102, v102, v15
  v_mul_f32 v103, v103, v15
  v_mul_f32 v104, v104, v15
  v_mul_f32 v105, v105, v15
  v_mul_f32 v106, v106, v15
  v_mul_f32 v107, v107, v15
  v_mul_f32 v108, v108, v15
  v_mul_f32 v109, v109, v15
  v_mul_f32 v110, v110, v15
  v_mul_f32 v111, v111, v15
  v_mul_f32 v112, v112, v15
  v_mul_f32 v113, v113, v15
  v_mul_f32 v114, v114, v15
  v_mul_f32 v115, v115, v15
  v_mul_f32 v116, v116, v15
  v_mul_f32 v117, v117, v15
  v_mul_f32 v118, v118, v15
  v_mul_f32 v119, v119, v15
  v_mul_f32 v120, v120, v15
  v_mul_f32 v121, v121, v15
  v_mul_f32 v122, v122, v15
  v_mul_f32 v123, v123, v15
  v_mul_f32 v124, v124, v15
  v_mul_f32 v125, v125, v15
  v_mul_f32 v126, v126, v15
  v_mul_f32 v127, v127, v15
  v_lshlrev_b32 v48, 16, v200
  v_and_b32 v49, 0xffff0000, v200
  v_mul_f32 v48, v48, v15
  v_mul_f32 v49, v49, v15
  v_cvt_pk_bf16_f32 v200, v48, v49
  v_lshlrev_b32 v48, 16, v201
  v_and_b32 v49, 0xffff0000, v201
  v_mul_f32 v48, v48, v15
  v_mul_f32 v49, v49, v15
  v_cvt_pk_bf16_f32 v201, v48, v49
  v_lshlrev_b32 v48, 16, v202
  v_and_b32 v49, 0xffff0000, v202
  v_mul_f32 v48, v48, v15
  v_mul_f32 v49, v49, v15
  v_cvt_pk_bf16_f32 v202, v48, v49
  v_lshlrev_b32 v48, 16, v203
  v_and_b32 v49, 0xffff0000, v203
  v_mul_f32 v48, v48, v15
  v_mul_f32 v49, v49, v15
  v_cvt_pk_bf16_f32 v203, v48, v49
  v_lshlrev_b32 v48, 16, v204
  v_and_b32 v49, 0xffff0000, v204
  v_mul_f32 v48, v48, v15
  v_mul_f32 v49, v49, v15
  v_cvt_pk_bf16_f32 v204, v48, v49
  v_lshlrev_b32 v48, 16, v205
  v_and_b32 v49, 0xffff0000, v205
  v_mul_f32 v48, v48, v15
  v_mul_f32 v49, v49, v15
  v_cvt_pk_bf16_f32 v205, v48, v49
  v_lshlrev_b32 v48, 16, v206
  v_and_b32 v49, 0xffff0000, v206
  v_mul_f32 v48, v48, v15
  v_mul_f32 v49, v49, v15
  v_cvt_pk_bf16_f32 v206, v48, v49
  v_lshlrev_b32 v48, 16, v207
  v_and_b32 v49, 0xffff0000, v207
  v_mul_f32 v48, v48, v15
  v_mul_f32 v49, v49, v15
  v_cvt_pk_bf16_f32 v207, v48, v49
  v_exp_f32 v48, v224
  v_exp_f32 v49, v225
  v_exp_f32 v50, v226
  v_add_f32 v13, v49, v48
  v_cvt_pk_bf16_f32 v240, v48, v49
  v_exp_f32 v51, v227
  v_add_f32 v13, v50, v13
  v_exp_f32 v52, v228
  v_add_f32 v13, v51, v13
  v_cvt_pk_bf16_f32 v241, v50, v51
  v_exp_f32 v53, v229
  v_add_f32 v13, v52, v13
  v_exp_f32 v54, v230
  v_add_f32 v13, v53, v13
  v_cvt_pk_bf16_f32 v242, v52, v53
  v_exp_f32 v55, v231
  v_add_f32 v13, v54, v13
  v_exp_f32 v48, v232
  v_add_f32 v13, v55, v13
  v_cvt_pk_bf16_f32 v243, v54, v55
  v_exp_f32 v49, v233
  v_add_f32 v13, v48, v13
  v_exp_f32 v50, v234
  v_add_f32 v13, v49, v13
  v_cvt_pk_bf16_f32 v244, v48, v49
  v_exp_f32 v51, v235
  v_add_f32 v13, v50, v13
  v_exp_f32 v52, v236
  v_add_f32 v13, v51, v13
  v_cvt_pk_bf16_f32 v245, v50, v51
  v_exp_f32 v53, v237
  v_add_f32 v13, v52, v13
  v_exp_f32 v54, v238
  v_add_f32 v13, v53, v13
  v_cvt_pk_bf16_f32 v246, v52, v53
  v_exp_f32 v55, v239
  v_add_f32 v13, v54, v13
  v_add_f32 v13, v55, v13
  v_cvt_pk_bf16_f32 v247, v54, v55
  s_nop 1
  s_branch L_back14
L_rare15:
  s_nop 15
  s_nop 3
  v_max3_f32 v14, v160, v161, v162
  v_max3_f32 v14, v14, v163, v164
  v_max3_f32 v14, v14, v165, v166
  v_max3_f32 v14, v14, v167, v168
  v_max3_f32 v14, v14, v169, v170
  v_max3_f32 v14, v14, v171, v172
  v_max3_f32 v14, v14, v173, v174
  v_max3_f32 v14, v14, v175, 0
  v_mov_b32 v15, v14
  s_nop 1
  v_permlane32_swap_b32 v14, v15
  v_max_f32 v14, v14, v15
  v_ceil_f32 v14, v14
  v_sub_f32 v15, 0, v14
  v_exp_f32 v15, v15
  v_sub_f32 v208, v208, v14
  v_sub_f32 v160, v160, v14
  v_sub_f32 v209, v209, v14
  v_sub_f32 v161, v161, v14
  v_sub_f32 v210, v210, v14
  v_sub_f32 v162, v162, v14
  v_sub_f32 v211, v211, v14
  v_sub_f32 v163, v163, v14
  v_sub_f32 v212, v212, v14
  v_sub_f32 v164, v164, v14
  v_sub_f32 v213, v213, v14
  v_sub_f32 v165, v165, v14
  v_sub_f32 v214, v214, v14
  v_sub_f32 v166, v166, v14
  v_sub_f32 v215, v215, v14
  v_sub_f32 v167, v167, v14
  v_sub_f32 v216, v216, v14
  v_sub_f32 v168, v168, v14
  v_sub_f32 v217, v217, v14
  v_sub_f32 v169, v169, v14
  v_sub_f32 v218, v218, v14
  v_sub_f32 v170, v170, v14
  v_sub_f32 v219, v219, v14
  v_sub_f32 v171, v171, v14
  v_sub_f32 v220, v220, v14
  v_sub_f32 v172, v172, v14
  v_sub_f32 v221, v221, v14
  v_sub_f32 v173, v173, v14
  v_sub_f32 v222, v222, v14
  v_sub_f32 v174, v174, v14
  v_sub_f32 v223, v223, v14
  v_sub_f32 v175, v175, v14
  v_mul_f32 v12, v12, v15
  v_mul_f32 v64, v64, v15
  v_mul_f32 v65, v65, v15
  v_mul_f32 v66, v66, v15
  v_mul_f32 v67, v67, v15
  v_mul_f32 v68, v68, v15
  v_mul_f32 v69, v69, v15
  v_mul_f32 v70, v70, v15
  v_mul_f32 v71, v71, v15
  v_mul_f32 v72, v72, v15
  v_mul_f32 v73, v73, v15
  v_mul_f32 v74, v74, v15
  v_mul_f32 v75, v75, v15
  v_mul_f32 v76, v76, v15
  v_mul_f32 v77, v77, v15
  v_mul_f32 v78, v78, v15
  v_mul_f32 v79, v79, v15
  v_mul_f32 v80, v80, v15
  v_mul_f32 v81, v81, v15
  v_mul_f32 v82, v82, v15
  v_mul_f32 v83, v83, v15
  v_mul_f32 v84, v84, v15
  v_mul_f32 v85, v85, v15
  v_mul_f32 v86, v86, v15
  v_mul_f32 v87, v87, v15
  v_mul_f32 v88, v88, v15
  v_mul_f32 v89, v89, v15
  v_mul_f32 v90, v90, v15
  v_mul_f32 v91, v91, v15
  v_mul_f32 v92, v92, v15
  v_mul_f32 v93, v93, v15
  v_mul_f32 v94, v94, v15
  v_mul_f32 v95, v95, v15
  v_mul_f32 v96, v96, v15
  v_mul_f32 v97, v97, v15
  v_mul_f32 v98, v98, v15
  v_mul_f32 v99, v99, v15
  v_mul_f32 v100, v100, v15
  v_mul_f32 v101, v101, v15
  v_mul_f32 v102, v102, v15
  v_mul_f32 v103, v103, v15
  v_mul_f32 v104, v104, v15
  v_mul_f32 v105, v105, v15
  v_mul_f32 v106, v106, v15
  v_mul_f32 v107, v107, v15
  v_mul_f32 v108, v108, v15
  v_mul_f32 v109, v109, v15
  v_mul_f32 v110, v110, v15
  v_mul_f32 v111, v111, v15
  v_mul_f32 v112, v112, v15
  v_mul_f32 v113, v113, v15
  v_mul_f32 v114, v114, v15
  v_mul_f32 v115, v115, v15
  v_mul_f32 v116, v116, v15
  v_mul_f32 v117, v117, v15
  v_mul_f32 v118, v118, v15
  v_mul_f32 v119, v119, v15
  v_mul_f32 v120, v120, v15
  v_mul_f32 v121, v121, v15
  v_mul_f32 v122, v122, v15
  v_mul_f32 v123, v123, v15
  v_mul_f32 v124, v124, v15
  v_mul_f32 v125, v125, v15
  v_mul_f32 v126, v126, v15
  v_mul_f32 v127, v127, v15
  v_exp_f32 v48, v160
  v_exp_f32 v49, v161
  v_exp_f32 v50, v162
  v_add_f32 v60, v49, v48
  v_cvt_pk_bf16_f32 v192, v48, v49
  v_exp_f32 v51, v163
  v_add_f32 v60, v50, v60
  v_exp_f32 v52, v164
  v_add_f32 v60, v51, v60
  v_cvt_pk_bf16_f32 v193, v50, v51
  v_exp_f32 v53, v165
  v_add_f32 v60, v52, v60
  v_exp_f32 v54, v166
  v_add_f32 v60, v53, v60
  v_cvt_pk_bf16_f32 v194, v52, v53
  v_exp_f32 v55, v167
  v_add_f32 v60, v54, v60
  v_exp_f32 v48, v168
  v_add_f32 v60, v55, v60
  v_cvt_pk_bf16_f32 v195, v54, v55
  v_exp_f32 v49, v169
  v_add_f32 v60, v48, v60
  v_exp_f32 v50, v170
  v_add_f32 v60, v49, v60
  v_cvt_pk_bf16_f32 v196, v48, v49
  v_exp_f32 v51, v171
  v_add_f32 v60, v50, v60
  v_exp_f32 v52, v172
  v_add_f32 v60, v51, v60
  v_cvt_pk_bf16_f32 v197, v50, v51
  v_exp_f32 v53, v173
  v_add_f32 v60, v52, v60
  v_exp_f32 v54, v174
  v_add_f32 v60, v53, v60
  v_cvt_pk_bf16_f32 v198, v52, v53
  v_exp_f32 v55, v175
  v_add_f32 v60, v54, v60
  v_add_f32 v60, v55, v60
  v_cvt_pk_bf16_f32 v199, v54, v55
  s_nop 1
  s_branch L_back15
L_exit:
  s_endpgm
L_code_end:
.section .rodata,"a"
.p2align 6
.amdhsa_kernel concat_heads__gqa_block_cached__gqa_block_cached__near_ridge_kernel
  .amdhsa_next_free_vgpr 256
  .amdhsa_next_free_sgpr 102
  .amdhsa_accum_offset 256
  .amdhsa_group_segment_fixed_size 0
  .amdhsa_kernarg_size 104
  .amdhsa_user_sgpr_count 2
  .amdhsa_user_sgpr_kernarg_segment_ptr 1
  .amdhsa_system_sgpr_workgroup_id_x 1
.end_amdhsa_kernel
```
